```python
import torch

def _softmax(x, axis=-1):
    return torch.softmax(x, dim=axis)

def _gelu(x):
    return torch.nn.functional.gelu(x, approximate='tanh')

def _silu(x):
    return torch.nn.functional.silu(x)

def _sigmoid(x):
    return torch.sigmoid(x)

def _layernorm(x, axis=-1, eps=1e-05):
    m = x.mean(dim=axis, keepdim=True)
    v = x.var(dim=axis, keepdim=True, unbiased=False)
    return (x - m) / torch.sqrt(v + eps)

def _scatter_add(tgt, idx, src, axis=0):
    return tgt.clone().index_add_(axis, idx, src)

def _segment_sum(src, seg, n):
    out = torch.zeros((n,) + src.shape[1:], dtype=src.dtype)
    return out.index_add_(0, seg, src)

def _pad(x, pw):
    flat = tuple((v for pair in reversed(pw) for v in pair))
    return torch.nn.functional.pad(x, flat)
kernel_name = 'adaLN_cond__sliding_block__mixer_channel_mlp__prompt'

def setup_inputs():

    _w = lambda a: (lambda t: t.to(torch.bfloat16) if t.is_floating_point() else t)(torch.as_tensor(a))

    def _A_setup():
        B, S, D = (1, 2048, 640)
        return {'x': _w((lambda *s: torch.randn(*s, dtype=torch.bfloat16) * 0.05)(B, S, D)), 'wqkv': _w((lambda *s: torch.randn(*s, dtype=torch.bfloat16) * 0.05)(D, 3 * D)), 'wo': _w((lambda *s: torch.randn(*s, dtype=torch.bfloat16) * 0.05)(D, D))}
    _A_in = _A_setup()

    def _B_setup():
        B, S, D, F = (1, 2048, 640, 1536)
        return {'x': _w((lambda *s: torch.randn(*s, dtype=torch.bfloat16) * 0.05)(B, S, D)), 'w1': _w((lambda *s: torch.randn(*s, dtype=torch.bfloat16) * 3.2)(D, F) * D ** (-0.5)), 'b1': _w((lambda *s: torch.randn(*s, dtype=torch.bfloat16) * 1.6)(F)), 'w2': _w((lambda *s: torch.randn(*s, dtype=torch.bfloat16) * 0.4)(F, D) * F ** (-0.5)), 'b2': _w((lambda *s: torch.randn(*s, dtype=torch.bfloat16) * 0.8)(D))}
    _B_in = _B_setup()
    return {'A_x': _A_in['x'], 'A_wqkv': _A_in['wqkv'], 'A_wo': _A_in['wo'], 'B_x': _B_in['x'], 'B_w1': _B_in['w1'], 'B_b1': _B_in['b1'], 'B_w2': _B_in['w2'], 'B_b2': _B_in['b2'], 'c': _w((lambda *s: torch.randn(*s, dtype=torch.bfloat16) * 0.1)(1, 640) * 8.0), 'w_mod': _w((lambda *s: torch.randn(*s, dtype=torch.bfloat16) * 0.1)(640, 6 * 640) * 640 ** (-0.5) * 8.0)}

def reference(A_x, A_wqkv, A_wo, B_x, B_w1, B_b1, B_w2, B_b2, c, w_mod):

    def _A_ref(x, wqkv, wo):
        B, S, D = x.shape
        H = 32
        Dh = D // H
        W = 256
        qkv = (lambda x, *d: x.permute(*d))((x @ wqkv).reshape(B, S, 3, H, Dh), 2, 0, 3, 1, 4)
        q, k, v = (qkv[0], qkv[1], qkv[2])
        scores = torch.einsum('bhqd,bhkd->bhqk', q, k) * Dh ** (-0.5)
        idx = torch.arange(S)
        mask = (idx[:, None] - idx[None, :] >= 0) & (idx[:, None] - idx[None, :] < W)
        scores = torch.where(mask[None, None], scores, -1000000000.0)
        p = _softmax(scores, axis=-1)
        o = torch.einsum('bhqk,bhkd->bhqd', p, v)
        return (lambda x, *d: x.permute(*d))(o, 0, 2, 1, 3).reshape(B, S, D) @ wo

    def _B_ref(x, w1, b1, w2, b2):
        y = _layernorm(x, axis=-1)
        h = _gelu(torch.einsum('bsd,df->bsf', y, w1) + b1)
        return torch.einsum('bsf,fd->bsd', h, w2) + b2
    x = A_x
    mod = (_silu(c) @ w_mod).reshape(c.shape[0], 6, 1, -1)
    sa, ca, ga, sb, cb, gb = (mod[:, 0].clone(), mod[:, 1].clone(), mod[:, 2].clone(), mod[:, 3].clone(), mod[:, 4].clone(), mod[:, 5].clone())
    h = _layernorm(x, axis=-1) * (1 + ca) + sa
    x = x + ga * _A_ref(h, A_wqkv, A_wo)
    h = _layernorm(x, axis=-1) * (1 + cb) + sb
    x = x + gb * _B_ref(h, B_w1, B_b1, B_w2, B_b2)
    return x
```

```asm
; @launch grid=(256,1,1) block=(256,1,1) lds=163840
.amdgcn_target "amdgcn-amd-amdhsa--gfx950"
.text
.globl adaLN_cond__sliding_block__mixer_channel_mlp__prompt_kernel
.p2align 8
.type adaLN_cond__sliding_block__mixer_channel_mlp__prompt_kernel,@function
adaLN_cond__sliding_block__mixer_channel_mlp__prompt_kernel:
    s_cmp_ge_u32 s2, 256
    s_cbranch_scc1 L_END
    s_load_dwordx16 s[64:79], s[0:1], 0
    s_load_dwordx8 s[80:87], s[0:1], 64
    s_load_dwordx2 s[88:89], s[0:1], 96
    v_and_b32 v1, 63, v0
    v_lshrrev_b32 v3, 6, v0
    s_mov_b32 s56, s2
    s_and_b32 s57, s2, 7
    s_lshr_b32 s58, s2, 3
    v_readfirstlane_b32 s55, v3
    s_and_b32 s54, s58, 7
    s_and_b32 s59, s57, 1
    s_lshl_b32 s59, s59, 3
    s_add_u32 s54, s54, s59
    s_lshr_b32 s58, s58, 3
    s_lshr_b32 s57, s57, 1
    s_lshl_b32 s57, s57, 2
    s_add_u32 s53, s57, s58
    v_lshlrev_b32 v2, 4, v1
    s_waitcnt lgkmcnt(0)
    s_load_dword s90, s[88:89], 0
    s_mov_b32 s8, s64
    s_and_b32 s9, s65, 0xffff
    s_mov_b32 s10, 2621440
    s_mov_b32 s11, 0x20000
    s_mov_b32 s40, s80
    s_and_b32 s41, s81, 0xffff
    s_mov_b32 s42, 1280
    s_mov_b32 s43, 0x20000
    s_mov_b32 s28, s82
    s_and_b32 s29, s83, 0xffff
    s_mov_b32 s30, 4915200
    s_mov_b32 s31, 0x20000
    s_mov_b32 s12, s66
    s_and_b32 s13, s67, 0xffff
    s_mov_b32 s14, 2457600
    s_mov_b32 s15, 0x20000
    s_mov_b32 s36, s88
    s_and_b32 s37, s89, 0xffff
    s_mov_b32 s38, 33554432
    s_mov_b32 s39, 0x20000
    s_mov_b32 s16, s68
    s_and_b32 s17, s69, 0xffff
    s_mov_b32 s18, 819200
    s_mov_b32 s19, 0x20000
    s_mov_b32 s20, s72
    s_and_b32 s21, s73, 0xffff
    s_mov_b32 s22, 1966080
    s_mov_b32 s23, 0x20000
    s_mov_b32 s24, s76
    s_and_b32 s25, s77, 0xffff
    s_mov_b32 s26, 1966080
    s_mov_b32 s27, 0x20000
    s_mov_b32 s32, s84
    s_and_b32 s33, s85, 0xffff
    s_mov_b32 s34, 2621440
    s_mov_b32 s35, 0x20000
    s_mov_b32 s44, s74
    s_and_b32 s45, s75, 0xffff
    s_mov_b32 s46, 3072
    s_mov_b32 s47, 0x20000
    s_mov_b32 s48, s78
    s_and_b32 s49, s79, 0xffff
    s_mov_b32 s50, 1280
    s_mov_b32 s51, 0x20000
    s_cmp_eq_u32 s55, 2
    s_cbranch_scc1 P0G_1
    s_cmp_eq_u32 s55, 3
    s_cbranch_scc1 P0DM_2
    s_lshl_b32 s57, s53, 7
    s_lshl_b32 s58, s54, 3
    s_add_u32 s57, s57, s58
    s_mul_i32 s58, s57, 1280
    v_lshrrev_b32 v3, 4, v0
    v_and_b32_e64 v4, 15, v0
    v_mul_u32_u24 v5, 1280, v3
    v_lshl_add_u32 v5, v4, 4, v5
    buffer_load_dwordx4 v[16:19], v5, s[8:11], s58 offen offset:0
    buffer_load_dwordx4 v[20:23], v5, s[8:11], s58 offen offset:256
    buffer_load_dwordx4 v[24:27], v5, s[8:11], s58 offen offset:512
    buffer_load_dwordx4 v[28:31], v5, s[8:11], s58 offen offset:768
    buffer_load_dwordx4 v[32:35], v5, s[8:11], s58 offen offset:1024
    s_mul_i32 s59, s55, 6400
    s_add_u32 s59, s59, 147456
    v_and_b32_e64 v3, 3, v3
    v_mul_u32_u24 v12, 80, v4
    v_lshl_add_u32 v12, v3, 4, v12
    v_add_u32 v12, s59, v12
    v_lshrrev_b32 v5, 2, v1
    v_and_b32_e64 v7, 3, v1
    v_mul_u32_u24 v13, 80, v5
    v_lshl_add_u32 v13, v7, 4, v13
    v_add_u32 v13, s59, v13
    v_lshrrev_b32 v14, 1, v5
    v_lshlrev_b32 v14, 10, v14
    v_and_b32 v5, 1, v5
    v_lshl_add_u32 v14, v5, 9, v14
    v_lshl_add_u32 v14, v7, 4, v14
    s_lshl_b32 s58, s53, 2
    s_lshr_b32 s59, s54, 2
    s_add_u32 s58, s58, s59
    s_mul_i32 s58, s58, 40960
    s_and_b32 s59, s54, 3
    s_lshl_b32 s59, s59, 7
    s_add_u32 s58, s58, s59
    s_lshl_b32 s59, s55, 6
    s_add_u32 s58, s58, s59
    s_add_u32 s62, s58, 1048576
    s_waitcnt lgkmcnt(0)
    s_add_u32 s52, s90, 0x9e3779b9
    s_waitcnt vmcnt(0)
    v_mov_b32 v5, 160256
    v_mov_b32_e64 v7, s52
    ds_write_b32 v5, v7
    v_lshlrev_b32_e64 v40, 16, v16
    v_and_b32 v41, 0xffff0000, v16
    v_lshlrev_b32_e64 v42, 16, v17
    v_and_b32 v43, 0xffff0000, v17
    v_lshlrev_b32_e64 v44, 16, v18
    v_and_b32 v45, 0xffff0000, v18
    v_lshlrev_b32_e64 v46, 16, v19
    v_and_b32 v47, 0xffff0000, v19
    v_lshlrev_b32_e64 v48, 16, v20
    v_and_b32 v49, 0xffff0000, v20
    v_lshlrev_b32_e64 v50, 16, v21
    v_and_b32 v51, 0xffff0000, v21
    v_lshlrev_b32_e64 v52, 16, v22
    v_and_b32 v53, 0xffff0000, v22
    v_lshlrev_b32_e64 v54, 16, v23
    v_and_b32 v55, 0xffff0000, v23
    v_lshlrev_b32_e64 v56, 16, v24
    v_and_b32 v57, 0xffff0000, v24
    v_lshlrev_b32_e64 v58, 16, v25
    v_and_b32 v59, 0xffff0000, v25
    v_lshlrev_b32_e64 v60, 16, v26
    v_and_b32 v61, 0xffff0000, v26
    v_lshlrev_b32_e64 v62, 16, v27
    v_and_b32 v63, 0xffff0000, v27
    v_lshlrev_b32_e64 v64, 16, v28
    v_and_b32 v65, 0xffff0000, v28
    v_lshlrev_b32_e64 v66, 16, v29
    v_and_b32 v67, 0xffff0000, v29
    v_lshlrev_b32_e64 v68, 16, v30
    v_and_b32 v69, 0xffff0000, v30
    v_lshlrev_b32_e64 v70, 16, v31
    v_and_b32 v71, 0xffff0000, v31
    v_lshlrev_b32_e64 v72, 16, v32
    v_and_b32 v73, 0xffff0000, v32
    v_lshlrev_b32_e64 v74, 16, v33
    v_and_b32 v75, 0xffff0000, v33
    v_lshlrev_b32_e64 v76, 16, v34
    v_and_b32 v77, 0xffff0000, v34
    v_lshlrev_b32_e64 v78, 16, v35
    v_and_b32 v79, 0xffff0000, v35
    v_pk_add_f32 v[6:7], v[40:41], v[42:43]
    v_pk_add_f32 v[8:9], v[44:45], v[46:47]
    v_pk_add_f32 v[6:7], v[6:7], v[48:49]
    v_pk_add_f32 v[8:9], v[8:9], v[50:51]
    v_pk_add_f32 v[6:7], v[6:7], v[52:53]
    v_pk_add_f32 v[8:9], v[8:9], v[54:55]
    v_pk_add_f32 v[6:7], v[6:7], v[56:57]
    v_pk_add_f32 v[8:9], v[8:9], v[58:59]
    v_pk_add_f32 v[6:7], v[6:7], v[60:61]
    v_pk_add_f32 v[8:9], v[8:9], v[62:63]
    v_pk_add_f32 v[6:7], v[6:7], v[64:65]
    v_pk_add_f32 v[8:9], v[8:9], v[66:67]
    v_pk_add_f32 v[6:7], v[6:7], v[68:69]
    v_pk_add_f32 v[8:9], v[8:9], v[70:71]
    v_pk_add_f32 v[6:7], v[6:7], v[72:73]
    v_pk_add_f32 v[8:9], v[8:9], v[74:75]
    v_pk_add_f32 v[6:7], v[6:7], v[76:77]
    v_pk_add_f32 v[8:9], v[8:9], v[78:79]
    v_pk_add_f32 v[6:7], v[6:7], v[8:9]
    v_add_f32 v6, v6, v7
    s_nop 1
    v_add_f32_dpp v6, v6, v6 row_ror:8 row_mask:0xf bank_mask:0xf
    s_nop 1
    v_add_f32_dpp v6, v6, v6 row_ror:4 row_mask:0xf bank_mask:0xf
    s_nop 1
    v_add_f32_dpp v6, v6, v6 row_ror:2 row_mask:0xf bank_mask:0xf
    s_nop 1
    s_nop 0
    v_add_f32_dpp v6, v6, v6 row_ror:1 row_mask:0xf bank_mask:0xf
    v_mul_f32 v6, 0xbacccccd, v6
    v_pk_add_f32 v[40:41], v[40:41], v[6:7] op_sel_hi:[1,0]
    v_pk_add_f32 v[42:43], v[42:43], v[6:7] op_sel_hi:[1,0]
    v_pk_add_f32 v[44:45], v[44:45], v[6:7] op_sel_hi:[1,0]
    v_pk_add_f32 v[46:47], v[46:47], v[6:7] op_sel_hi:[1,0]
    v_pk_add_f32 v[48:49], v[48:49], v[6:7] op_sel_hi:[1,0]
    v_pk_add_f32 v[50:51], v[50:51], v[6:7] op_sel_hi:[1,0]
    v_pk_add_f32 v[52:53], v[52:53], v[6:7] op_sel_hi:[1,0]
    v_pk_add_f32 v[54:55], v[54:55], v[6:7] op_sel_hi:[1,0]
    v_pk_add_f32 v[56:57], v[56:57], v[6:7] op_sel_hi:[1,0]
    v_pk_add_f32 v[58:59], v[58:59], v[6:7] op_sel_hi:[1,0]
    v_pk_add_f32 v[60:61], v[60:61], v[6:7] op_sel_hi:[1,0]
    v_pk_add_f32 v[62:63], v[62:63], v[6:7] op_sel_hi:[1,0]
    v_pk_add_f32 v[64:65], v[64:65], v[6:7] op_sel_hi:[1,0]
    v_pk_add_f32 v[66:67], v[66:67], v[6:7] op_sel_hi:[1,0]
    v_pk_add_f32 v[68:69], v[68:69], v[6:7] op_sel_hi:[1,0]
    v_pk_add_f32 v[70:71], v[70:71], v[6:7] op_sel_hi:[1,0]
    v_pk_add_f32 v[72:73], v[72:73], v[6:7] op_sel_hi:[1,0]
    v_pk_add_f32 v[74:75], v[74:75], v[6:7] op_sel_hi:[1,0]
    v_pk_add_f32 v[76:77], v[76:77], v[6:7] op_sel_hi:[1,0]
    v_pk_add_f32 v[78:79], v[78:79], v[6:7] op_sel_hi:[1,0]
    v_pk_mul_f32 v[8:9], v[40:41], v[40:41]
    v_pk_mul_f32 v[10:11], v[42:43], v[42:43]
    v_pk_fma_f32 v[8:9], v[44:45], v[44:45], v[8:9]
    v_pk_fma_f32 v[10:11], v[46:47], v[46:47], v[10:11]
    v_pk_fma_f32 v[8:9], v[48:49], v[48:49], v[8:9]
    v_pk_fma_f32 v[10:11], v[50:51], v[50:51], v[10:11]
    v_pk_fma_f32 v[8:9], v[52:53], v[52:53], v[8:9]
    v_pk_fma_f32 v[10:11], v[54:55], v[54:55], v[10:11]
    v_pk_fma_f32 v[8:9], v[56:57], v[56:57], v[8:9]
    v_pk_fma_f32 v[10:11], v[58:59], v[58:59], v[10:11]
    v_pk_fma_f32 v[8:9], v[60:61], v[60:61], v[8:9]
    v_pk_fma_f32 v[10:11], v[62:63], v[62:63], v[10:11]
    v_pk_fma_f32 v[8:9], v[64:65], v[64:65], v[8:9]
    v_pk_fma_f32 v[10:11], v[66:67], v[66:67], v[10:11]
    v_pk_fma_f32 v[8:9], v[68:69], v[68:69], v[8:9]
    v_pk_fma_f32 v[10:11], v[70:71], v[70:71], v[10:11]
    v_pk_fma_f32 v[8:9], v[72:73], v[72:73], v[8:9]
    v_pk_fma_f32 v[10:11], v[74:75], v[74:75], v[10:11]
    v_pk_fma_f32 v[8:9], v[76:77], v[76:77], v[8:9]
    v_pk_fma_f32 v[10:11], v[78:79], v[78:79], v[10:11]
    v_pk_add_f32 v[8:9], v[8:9], v[10:11]
    v_add_f32 v8, v8, v9
    s_nop 1
    v_add_f32_dpp v8, v8, v8 row_ror:8 row_mask:0xf bank_mask:0xf
    s_nop 1
    v_add_f32_dpp v8, v8, v8 row_ror:4 row_mask:0xf bank_mask:0xf
    s_nop 1
    v_add_f32_dpp v8, v8, v8 row_ror:2 row_mask:0xf bank_mask:0xf
    s_nop 1
    v_add_f32_dpp v8, v8, v8 row_ror:1 row_mask:0xf bank_mask:0xf
    v_mov_b32 v9, 0x3727c5ac
    v_mov_b32 v10, 0x3acccccd
    v_fma_f32 v8, v8, v10, v9
    v_rsq_f32 v8, v8
    s_nop 0
    s_nop 0
    v_pk_mul_f32 v[40:41], v[40:41], v[8:9] op_sel_hi:[1,0]
    v_pk_mul_f32 v[42:43], v[42:43], v[8:9] op_sel_hi:[1,0]
    v_pk_mul_f32 v[44:45], v[44:45], v[8:9] op_sel_hi:[1,0]
    v_pk_mul_f32 v[46:47], v[46:47], v[8:9] op_sel_hi:[1,0]
    v_cvt_pk_f16_f32 v16, v40, v41
    v_cvt_pk_f16_f32 v17, v42, v43
    v_cvt_pk_f16_f32 v18, v44, v45
    v_cvt_pk_f16_f32 v19, v46, v47
    ds_write_b128 v12, v[16:19] offset:0
    v_pk_mul_f32 v[48:49], v[48:49], v[8:9] op_sel_hi:[1,0]
    v_pk_mul_f32 v[50:51], v[50:51], v[8:9] op_sel_hi:[1,0]
    v_pk_mul_f32 v[52:53], v[52:53], v[8:9] op_sel_hi:[1,0]
    v_pk_mul_f32 v[54:55], v[54:55], v[8:9] op_sel_hi:[1,0]
    v_cvt_pk_f16_f32 v20, v48, v49
    v_cvt_pk_f16_f32 v21, v50, v51
    v_cvt_pk_f16_f32 v22, v52, v53
    v_cvt_pk_f16_f32 v23, v54, v55
    ds_write_b128 v12, v[20:23] offset:1280
    v_pk_mul_f32 v[56:57], v[56:57], v[8:9] op_sel_hi:[1,0]
    v_pk_mul_f32 v[58:59], v[58:59], v[8:9] op_sel_hi:[1,0]
    v_pk_mul_f32 v[60:61], v[60:61], v[8:9] op_sel_hi:[1,0]
    v_pk_mul_f32 v[62:63], v[62:63], v[8:9] op_sel_hi:[1,0]
    v_cvt_pk_f16_f32 v24, v56, v57
    v_cvt_pk_f16_f32 v25, v58, v59
    v_cvt_pk_f16_f32 v26, v60, v61
    v_cvt_pk_f16_f32 v27, v62, v63
    ds_write_b128 v12, v[24:27] offset:2560
    v_pk_mul_f32 v[64:65], v[64:65], v[8:9] op_sel_hi:[1,0]
    v_pk_mul_f32 v[66:67], v[66:67], v[8:9] op_sel_hi:[1,0]
    v_pk_mul_f32 v[68:69], v[68:69], v[8:9] op_sel_hi:[1,0]
    v_pk_mul_f32 v[70:71], v[70:71], v[8:9] op_sel_hi:[1,0]
    v_cvt_pk_f16_f32 v28, v64, v65
    v_cvt_pk_f16_f32 v29, v66, v67
    v_cvt_pk_f16_f32 v30, v68, v69
    v_cvt_pk_f16_f32 v31, v70, v71
    ds_write_b128 v12, v[28:31] offset:3840
    v_pk_mul_f32 v[72:73], v[72:73], v[8:9] op_sel_hi:[1,0]
    v_pk_mul_f32 v[74:75], v[74:75], v[8:9] op_sel_hi:[1,0]
    v_pk_mul_f32 v[76:77], v[76:77], v[8:9] op_sel_hi:[1,0]
    v_pk_mul_f32 v[78:79], v[78:79], v[8:9] op_sel_hi:[1,0]
    v_cvt_pk_f16_f32 v32, v72, v73
    v_cvt_pk_f16_f32 v33, v74, v75
    v_cvt_pk_f16_f32 v34, v76, v77
    v_cvt_pk_f16_f32 v35, v78, v79
    ds_write_b128 v12, v[32:35] offset:5120
    s_waitcnt lgkmcnt(0)
    s_nop 0
    ds_read_b128 v[40:43], v13 offset:0
    ds_read_b128 v[44:47], v13 offset:1280
    ds_read_b128 v[48:51], v13 offset:2560
    ds_read_b128 v[52:55], v13 offset:3840
    ds_read_b128 v[56:59], v13 offset:5120
    s_waitcnt lgkmcnt(4)
    buffer_store_dwordx4 v[40:43], v14, s[36:39], s62 offen sc1
    s_add_u32 s62, s62, 8192
    s_waitcnt lgkmcnt(3)
    buffer_store_dwordx4 v[44:47], v14, s[36:39], s62 offen sc1
    s_add_u32 s62, s62, 8192
    s_waitcnt lgkmcnt(2)
    buffer_store_dwordx4 v[48:51], v14, s[36:39], s62 offen sc1
    s_add_u32 s62, s62, 8192
    s_waitcnt lgkmcnt(1)
    buffer_store_dwordx4 v[52:55], v14, s[36:39], s62 offen sc1
    s_add_u32 s62, s62, 8192
    s_waitcnt lgkmcnt(0)
    buffer_store_dwordx4 v[56:59], v14, s[36:39], s62 offen sc1
    s_lshl_b32 s58, s53, 4
    s_add_u32 s58, s58, s54
    s_lshl_b32 s58, s58, 1
    s_add_u32 s58, s58, s55
    s_waitcnt vmcnt(0)
    s_lshl_b32 s57, s58, 7
    s_add_u32 s57, s57, 4096
    v_mov_b32 v3, s52
    v_mov_b32 v4, 0
    s_mov_b64 exec, 1
    buffer_store_dword v3, v4, s[36:39], s57 offen sc1
    s_nop 1
    s_mov_b64 exec, -1
    s_branch P0J_3
P0G_1:
    s_cmp_ge_u32 s56, 80
    s_cbranch_scc1 GL_4
    s_mul_i32 s61, s56, 3277
    s_lshr_b32 s61, s61, 16
    s_mul_i32 s60, s61, 20
    s_sub_u32 s60, s56, s60
    s_mul_i32 s59, s61, 160
    s_lshl_b32 s62, s59, 1
    s_mul_i32 s63, s59, 7680
    s_lshl_b32 s58, s60, 7
    s_add_u32 s63, s63, s58
    v_lshrrev_b32 v3, 3, v1
    v_and_b32 v4, 7, v1
    v_mul_u32_u24 v5, 7680, v3
    v_lshl_add_u32 v5, v4, 4, v5
    v_lshlrev_b32 v6, 1, v1
    v_min_u32 v7, 31, v1
    v_lshlrev_b32_e64 v7, 1, v7
    buffer_load_ushort v96, v6, s[40:43], s62 offen
    buffer_load_ushort v97, v6, s[40:43], s62 offen offset:128
    buffer_load_ushort v98, v7, s[40:43], s62 offen offset:256
    buffer_load_dwordx4 v[16:19], v5, s[28:31], s63 offen
    s_add_u32 s63, s63, 61440
    buffer_load_dwordx4 v[20:23], v5, s[28:31], s63 offen
    s_add_u32 s63, s63, 61440
    buffer_load_dwordx4 v[24:27], v5, s[28:31], s63 offen
    s_add_u32 s63, s63, 61440
    buffer_load_dwordx4 v[28:31], v5, s[28:31], s63 offen
    s_add_u32 s63, s63, 61440
    buffer_load_dwordx4 v[32:35], v5, s[28:31], s63 offen
    s_add_u32 s63, s63, 61440
    buffer_load_dwordx4 v[36:39], v5, s[28:31], s63 offen
    s_add_u32 s63, s63, 61440
    buffer_load_dwordx4 v[40:43], v5, s[28:31], s63 offen
    s_add_u32 s63, s63, 61440
    buffer_load_dwordx4 v[44:47], v5, s[28:31], s63 offen
    s_add_u32 s63, s63, 61440
    buffer_load_dwordx4 v[48:51], v5, s[28:31], s63 offen
    s_add_u32 s63, s63, 61440
    buffer_load_dwordx4 v[52:55], v5, s[28:31], s63 offen
    s_add_u32 s63, s63, 61440
    buffer_load_dwordx4 v[56:59], v5, s[28:31], s63 offen
    s_add_u32 s63, s63, 61440
    buffer_load_dwordx4 v[60:63], v5, s[28:31], s63 offen
    s_add_u32 s63, s63, 61440
    buffer_load_dwordx4 v[64:67], v5, s[28:31], s63 offen
    s_add_u32 s63, s63, 61440
    buffer_load_dwordx4 v[68:71], v5, s[28:31], s63 offen
    s_add_u32 s63, s63, 61440
    buffer_load_dwordx4 v[72:75], v5, s[28:31], s63 offen
    s_add_u32 s63, s63, 61440
    buffer_load_dwordx4 v[76:79], v5, s[28:31], s63 offen
    s_add_u32 s63, s63, 61440
    buffer_load_dwordx4 v[80:83], v5, s[28:31], s63 offen
    s_add_u32 s63, s63, 61440
    buffer_load_dwordx4 v[84:87], v5, s[28:31], s63 offen
    s_add_u32 s63, s63, 61440
    buffer_load_dwordx4 v[88:91], v5, s[28:31], s63 offen
    s_add_u32 s63, s63, 61440
    buffer_load_dwordx4 v[92:95], v5, s[28:31], s63 offen
    s_waitcnt vmcnt(22)
    v_lshlrev_b32 v96, 16, v96
    s_waitcnt vmcnt(21)
    v_lshlrev_b32 v97, 16, v97
    s_waitcnt vmcnt(20)
    v_lshlrev_b32 v98, 16, v98
    v_mul_f32 v160, 0xbfb8aa3b, v96
    v_mul_f32 v161, 0xbfb8aa3b, v97
    v_mul_f32 v162, 0xbfb8aa3b, v98
    v_exp_f32 v160, v160
    v_exp_f32 v161, v161
    v_exp_f32 v162, v162
    v_add_f32 v160, 1.0, v160
    v_add_f32 v161, 1.0, v161
    v_add_f32 v162, 1.0, v162
    v_rcp_f32 v160, v160
    v_rcp_f32 v161, v161
    v_rcp_f32 v162, v162
    v_mul_f32 v160, v96, v160
    v_mul_f32 v161, v97, v161
    v_mul_f32 v162, v98, v162
    v_cvt_pk_bf16_f32 v160, v160, v160
    v_cvt_pk_bf16_f32 v161, v161, v161
    v_cvt_pk_bf16_f32 v162, v162, v162
    v_lshlrev_b32 v160, 16, v160
    v_lshlrev_b32 v161, 16, v161
    v_lshlrev_b32 v162, 16, v162
    v_lshlrev_b32 v6, 2, v1
    v_add_u32 v6, 160320, v6
    v_lshlrev_b32_e64 v7, 1, v7
    v_add_u32 v7, 160832, v7
    ds_write_b32 v6, v160
    ds_write_b32 v6, v161 offset:256
    ds_write_b32 v7, v162
    v_lshlrev_b32_e64 v6, 2, v3
    v_add_u32 v6, 160320, v6
    s_waitcnt lgkmcnt(0)
    s_nop 0
    ds_read_b32 v116, v6 offset:0
    ds_read_b32 v118, v6 offset:32
    ds_read_b32 v120, v6 offset:64
    ds_read_b32 v122, v6 offset:96
    ds_read_b32 v124, v6 offset:128
    ds_read_b32 v126, v6 offset:160
    ds_read_b32 v128, v6 offset:192
    ds_read_b32 v130, v6 offset:224
    ds_read_b32 v132, v6 offset:256
    ds_read_b32 v134, v6 offset:288
    ds_read_b32 v136, v6 offset:320
    ds_read_b32 v138, v6 offset:352
    ds_read_b32 v140, v6 offset:384
    ds_read_b32 v142, v6 offset:416
    ds_read_b32 v144, v6 offset:448
    s_waitcnt lgkmcnt(14)
    ds_read_b32 v146, v6 offset:480
    s_waitcnt lgkmcnt(14)
    ds_read_b32 v148, v6 offset:512
    s_waitcnt lgkmcnt(14)
    ds_read_b32 v150, v6 offset:544
    s_waitcnt lgkmcnt(14)
    ds_read_b32 v152, v6 offset:576
    s_waitcnt lgkmcnt(14)
    ds_read_b32 v154, v6 offset:608
    s_waitcnt vmcnt(0)
    v_lshlrev_b32_e64 v172, 16, v16
    v_and_b32 v173, 0xffff0000, v16
    v_pk_mul_f32 v[8:9], v[172:173], v[116:117] op_sel_hi:[1,0]
    v_lshlrev_b32_e64 v174, 16, v17
    v_and_b32 v175, 0xffff0000, v17
    v_pk_mul_f32 v[10:11], v[174:175], v[116:117] op_sel_hi:[1,0]
    v_lshlrev_b32_e64 v172, 16, v18
    v_and_b32 v173, 0xffff0000, v18
    v_pk_mul_f32 v[12:13], v[172:173], v[116:117] op_sel_hi:[1,0]
    v_lshlrev_b32_e64 v174, 16, v19
    v_and_b32 v175, 0xffff0000, v19
    v_pk_mul_f32 v[14:15], v[174:175], v[116:117] op_sel_hi:[1,0]
    v_lshlrev_b32_e64 v176, 16, v20
    v_and_b32 v177, 0xffff0000, v20
    v_pk_fma_f32 v[8:9], v[176:177], v[118:119], v[8:9] op_sel_hi:[1,0,1]
    v_lshlrev_b32_e64 v178, 16, v21
    v_and_b32 v179, 0xffff0000, v21
    v_pk_fma_f32 v[10:11], v[178:179], v[118:119], v[10:11] op_sel_hi:[1,0,1]
    v_lshlrev_b32_e64 v176, 16, v22
    v_and_b32 v177, 0xffff0000, v22
    v_pk_fma_f32 v[12:13], v[176:177], v[118:119], v[12:13] op_sel_hi:[1,0,1]
    v_lshlrev_b32_e64 v178, 16, v23
    v_and_b32 v179, 0xffff0000, v23
    v_pk_fma_f32 v[14:15], v[178:179], v[118:119], v[14:15] op_sel_hi:[1,0,1]
    v_lshlrev_b32_e64 v172, 16, v24
    v_and_b32 v173, 0xffff0000, v24
    v_pk_fma_f32 v[8:9], v[172:173], v[120:121], v[8:9] op_sel_hi:[1,0,1]
    v_lshlrev_b32_e64 v174, 16, v25
    v_and_b32 v175, 0xffff0000, v25
    v_pk_fma_f32 v[10:11], v[174:175], v[120:121], v[10:11] op_sel_hi:[1,0,1]
    v_lshlrev_b32_e64 v172, 16, v26
    v_and_b32 v173, 0xffff0000, v26
    v_pk_fma_f32 v[12:13], v[172:173], v[120:121], v[12:13] op_sel_hi:[1,0,1]
    v_lshlrev_b32_e64 v174, 16, v27
    v_and_b32 v175, 0xffff0000, v27
    v_pk_fma_f32 v[14:15], v[174:175], v[120:121], v[14:15] op_sel_hi:[1,0,1]
    v_lshlrev_b32_e64 v176, 16, v28
    v_and_b32 v177, 0xffff0000, v28
    v_pk_fma_f32 v[8:9], v[176:177], v[122:123], v[8:9] op_sel_hi:[1,0,1]
    v_lshlrev_b32_e64 v178, 16, v29
    v_and_b32 v179, 0xffff0000, v29
    v_pk_fma_f32 v[10:11], v[178:179], v[122:123], v[10:11] op_sel_hi:[1,0,1]
    v_lshlrev_b32_e64 v176, 16, v30
    v_and_b32 v177, 0xffff0000, v30
    v_pk_fma_f32 v[12:13], v[176:177], v[122:123], v[12:13] op_sel_hi:[1,0,1]
    v_lshlrev_b32_e64 v178, 16, v31
    v_and_b32 v179, 0xffff0000, v31
    v_pk_fma_f32 v[14:15], v[178:179], v[122:123], v[14:15] op_sel_hi:[1,0,1]
    v_lshlrev_b32_e64 v172, 16, v32
    v_and_b32 v173, 0xffff0000, v32
    v_pk_fma_f32 v[8:9], v[172:173], v[124:125], v[8:9] op_sel_hi:[1,0,1]
    v_lshlrev_b32_e64 v174, 16, v33
    v_and_b32 v175, 0xffff0000, v33
    v_pk_fma_f32 v[10:11], v[174:175], v[124:125], v[10:11] op_sel_hi:[1,0,1]
    v_lshlrev_b32_e64 v172, 16, v34
    v_and_b32 v173, 0xffff0000, v34
    v_pk_fma_f32 v[12:13], v[172:173], v[124:125], v[12:13] op_sel_hi:[1,0,1]
    v_lshlrev_b32_e64 v174, 16, v35
    v_and_b32 v175, 0xffff0000, v35
    v_pk_fma_f32 v[14:15], v[174:175], v[124:125], v[14:15] op_sel_hi:[1,0,1]
    v_lshlrev_b32_e64 v176, 16, v36
    v_and_b32 v177, 0xffff0000, v36
    s_waitcnt lgkmcnt(14)
    v_pk_fma_f32 v[8:9], v[176:177], v[126:127], v[8:9] op_sel_hi:[1,0,1]
    v_lshlrev_b32 v178, 16, v37
    v_and_b32 v179, 0xffff0000, v37
    v_pk_fma_f32 v[10:11], v[178:179], v[126:127], v[10:11] op_sel_hi:[1,0,1]
    v_lshlrev_b32_e64 v176, 16, v38
    v_and_b32 v177, 0xffff0000, v38
    v_pk_fma_f32 v[12:13], v[176:177], v[126:127], v[12:13] op_sel_hi:[1,0,1]
    v_lshlrev_b32_e64 v178, 16, v39
    v_and_b32 v179, 0xffff0000, v39
    v_pk_fma_f32 v[14:15], v[178:179], v[126:127], v[14:15] op_sel_hi:[1,0,1]
    v_lshlrev_b32_e64 v172, 16, v40
    v_and_b32 v173, 0xffff0000, v40
    s_waitcnt lgkmcnt(13)
    v_pk_fma_f32 v[8:9], v[172:173], v[128:129], v[8:9] op_sel_hi:[1,0,1]
    v_lshlrev_b32 v174, 16, v41
    v_and_b32 v175, 0xffff0000, v41
    v_pk_fma_f32 v[10:11], v[174:175], v[128:129], v[10:11] op_sel_hi:[1,0,1]
    v_lshlrev_b32_e64 v172, 16, v42
    v_and_b32 v173, 0xffff0000, v42
    v_pk_fma_f32 v[12:13], v[172:173], v[128:129], v[12:13] op_sel_hi:[1,0,1]
    v_lshlrev_b32_e64 v174, 16, v43
    v_and_b32 v175, 0xffff0000, v43
    v_pk_fma_f32 v[14:15], v[174:175], v[128:129], v[14:15] op_sel_hi:[1,0,1]
    v_lshlrev_b32_e64 v176, 16, v44
    v_and_b32 v177, 0xffff0000, v44
    s_waitcnt lgkmcnt(12)
    v_pk_fma_f32 v[8:9], v[176:177], v[130:131], v[8:9] op_sel_hi:[1,0,1]
    v_lshlrev_b32 v178, 16, v45
    v_and_b32 v179, 0xffff0000, v45
    v_pk_fma_f32 v[10:11], v[178:179], v[130:131], v[10:11] op_sel_hi:[1,0,1]
    v_lshlrev_b32_e64 v176, 16, v46
    v_and_b32 v177, 0xffff0000, v46
    v_pk_fma_f32 v[12:13], v[176:177], v[130:131], v[12:13] op_sel_hi:[1,0,1]
    v_lshlrev_b32_e64 v178, 16, v47
    v_and_b32 v179, 0xffff0000, v47
    v_pk_fma_f32 v[14:15], v[178:179], v[130:131], v[14:15] op_sel_hi:[1,0,1]
    v_lshlrev_b32_e64 v172, 16, v48
    v_and_b32 v173, 0xffff0000, v48
    s_waitcnt lgkmcnt(11)
    v_pk_fma_f32 v[8:9], v[172:173], v[132:133], v[8:9] op_sel_hi:[1,0,1]
    v_lshlrev_b32 v174, 16, v49
    v_and_b32 v175, 0xffff0000, v49
    v_pk_fma_f32 v[10:11], v[174:175], v[132:133], v[10:11] op_sel_hi:[1,0,1]
    v_lshlrev_b32_e64 v172, 16, v50
    v_and_b32 v173, 0xffff0000, v50
    v_pk_fma_f32 v[12:13], v[172:173], v[132:133], v[12:13] op_sel_hi:[1,0,1]
    v_lshlrev_b32_e64 v174, 16, v51
    v_and_b32 v175, 0xffff0000, v51
    v_pk_fma_f32 v[14:15], v[174:175], v[132:133], v[14:15] op_sel_hi:[1,0,1]
    v_lshlrev_b32_e64 v176, 16, v52
    v_and_b32 v177, 0xffff0000, v52
    s_waitcnt lgkmcnt(10)
    v_pk_fma_f32 v[8:9], v[176:177], v[134:135], v[8:9] op_sel_hi:[1,0,1]
    v_lshlrev_b32 v178, 16, v53
    v_and_b32 v179, 0xffff0000, v53
    v_pk_fma_f32 v[10:11], v[178:179], v[134:135], v[10:11] op_sel_hi:[1,0,1]
    v_lshlrev_b32_e64 v176, 16, v54
    v_and_b32 v177, 0xffff0000, v54
    v_pk_fma_f32 v[12:13], v[176:177], v[134:135], v[12:13] op_sel_hi:[1,0,1]
    v_lshlrev_b32_e64 v178, 16, v55
    v_and_b32 v179, 0xffff0000, v55
    v_pk_fma_f32 v[14:15], v[178:179], v[134:135], v[14:15] op_sel_hi:[1,0,1]
    v_lshlrev_b32_e64 v172, 16, v56
    v_and_b32 v173, 0xffff0000, v56
    s_waitcnt lgkmcnt(9)
    v_pk_fma_f32 v[8:9], v[172:173], v[136:137], v[8:9] op_sel_hi:[1,0,1]
    v_lshlrev_b32 v174, 16, v57
    v_and_b32 v175, 0xffff0000, v57
    v_pk_fma_f32 v[10:11], v[174:175], v[136:137], v[10:11] op_sel_hi:[1,0,1]
    v_lshlrev_b32_e64 v172, 16, v58
    v_and_b32 v173, 0xffff0000, v58
    v_pk_fma_f32 v[12:13], v[172:173], v[136:137], v[12:13] op_sel_hi:[1,0,1]
    v_lshlrev_b32_e64 v174, 16, v59
    v_and_b32 v175, 0xffff0000, v59
    v_pk_fma_f32 v[14:15], v[174:175], v[136:137], v[14:15] op_sel_hi:[1,0,1]
    v_lshlrev_b32_e64 v176, 16, v60
    v_and_b32 v177, 0xffff0000, v60
    s_waitcnt lgkmcnt(8)
    v_pk_fma_f32 v[8:9], v[176:177], v[138:139], v[8:9] op_sel_hi:[1,0,1]
    v_lshlrev_b32 v178, 16, v61
    v_and_b32 v179, 0xffff0000, v61
    v_pk_fma_f32 v[10:11], v[178:179], v[138:139], v[10:11] op_sel_hi:[1,0,1]
    v_lshlrev_b32_e64 v176, 16, v62
    v_and_b32 v177, 0xffff0000, v62
    v_pk_fma_f32 v[12:13], v[176:177], v[138:139], v[12:13] op_sel_hi:[1,0,1]
    v_lshlrev_b32_e64 v178, 16, v63
    v_and_b32 v179, 0xffff0000, v63
    v_pk_fma_f32 v[14:15], v[178:179], v[138:139], v[14:15] op_sel_hi:[1,0,1]
    v_lshlrev_b32_e64 v172, 16, v64
    v_and_b32 v173, 0xffff0000, v64
    s_waitcnt lgkmcnt(7)
    v_pk_fma_f32 v[8:9], v[172:173], v[140:141], v[8:9] op_sel_hi:[1,0,1]
    v_lshlrev_b32 v174, 16, v65
    v_and_b32 v175, 0xffff0000, v65
    v_pk_fma_f32 v[10:11], v[174:175], v[140:141], v[10:11] op_sel_hi:[1,0,1]
    v_lshlrev_b32_e64 v172, 16, v66
    v_and_b32 v173, 0xffff0000, v66
    v_pk_fma_f32 v[12:13], v[172:173], v[140:141], v[12:13] op_sel_hi:[1,0,1]
    v_lshlrev_b32_e64 v174, 16, v67
    v_and_b32 v175, 0xffff0000, v67
    v_pk_fma_f32 v[14:15], v[174:175], v[140:141], v[14:15] op_sel_hi:[1,0,1]
    v_lshlrev_b32_e64 v176, 16, v68
    v_and_b32 v177, 0xffff0000, v68
    s_waitcnt lgkmcnt(6)
    v_pk_fma_f32 v[8:9], v[176:177], v[142:143], v[8:9] op_sel_hi:[1,0,1]
    v_lshlrev_b32 v178, 16, v69
    v_and_b32 v179, 0xffff0000, v69
    v_pk_fma_f32 v[10:11], v[178:179], v[142:143], v[10:11] op_sel_hi:[1,0,1]
    v_lshlrev_b32_e64 v176, 16, v70
    v_and_b32 v177, 0xffff0000, v70
    v_pk_fma_f32 v[12:13], v[176:177], v[142:143], v[12:13] op_sel_hi:[1,0,1]
    v_lshlrev_b32_e64 v178, 16, v71
    v_and_b32 v179, 0xffff0000, v71
    v_pk_fma_f32 v[14:15], v[178:179], v[142:143], v[14:15] op_sel_hi:[1,0,1]
    v_lshlrev_b32_e64 v172, 16, v72
    v_and_b32 v173, 0xffff0000, v72
    s_waitcnt lgkmcnt(5)
    v_pk_fma_f32 v[8:9], v[172:173], v[144:145], v[8:9] op_sel_hi:[1,0,1]
    v_lshlrev_b32 v174, 16, v73
    v_and_b32 v175, 0xffff0000, v73
    v_pk_fma_f32 v[10:11], v[174:175], v[144:145], v[10:11] op_sel_hi:[1,0,1]
    v_lshlrev_b32_e64 v172, 16, v74
    v_and_b32 v173, 0xffff0000, v74
    v_pk_fma_f32 v[12:13], v[172:173], v[144:145], v[12:13] op_sel_hi:[1,0,1]
    v_lshlrev_b32_e64 v174, 16, v75
    v_and_b32 v175, 0xffff0000, v75
    v_pk_fma_f32 v[14:15], v[174:175], v[144:145], v[14:15] op_sel_hi:[1,0,1]
    v_lshlrev_b32_e64 v176, 16, v76
    v_and_b32 v177, 0xffff0000, v76
    s_waitcnt lgkmcnt(4)
    v_pk_fma_f32 v[8:9], v[176:177], v[146:147], v[8:9] op_sel_hi:[1,0,1]
    v_lshlrev_b32 v178, 16, v77
    v_and_b32 v179, 0xffff0000, v77
    v_pk_fma_f32 v[10:11], v[178:179], v[146:147], v[10:11] op_sel_hi:[1,0,1]
    v_lshlrev_b32_e64 v176, 16, v78
    v_and_b32 v177, 0xffff0000, v78
    v_pk_fma_f32 v[12:13], v[176:177], v[146:147], v[12:13] op_sel_hi:[1,0,1]
    v_lshlrev_b32_e64 v178, 16, v79
    v_and_b32 v179, 0xffff0000, v79
    v_pk_fma_f32 v[14:15], v[178:179], v[146:147], v[14:15] op_sel_hi:[1,0,1]
    v_lshlrev_b32_e64 v172, 16, v80
    v_and_b32 v173, 0xffff0000, v80
    s_waitcnt lgkmcnt(3)
    v_pk_fma_f32 v[8:9], v[172:173], v[148:149], v[8:9] op_sel_hi:[1,0,1]
    v_lshlrev_b32 v174, 16, v81
    v_and_b32 v175, 0xffff0000, v81
    v_pk_fma_f32 v[10:11], v[174:175], v[148:149], v[10:11] op_sel_hi:[1,0,1]
    v_lshlrev_b32_e64 v172, 16, v82
    v_and_b32 v173, 0xffff0000, v82
    v_pk_fma_f32 v[12:13], v[172:173], v[148:149], v[12:13] op_sel_hi:[1,0,1]
    v_lshlrev_b32_e64 v174, 16, v83
    v_and_b32 v175, 0xffff0000, v83
    v_pk_fma_f32 v[14:15], v[174:175], v[148:149], v[14:15] op_sel_hi:[1,0,1]
    v_lshlrev_b32_e64 v176, 16, v84
    v_and_b32 v177, 0xffff0000, v84
    s_waitcnt lgkmcnt(2)
    v_pk_fma_f32 v[8:9], v[176:177], v[150:151], v[8:9] op_sel_hi:[1,0,1]
    v_lshlrev_b32 v178, 16, v85
    v_and_b32 v179, 0xffff0000, v85
    v_pk_fma_f32 v[10:11], v[178:179], v[150:151], v[10:11] op_sel_hi:[1,0,1]
    v_lshlrev_b32_e64 v176, 16, v86
    v_and_b32 v177, 0xffff0000, v86
    v_pk_fma_f32 v[12:13], v[176:177], v[150:151], v[12:13] op_sel_hi:[1,0,1]
    v_lshlrev_b32_e64 v178, 16, v87
    v_and_b32 v179, 0xffff0000, v87
    v_pk_fma_f32 v[14:15], v[178:179], v[150:151], v[14:15] op_sel_hi:[1,0,1]
    v_lshlrev_b32_e64 v172, 16, v88
    v_and_b32 v173, 0xffff0000, v88
    s_waitcnt lgkmcnt(1)
    v_pk_fma_f32 v[8:9], v[172:173], v[152:153], v[8:9] op_sel_hi:[1,0,1]
    v_lshlrev_b32 v174, 16, v89
    v_and_b32 v175, 0xffff0000, v89
    v_pk_fma_f32 v[10:11], v[174:175], v[152:153], v[10:11] op_sel_hi:[1,0,1]
    v_lshlrev_b32_e64 v172, 16, v90
    v_and_b32 v173, 0xffff0000, v90
    v_pk_fma_f32 v[12:13], v[172:173], v[152:153], v[12:13] op_sel_hi:[1,0,1]
    v_lshlrev_b32_e64 v174, 16, v91
    v_and_b32 v175, 0xffff0000, v91
    v_pk_fma_f32 v[14:15], v[174:175], v[152:153], v[14:15] op_sel_hi:[1,0,1]
    v_lshlrev_b32_e64 v176, 16, v92
    v_and_b32 v177, 0xffff0000, v92
    s_waitcnt lgkmcnt(0)
    v_pk_fma_f32 v[8:9], v[176:177], v[154:155], v[8:9] op_sel_hi:[1,0,1]
    v_lshlrev_b32 v178, 16, v93
    v_and_b32 v179, 0xffff0000, v93
    v_pk_fma_f32 v[10:11], v[178:179], v[154:155], v[10:11] op_sel_hi:[1,0,1]
    v_lshlrev_b32_e64 v176, 16, v94
    v_and_b32 v177, 0xffff0000, v94
    v_pk_fma_f32 v[12:13], v[176:177], v[154:155], v[12:13] op_sel_hi:[1,0,1]
    v_lshlrev_b32_e64 v178, 16, v95
    v_and_b32 v179, 0xffff0000, v95
    v_pk_fma_f32 v[14:15], v[178:179], v[154:155], v[14:15] op_sel_hi:[1,0,1]
    v_add_f32_dpp v8, v8, v8 row_ror:8 row_mask:0xf bank_mask:0xf
    v_add_f32_dpp v9, v9, v9 row_ror:8 row_mask:0xf bank_mask:0xf
    v_add_f32_dpp v10, v10, v10 row_ror:8 row_mask:0xf bank_mask:0xf
    v_add_f32_dpp v11, v11, v11 row_ror:8 row_mask:0xf bank_mask:0xf
    v_add_f32_dpp v12, v12, v12 row_ror:8 row_mask:0xf bank_mask:0xf
    v_add_f32_dpp v13, v13, v13 row_ror:8 row_mask:0xf bank_mask:0xf
    v_add_f32_dpp v14, v14, v14 row_ror:8 row_mask:0xf bank_mask:0xf
    v_add_f32_dpp v15, v15, v15 row_ror:8 row_mask:0xf bank_mask:0xf
    v_mov_b32 v20, v8
    v_mov_b32 v21, v9
    v_mov_b32 v22, v10
    v_mov_b32 v23, v11
    v_mov_b32 v24, v12
    v_mov_b32 v25, v13
    v_mov_b32 v26, v14
    v_mov_b32 v27, v15
    v_permlane16_swap_b32 v8, v20
    v_permlane16_swap_b32 v9, v21
    v_permlane16_swap_b32 v10, v22
    v_permlane16_swap_b32 v11, v23
    v_permlane16_swap_b32 v12, v24
    v_permlane16_swap_b32 v13, v25
    v_permlane16_swap_b32 v14, v26
    v_permlane16_swap_b32 v15, v27
    v_add_f32 v8, v8, v20
    v_add_f32 v9, v9, v21
    v_add_f32 v10, v10, v22
    v_add_f32 v11, v11, v23
    v_add_f32 v12, v12, v24
    v_add_f32 v13, v13, v25
    v_add_f32 v14, v14, v26
    v_add_f32 v15, v15, v27
    v_mov_b32 v20, v8
    v_mov_b32 v21, v9
    v_mov_b32 v22, v10
    v_mov_b32 v23, v11
    v_mov_b32 v24, v12
    v_mov_b32 v25, v13
    v_mov_b32 v26, v14
    v_mov_b32 v27, v15
    v_permlane32_swap_b32 v8, v20
    v_permlane32_swap_b32 v9, v21
    v_permlane32_swap_b32 v10, v22
    v_permlane32_swap_b32 v11, v23
    v_permlane32_swap_b32 v12, v24
    v_permlane32_swap_b32 v13, v25
    v_permlane32_swap_b32 v14, v26
    v_permlane32_swap_b32 v15, v27
    v_add_f32 v8, v8, v20
    v_add_f32 v9, v9, v21
    v_add_f32 v10, v10, v22
    v_add_f32 v11, v11, v23
    v_add_f32 v12, v12, v24
    v_add_f32 v13, v13, v25
    v_add_f32 v14, v14, v26
    v_add_f32 v15, v15, v27
    s_mul_i32 s58, s61, 15360
    s_lshl_b32 s59, s60, 8
    s_add_u32 s58, s58, s59
    s_add_u32 s58, s58, 262144
    v_lshlrev_b32_e64 v6, 5, v4
    v_mov_b32 v7, 0xf0000000
    v_cmp_gt_u32 vcc, 8, v1
    s_nop 1
    v_cndmask_b32_e64 v6, v7, v6, vcc
    buffer_store_dwordx4 v[8:11], v6, s[36:39], s58 offen sc1
    buffer_store_dwordx4 v[12:15], v6, s[36:39], s58 offen offset:16 sc1
    s_waitcnt lgkmcnt(0)
    s_add_u32 s52, s90, 0x9e3779b9
    s_waitcnt vmcnt(0)
    s_lshl_b32 s57, s56, 7
    s_add_u32 s57, s57, 69632
    v_mov_b32 v3, s52
    v_mov_b32 v4, 0
    s_mov_b64 exec, 1
    buffer_store_dword v3, v4, s[36:39], s57 offen sc1
    s_nop 1
    s_mov_b64 exec, -1
    s_branch P0J_3
GL_4:
    s_waitcnt lgkmcnt(0)
    s_add_u32 s52, s90, 0x9e3779b9
    v_mov_b32 v5, 160256
    s_mov_b32 s57, 0
SIGL_5:
    ds_read_b32 v7, v5
    s_waitcnt lgkmcnt(0)
    v_cmp_ne_u32 vcc, s52, v7
    s_add_u32 s57, s57, 1
    s_cmp_gt_u32 s57, 400000
    s_cbranch_scc1 SIGD_6
    s_cbranch_vccnz SIGL_5
SIGD_6:
    s_sub_u32 s58, s56, 80
    v_lshlrev_b32_e64 v10, 7, v1
    s_mul_i32 s59, s58, 4736
    v_mov_b32 v12, 0xf0000000
    v_cmp_gt_u32 vcc, 37, v1
    s_nop 1
    v_cndmask_b32_e64 v11, v12, v10, vcc
    buffer_load_dword a244, v11, s[16:19], s59 offen offset:0
    s_add_u32 s59, s59, 8192
    s_mul_i32 s59, s58, 11264
    v_mov_b32 v12, 0xf0000000
    v_cmp_gt_u32 vcc, 64, v1
    s_nop 1
    v_cndmask_b32_e64 v11, v12, v10, vcc
    buffer_load_dword a244, v11, s[20:23], s59 offen offset:0
    s_add_u32 s59, s59, 8192
    v_mov_b32 v12, 0xf0000000
    v_cmp_gt_u32 vcc, 24, v1
    s_nop 1
    v_cndmask_b32_e64 v11, v12, v10, vcc
    buffer_load_dword a244, v11, s[20:23], s59 offen offset:0
    s_add_u32 s59, s59, 8192
    s_mul_i32 s59, s58, 11264
    v_mov_b32 v12, 0xf0000000
    v_cmp_gt_u32 vcc, 64, v1
    s_nop 1
    v_cndmask_b32_e64 v11, v12, v10, vcc
    buffer_load_dword a244, v11, s[24:27], s59 offen offset:0
    s_add_u32 s59, s59, 8192
    v_mov_b32 v12, 0xf0000000
    v_cmp_gt_u32 vcc, 24, v1
    s_nop 1
    v_cndmask_b32_e64 v11, v12, v10, vcc
    buffer_load_dword a244, v11, s[24:27], s59 offen offset:0
    s_add_u32 s59, s59, 8192
    s_mul_i32 s59, s58, 146
    s_add_u32 s59, s59, 0
    v_add_u32 v8, s59, v1
    v_mul_u32_u24 v9, 52429, v8
    v_lshrrev_b32 v9, 21, v9
    v_mul_u32_u24 v11, 40, v9
    v_sub_u32 v11, v8, v11
    v_lshlrev_b32 v11, 7, v11
    v_mul_u32_u24 v9, 7680, v9
    v_add_u32_e64 v11, v11, v9
    v_add_u32 v11, 2560, v11
    v_mov_b32 v12, 0xf0000000
    v_cmp_gt_u32 vcc, 64, v1
    s_nop 1
    v_cndmask_b32_e64 v11, v12, v11, vcc
    buffer_load_dword a244, v11, s[28:31], 0 offen
    s_mul_i32 s59, s58, 146
    s_add_u32 s59, s59, 64
    v_add_u32 v8, s59, v1
    v_mul_u32_u24 v9, 52429, v8
    v_lshrrev_b32 v9, 21, v9
    v_mul_u32_u24 v11, 40, v9
    v_sub_u32 v11, v8, v11
    v_lshlrev_b32 v11, 7, v11
    v_mul_u32_u24 v9, 7680, v9
    v_add_u32_e64 v11, v11, v9
    v_add_u32 v11, 2560, v11
    v_mov_b32 v12, 0xf0000000
    v_cmp_gt_u32 vcc, 64, v1
    s_nop 1
    v_cndmask_b32_e64 v11, v12, v11, vcc
    buffer_load_dword a244, v11, s[28:31], 0 offen
    s_mul_i32 s59, s58, 146
    s_add_u32 s59, s59, 128
    v_add_u32_e64 v8, s59, v1
    v_mul_u32_u24 v9, 52429, v8
    v_lshrrev_b32 v9, 21, v9
    v_mul_u32_u24 v11, 40, v9
    v_sub_u32 v11, v8, v11
    v_lshlrev_b32 v11, 7, v11
    v_mul_u32_u24 v9, 7680, v9
    v_add_u32_e64 v11, v11, v9
    v_add_u32 v11, 2560, v11
    v_mov_b32 v12, 0xf0000000
    v_cmp_gt_u32 vcc, 18, v1
    s_nop 1
    v_cndmask_b32_e64 v11, v12, v11, vcc
    buffer_load_dword a244, v11, s[28:31], 0 offen
    s_branch P0J_3
P0DM_2:
    s_mul_i32 s58, s56, 9600
    v_lshlrev_b32 v10, 7, v1
    v_add_u32 v11, 8192, v10
    v_mov_b32 v12, 0xf0000000
    v_cmp_gt_u32 vcc, 11, v1
    s_nop 1
    v_cndmask_b32_e64 v11, v12, v11, vcc
    buffer_load_dword a246, v10, s[12:15], s58 offen
    buffer_load_dword a247, v11, s[12:15], s58 offen
    s_getpc_b64 s[92:93]
PCH_7:
    s_lshr_b32 s57, s56, 3
    s_lshl_b32 s57, s57, 11
    v_add_u32 v10, s57, v2
    v_add_u32 v11, 1024, v10
    v_min_u32 v10, L_CODE_END-PCH_7-16, v10
    v_min_u32 v11, L_CODE_END-PCH_7-16, v11
    global_load_dwordx4 a[248:251], v10, s[92:93]
    global_load_dwordx4 a[252:255], v11, s[92:93]
    s_waitcnt lgkmcnt(0)
    s_add_u32 s52, s90, 0x9e3779b9
    s_lshl_b32 s96, s54, 8
    s_cmp_eq_u32 s54, 15
    s_cbranch_scc1 P0J_3
    v_lshrrev_b32 v3, 4, v1
    v_lshlrev_b32 v4, 2, v3
    v_sub_u32 v4, v1, v4
    v_and_b32 v4, 15, v4
    v_mul_u32_u24 v15, 3840, v3
    v_lshl_add_u32 v15, v4, 4, v15
    s_and_b32 s58, s53, 1
    s_add_u32 s58, s58, 256
    s_mul_i32 s58, s58, 3840
    s_add_u32 s58, s58, s96
    v_lshrrev_b32_e64 v10, 1, v1
    v_mul_u32_u24 v10, 7680, v10
    v_and_b32_e64 v11, 1, v1
    v_lshl_add_u32 v10, v11, 7, v10
    v_mov_b32 v5, 160256
    s_mov_b32 s57, 0
SIGL_8:
    ds_read_b32 v7, v5
    s_waitcnt lgkmcnt(0)
    v_cmp_ne_u32 vcc, s52, v7
    s_add_u32 s57, s57, 1
    s_cmp_gt_u32 s57, 400000
    s_cbranch_scc1 SIGD_9
    s_cbranch_vccnz SIGL_8
SIGD_9:
    s_mov_b32 m0, 0
    s_add_u32 s57, s96, 0
    buffer_load_dwordx4 v15, s[12:15], s57 offen lds
    s_mov_b32 m0, 1024
    s_add_u32 s57, s96, 15360
    buffer_load_dwordx4 v15, s[12:15], s57 offen lds
    s_mov_b32 m0, 2048
    s_add_u32 s57, s96, 30720
    buffer_load_dwordx4 v15, s[12:15], s57 offen lds
    s_mov_b32 m0, 3072
    s_add_u32 s57, s96, 46080
    buffer_load_dwordx4 v15, s[12:15], s57 offen lds
    s_mov_b32 m0, 4096
    s_add_u32 s57, s96, 61440
    buffer_load_dwordx4 v15, s[12:15], s57 offen lds
    s_mov_b32 m0, 5120
    s_add_u32 s57, s96, 76800
    buffer_load_dwordx4 v15, s[12:15], s57 offen lds
    s_mov_b32 m0, 6144
    s_add_u32 s57, s96, 92160
    buffer_load_dwordx4 v15, s[12:15], s57 offen lds
    s_mov_b32 m0, 7168
    s_add_u32 s57, s96, 107520
    buffer_load_dwordx4 v15, s[12:15], s57 offen lds
    s_mov_b32 m0, 8192
    s_add_u32 s57, s96, 122880
    buffer_load_dwordx4 v15, s[12:15], s57 offen lds
    s_mov_b32 m0, 9216
    s_add_u32 s57, s96, 138240
    buffer_load_dwordx4 v15, s[12:15], s57 offen lds
    s_mov_b32 m0, 10240
    s_add_u32 s57, s96, 153600
    buffer_load_dwordx4 v15, s[12:15], s57 offen lds
    s_mov_b32 m0, 11264
    s_add_u32 s57, s96, 168960
    buffer_load_dwordx4 v15, s[12:15], s57 offen lds
    s_mov_b32 m0, 12288
    s_add_u32 s57, s96, 184320
    buffer_load_dwordx4 v15, s[12:15], s57 offen lds
    s_mov_b32 m0, 13312
    s_add_u32 s57, s96, 199680
    buffer_load_dwordx4 v15, s[12:15], s57 offen lds
    s_mov_b32 m0, 14336
    s_add_u32 s57, s96, 215040
    buffer_load_dwordx4 v15, s[12:15], s57 offen lds
    s_mov_b32 m0, 15360
    s_add_u32 s57, s96, 230400
    buffer_load_dwordx4 v15, s[12:15], s57 offen lds
    s_mov_b32 m0, 16384
    s_add_u32 s57, s96, 245760
    buffer_load_dwordx4 v15, s[12:15], s57 offen lds
    s_mov_b32 m0, 17408
    s_add_u32 s57, s96, 261120
    buffer_load_dwordx4 v15, s[12:15], s57 offen lds
    s_mov_b32 m0, 18432
    s_add_u32 s57, s96, 276480
    buffer_load_dwordx4 v15, s[12:15], s57 offen lds
    s_mov_b32 m0, 19456
    s_add_u32 s57, s96, 291840
    buffer_load_dwordx4 v15, s[12:15], s57 offen lds
    s_mov_b32 m0, 20480
    s_add_u32 s57, s96, 307200
    buffer_load_dwordx4 v15, s[12:15], s57 offen lds
    s_mov_b32 m0, 21504
    s_add_u32 s57, s96, 322560
    buffer_load_dwordx4 v15, s[12:15], s57 offen lds
    s_mov_b32 m0, 22528
    s_add_u32 s57, s96, 337920
    buffer_load_dwordx4 v15, s[12:15], s57 offen lds
    s_mov_b32 m0, 23552
    s_add_u32 s57, s96, 353280
    buffer_load_dwordx4 v15, s[12:15], s57 offen lds
    s_mov_b32 m0, 24576
    s_add_u32 s57, s96, 368640
    buffer_load_dwordx4 v15, s[12:15], s57 offen lds
    s_mov_b32 m0, 25600
    s_add_u32 s57, s96, 384000
    buffer_load_dwordx4 v15, s[12:15], s57 offen lds
    s_mov_b32 m0, 26624
    s_add_u32 s57, s96, 399360
    buffer_load_dwordx4 v15, s[12:15], s57 offen lds
    s_mov_b32 m0, 27648
    s_add_u32 s57, s96, 414720
    buffer_load_dwordx4 v15, s[12:15], s57 offen lds
    s_waitcnt vmcnt(24)
    s_nop 0
    s_mov_b32 m0, 28672
    s_add_u32 s57, s96, 430080
    buffer_load_dwordx4 v15, s[12:15], s57 offen lds
    s_mov_b32 m0, 29696
    s_add_u32 s57, s96, 445440
    buffer_load_dwordx4 v15, s[12:15], s57 offen lds
    s_mov_b32 m0, 30720
    s_add_u32 s57, s96, 460800
    buffer_load_dwordx4 v15, s[12:15], s57 offen lds
    s_mov_b32 m0, 31744
    s_add_u32 s57, s96, 476160
    buffer_load_dwordx4 v15, s[12:15], s57 offen lds
    s_waitcnt vmcnt(24)
    s_nop 0
    s_mov_b32 m0, 32768
    s_add_u32 s57, s96, 491520
    buffer_load_dwordx4 v15, s[12:15], s57 offen lds
    s_mov_b32 m0, 33792
    s_add_u32 s57, s96, 506880
    buffer_load_dwordx4 v15, s[12:15], s57 offen lds
    s_mov_b32 m0, 34816
    s_add_u32 s57, s96, 522240
    buffer_load_dwordx4 v15, s[12:15], s57 offen lds
    s_mov_b32 m0, 35840
    s_add_u32 s57, s96, 537600
    buffer_load_dwordx4 v15, s[12:15], s57 offen lds
    s_waitcnt vmcnt(24)
    s_nop 0
    s_mov_b32 m0, 36864
    s_add_u32 s57, s96, 552960
    buffer_load_dwordx4 v15, s[12:15], s57 offen lds
    s_mov_b32 m0, 37888
    s_add_u32 s57, s96, 568320
    buffer_load_dwordx4 v15, s[12:15], s57 offen lds
    s_mov_b32 m0, 38912
    s_add_u32 s57, s96, 583680
    buffer_load_dwordx4 v15, s[12:15], s57 offen lds
    s_mov_b32 m0, 39936
    s_add_u32 s57, s96, 599040
    buffer_load_dwordx4 v15, s[12:15], s57 offen lds
    s_waitcnt vmcnt(24)
    s_nop 0
    s_mov_b32 m0, 40960
    s_add_u32 s57, s96, 614400
    buffer_load_dwordx4 v15, s[12:15], s57 offen lds
    s_mov_b32 m0, 41984
    s_add_u32 s57, s96, 629760
    buffer_load_dwordx4 v15, s[12:15], s57 offen lds
    s_mov_b32 m0, 43008
    s_add_u32 s57, s96, 645120
    buffer_load_dwordx4 v15, s[12:15], s57 offen lds
    s_mov_b32 m0, 44032
    s_add_u32 s57, s96, 660480
    buffer_load_dwordx4 v15, s[12:15], s57 offen lds
    s_waitcnt vmcnt(24)
    s_nop 0
    s_mov_b32 m0, 45056
    s_add_u32 s57, s96, 675840
    buffer_load_dwordx4 v15, s[12:15], s57 offen lds
    s_mov_b32 m0, 46080
    s_add_u32 s57, s96, 691200
    buffer_load_dwordx4 v15, s[12:15], s57 offen lds
    s_mov_b32 m0, 47104
    s_add_u32 s57, s96, 706560
    buffer_load_dwordx4 v15, s[12:15], s57 offen lds
    s_mov_b32 m0, 48128
    s_add_u32 s57, s96, 721920
    buffer_load_dwordx4 v15, s[12:15], s57 offen lds
    s_waitcnt vmcnt(24)
    s_nop 0
    s_mov_b32 m0, 49152
    s_add_u32 s57, s96, 737280
    buffer_load_dwordx4 v15, s[12:15], s57 offen lds
    s_mov_b32 m0, 50176
    s_add_u32 s57, s96, 752640
    buffer_load_dwordx4 v15, s[12:15], s57 offen lds
    s_mov_b32 m0, 51200
    s_add_u32 s57, s96, 768000
    buffer_load_dwordx4 v15, s[12:15], s57 offen lds
    s_mov_b32 m0, 52224
    s_add_u32 s57, s96, 783360
    buffer_load_dwordx4 v15, s[12:15], s57 offen lds
    s_waitcnt vmcnt(24)
    s_nop 0
    s_mov_b32 m0, 53248
    s_add_u32 s57, s96, 798720
    buffer_load_dwordx4 v15, s[12:15], s57 offen lds
    s_mov_b32 m0, 54272
    s_add_u32 s57, s96, 814080
    buffer_load_dwordx4 v15, s[12:15], s57 offen lds
    s_mov_b32 m0, 55296
    s_add_u32 s57, s96, 829440
    buffer_load_dwordx4 v15, s[12:15], s57 offen lds
    s_mov_b32 m0, 56320
    s_add_u32 s57, s96, 844800
    buffer_load_dwordx4 v15, s[12:15], s57 offen lds
    s_waitcnt vmcnt(24)
    s_nop 0
    s_mov_b32 m0, 57344
    s_add_u32 s57, s96, 860160
    buffer_load_dwordx4 v15, s[12:15], s57 offen lds
    s_mov_b32 m0, 58368
    s_add_u32 s57, s96, 875520
    buffer_load_dwordx4 v15, s[12:15], s57 offen lds
    s_mov_b32 m0, 59392
    s_add_u32 s57, s96, 890880
    buffer_load_dwordx4 v15, s[12:15], s57 offen lds
    s_mov_b32 m0, 60416
    s_add_u32 s57, s96, 906240
    buffer_load_dwordx4 v15, s[12:15], s57 offen lds
    s_waitcnt vmcnt(24)
    s_nop 0
    s_mov_b32 m0, 61440
    s_add_u32 s57, s96, 921600
    buffer_load_dwordx4 v15, s[12:15], s57 offen lds
    s_mov_b32 m0, 62464
    s_add_u32 s57, s96, 936960
    buffer_load_dwordx4 v15, s[12:15], s57 offen lds
    s_mov_b32 m0, 63488
    s_add_u32 s57, s96, 952320
    buffer_load_dwordx4 v15, s[12:15], s57 offen lds
    s_mov_b32 m0, 64512
    s_add_u32 s57, s96, 967680
    buffer_load_dwordx4 v15, s[12:15], s57 offen lds
    s_waitcnt vmcnt(24)
    s_waitcnt vmcnt(14)
P0J_3:
    s_lshl_b32 s80, s56, 2
    s_add_u32 s80, s80, s55
    s_add_u32 s80, s80, 0
    s_lshl_b32 s81, s55, 12
    s_add_u32 s81, s81, 16384
    v_lshrrev_b32 v3, 3, v1
    v_and_b32 v4, 7, v1
    v_and_b32 v5, 3, v3
    v_lshrrev_b32 v6, 2, v3
    s_cmp_ge_u32 s80, 1160
    s_cbranch_scc1 RLN_17
    s_cmp_lt_u32 s80, 480
    s_cbranch_scc1 RW2_10
    s_cmp_lt_u32 s80, 864
    s_cbranch_scc1 RW1A_13
    s_cmp_lt_u32 s80, 960
    s_cbranch_scc1 RW1B_14
    s_cmp_lt_u32 s80, 1120
    s_cbranch_scc1 RWOM_11
    s_branch RWOT_12
RW2_10:
    s_mul_i32 s82, s80, 6554
    s_lshr_b32 s82, s82, 16
    s_mul_i32 s83, s82, 10
    s_sub_u32 s83, s80, s83
    v_lshl_add_u32 v7, v6, 3, v5
    s_lshl_b32 s84, s82, 5
    s_mov_b32 s85, 0
    s_mov_b32 s86, 4
    s_mov_b32 s87, 16
    s_mov_b32 s88, 20
    s_mov_b32 s89, 28311552
    s_mov_b32 s91, 48
    s_mov_b32 s64, s24
    s_mov_b32 s65, s25
    s_mov_b32 s66, s26
    s_mov_b32 s67, 0x20000
    s_branch RL16_15
RWOM_11:
    s_sub_u32 s57, s80, 960
    s_mul_i32 s82, s57, 6554
    s_lshr_b32 s82, s82, 16
    s_mul_i32 s83, s82, 10
    s_sub_u32 s83, s57, s83
    v_lshl_add_u32 v7, v6, 3, v5
    s_mul_i32 s84, s82, 40
    s_mov_b32 s85, 0
    s_mov_b32 s86, 4
    s_mov_b32 s87, 20
    s_mov_b32 s88, 24
    s_mov_b32 s89, 25165824
    s_mov_b32 s91, 20
    s_mov_b32 s64, s16
    s_mov_b32 s65, s17
    s_mov_b32 s66, s18
    s_mov_b32 s67, 0x20000
    s_branch RL16_15
RWOT_12:
    s_sub_u32 s57, s80, 1120
    s_mul_i32 s82, s57, 6554
    s_lshr_b32 s82, s82, 16
    s_mul_i32 s83, s82, 10
    s_sub_u32 s83, s57, s83
    v_mul_u32_u24 v7, 20, v6
    v_add_u32_e64 v7, v7, v5
    s_mul_i32 s84, s82, 160
    s_add_u32 s82, s82, 16
    s_mov_b32 s85, 16
    s_mov_b32 s86, 56
    s_mov_b32 s87, 96
    s_mov_b32 s88, 136
    s_mov_b32 s89, 25165824
    s_mov_b32 s91, 20
    s_mov_b32 s64, s16
    s_mov_b32 s65, s17
    s_mov_b32 s66, s18
    s_mov_b32 s67, 0x20000
RL16_15:
    v_mul_u32_u24 v7, 1280, v7
    v_lshl_add_u32 v7, v4, 4, v7
    s_lshl_b32 s58, s83, 7
    s_add_u32 s57, s84, s85
    s_mul_i32 s57, s57, 1280
    s_add_u32 s57, s57, s58
    v_add_u32 v208, s57, v7
    s_add_u32 s57, s84, s86
    s_mul_i32 s57, s57, 1280
    s_add_u32 s57, s57, s58
    v_add_u32 v209, s57, v7
    s_add_u32 s57, s84, s87
    s_mul_i32 s57, s57, 1280
    s_add_u32 s57, s57, s58
    v_add_u32 v210, s57, v7
    s_add_u32 s57, s84, s88
    s_mul_i32 s57, s57, 1280
    s_add_u32 s57, s57, s58
    v_add_u32 v211, s57, v7
    v_lshrrev_b32_e64 v8, 4, v1
    v_bfe_u32 v9, v1, 2, 2
    v_lshl_add_u32 v8, v8, 3, v9
    v_lshlrev_b32 v8, 7, v8
    v_and_b32 v9, 3, v1
    v_lshl_add_u32 v8, v9, 3, v8
    v_add_u32 v8, s81, v8
    v_add_u32 v212, 0, v8
    s_lshl_b32 s58, s83, 2
    s_add_u32 s58, s58, 0
    s_mul_i32 s59, s58, 13108
    s_lshr_b32 s59, s59, 16
    s_mul_i32 s60, s59, 5
    s_sub_u32 s60, s58, s60
    s_mul_i32 s59, s59, s91
    s_add_u32 s59, s59, s82
    s_mul_i32 s59, s59, 5
    s_add_u32 s59, s59, s60
    s_lshl_b32 s59, s59, 10
    s_add_u32 s68, s59, s89
    v_add_u32 v213, 32, v8
    s_lshl_b32 s58, s83, 2
    s_add_u32 s58, s58, 1
    s_mul_i32 s59, s58, 13108
    s_lshr_b32 s59, s59, 16
    s_mul_i32 s60, s59, 5
    s_sub_u32 s60, s58, s60
    s_mul_i32 s59, s59, s91
    s_add_u32 s59, s59, s82
    s_mul_i32 s59, s59, 5
    s_add_u32 s59, s59, s60
    s_lshl_b32 s59, s59, 10
    s_add_u32 s69, s59, s89
    v_add_u32 v214, 64, v8
    s_lshl_b32 s58, s83, 2
    s_add_u32 s58, s58, 2
    s_mul_i32 s59, s58, 13108
    s_lshr_b32 s59, s59, 16
    s_mul_i32 s60, s59, 5
    s_sub_u32 s60, s58, s60
    s_mul_i32 s59, s59, s91
    s_add_u32 s59, s59, s82
    s_mul_i32 s59, s59, 5
    s_add_u32 s59, s59, s60
    s_lshl_b32 s59, s59, 10
    s_add_u32 s70, s59, s89
    v_add_u32 v215, 96, v8
    s_lshl_b32 s58, s83, 2
    s_add_u32 s58, s58, 3
    s_mul_i32 s59, s58, 13108
    s_lshr_b32 s59, s59, 16
    s_mul_i32 s60, s59, 5
    s_sub_u32 s60, s58, s60
    s_mul_i32 s59, s59, s91
    s_add_u32 s59, s59, s82
    s_mul_i32 s59, s59, 5
    s_add_u32 s59, s59, s60
    s_lshl_b32 s59, s59, 10
    s_add_u32 s71, s59, s89
    s_branch RLD_18
RW1A_13:
    s_sub_u32 s57, s80, 480
    s_mul_i32 s58, s57, 2731
    s_lshr_b32 s58, s58, 16
    s_mul_i32 s59, s58, 24
    s_sub_u32 s59, s57, s59
    s_lshr_b32 s60, s58, 1
    s_and_b32 s58, s58, 1
    v_lshl_add_u32 v7, v6, 4, v5
    s_mul_i32 s84, s60, 80
    s_lshl_b32 s63, s58, 5
    s_add_u32 s84, s84, s63
    s_mov_b32 s85, 0
    s_mov_b32 s86, 4
    s_mov_b32 s87, 8
    s_mov_b32 s88, 12
    s_lshl_b32 s82, s59, 7
    s_mov_b32 s83, s82
    s_mul_i32 s89, s60, 5
    s_lshl_b32 s63, s58, 1
    s_add_u32 s89, s89, s63
    s_add_u32 s91, s89, 1
    s_lshl_b32 s61, s59, 1
    s_mov_b32 s62, s61
    s_branch RL32_16
RW1B_14:
    s_sub_u32 s57, s80, 864
    s_mul_i32 s60, s57, 5462
    s_lshr_b32 s60, s60, 16
    s_mul_i32 s59, s60, 12
    s_sub_u32 s59, s57, s59
    v_mov_b32_e64 v7, v3
    s_mul_i32 s84, s60, 80
    s_add_u32 s84, s84, 64
    s_mov_b32 s85, 0
    s_mov_b32 s86, 8
    s_mov_b32 s87, 0
    s_mov_b32 s88, 8
    s_lshl_b32 s82, s59, 8
    s_add_u32 s83, s82, 128
    s_mul_i32 s89, s60, 5
    s_add_u32 s89, s89, 4
    s_mov_b32 s91, s89
    s_lshl_b32 s61, s59, 2
    s_add_u32 s62, s61, 2
RL32_16:
    s_mov_b32 s64, s20
    s_mov_b32 s65, s21
    s_mov_b32 s66, s22
    s_mov_b32 s67, 0x20000
    v_mul_u32_u24 v7, 3072, v7
    v_lshl_add_u32 v7, v4, 4, v7
    s_add_u32 s57, s84, s85
    s_mul_i32 s57, s57, 3072
    s_add_u32 s57, s57, s82
    v_add_u32 v208, s57, v7
    s_add_u32 s57, s84, s86
    s_mul_i32 s57, s57, 3072
    s_add_u32 s57, s57, s82
    v_add_u32 v209, s57, v7
    s_add_u32 s57, s84, s87
    s_mul_i32 s57, s57, 3072
    s_add_u32 s57, s57, s83
    v_add_u32 v210, s57, v7
    s_add_u32 s57, s84, s88
    s_mul_i32 s57, s57, 3072
    s_add_u32 s57, s57, s83
    v_add_u32 v211, s57, v7
    v_lshrrev_b32_e64 v8, 5, v1
    v_bfe_u32 v9, v1, 2, 2
    v_lshl_add_u32 v8, v8, 3, v9
    v_lshlrev_b32_e64 v8, 7, v8
    v_bfe_u32 v9, v1, 4, 1
    v_lshl_add_u32 v8, v9, 5, v8
    v_and_b32_e64 v9, 3, v1
    v_lshl_add_u32 v8, v9, 3, v8
    v_add_u32 v8, s81, v8
    v_add_u32 v212, 0, v8
    s_add_u32 s57, s61, 0
    s_mul_i32 s57, s57, 40
    s_add_u32 s57, s57, s89
    s_lshl_b32 s57, s57, 10
    s_add_u32 s68, s57, 26214400
    v_add_u32 v213, 64, v8
    s_add_u32 s57, s61, 1
    s_mul_i32 s57, s57, 40
    s_add_u32 s57, s57, s89
    s_lshl_b32 s57, s57, 10
    s_add_u32 s69, s57, 26214400
    v_add_u32 v214, 2048, v8
    s_add_u32 s57, s62, 0
    s_mul_i32 s57, s57, 40
    s_add_u32 s57, s57, s91
    s_lshl_b32 s57, s57, 10
    s_add_u32 s70, s57, 26214400
    v_add_u32 v215, 2112, v8
    s_add_u32 s57, s62, 1
    s_mul_i32 s57, s57, 40
    s_add_u32 s57, s57, s91
    s_lshl_b32 s57, s57, 10
    s_add_u32 s71, s57, 26214400
    s_branch RLD_18
RLN_17:
    s_mov_b32 s64, s20
    s_mov_b32 s65, s21
    s_mov_b32 s66, s22
    s_mov_b32 s67, 0x20000
    v_mov_b32 v208, 0xf0000000
    v_add_u32 v212, s81, v2
    s_mov_b32 s68, 0x7ffff000
    v_mov_b32 v209, 0xf0000000
    v_add_u32_e64 v213, s81, v2
    s_mov_b32 s69, 0x7ffff000
    v_mov_b32 v210, 0xf0000000
    v_add_u32_e64 v214, s81, v2
    s_mov_b32 s70, 0x7ffff000
    v_mov_b32 v211, 0xf0000000
    v_add_u32_e64 v215, s81, v2
    s_mov_b32 s71, 0x7ffff000
RLD_18:
    s_lshl_b32 s80, s56, 2
    s_add_u32 s80, s80, s55
    s_add_u32 s80, s80, 1024
    s_lshl_b32 s81, s55, 12
    s_add_u32 s81, s81, 32768
    v_lshrrev_b32 v3, 3, v1
    v_and_b32 v4, 7, v1
    v_and_b32 v5, 3, v3
    v_lshrrev_b32_e64 v6, 2, v3
    s_cmp_ge_u32 s80, 1160
    s_cbranch_scc1 RLN_26
    s_cmp_lt_u32 s80, 480
    s_cbranch_scc1 RW2_19
    s_cmp_lt_u32 s80, 864
    s_cbranch_scc1 RW1A_22
    s_cmp_lt_u32 s80, 960
    s_cbranch_scc1 RW1B_23
    s_cmp_lt_u32 s80, 1120
    s_cbranch_scc1 RWOM_20
    s_branch RWOT_21
RW2_19:
    s_mul_i32 s82, s80, 6554
    s_lshr_b32 s82, s82, 16
    s_mul_i32 s83, s82, 10
    s_sub_u32 s83, s80, s83
    v_lshl_add_u32 v7, v6, 3, v5
    s_lshl_b32 s84, s82, 5
    s_mov_b32 s85, 0
    s_mov_b32 s86, 4
    s_mov_b32 s87, 16
    s_mov_b32 s88, 20
    s_mov_b32 s89, 28311552
    s_mov_b32 s91, 48
    s_mov_b32 s72, s24
    s_mov_b32 s73, s25
    s_mov_b32 s74, s26
    s_mov_b32 s75, 0x20000
    s_branch RL16_24
RWOM_20:
    s_sub_u32 s57, s80, 960
    s_mul_i32 s82, s57, 6554
    s_lshr_b32 s82, s82, 16
    s_mul_i32 s83, s82, 10
    s_sub_u32 s83, s57, s83
    v_lshl_add_u32 v7, v6, 3, v5
    s_mul_i32 s84, s82, 40
    s_mov_b32 s85, 0
    s_mov_b32 s86, 4
    s_mov_b32 s87, 20
    s_mov_b32 s88, 24
    s_mov_b32 s89, 25165824
    s_mov_b32 s91, 20
    s_mov_b32 s72, s16
    s_mov_b32 s73, s17
    s_mov_b32 s74, s18
    s_mov_b32 s75, 0x20000
    s_branch RL16_24
RWOT_21:
    s_sub_u32 s57, s80, 1120
    s_mul_i32 s82, s57, 6554
    s_lshr_b32 s82, s82, 16
    s_mul_i32 s83, s82, 10
    s_sub_u32 s83, s57, s83
    v_mul_u32_u24 v7, 20, v6
    v_add_u32_e64 v7, v7, v5
    s_mul_i32 s84, s82, 160
    s_add_u32 s82, s82, 16
    s_mov_b32 s85, 16
    s_mov_b32 s86, 56
    s_mov_b32 s87, 96
    s_mov_b32 s88, 136
    s_mov_b32 s89, 25165824
    s_mov_b32 s91, 20
    s_mov_b32 s72, s16
    s_mov_b32 s73, s17
    s_mov_b32 s74, s18
    s_mov_b32 s75, 0x20000
RL16_24:
    v_mul_u32_u24 v7, 1280, v7
    v_lshl_add_u32 v7, v4, 4, v7
    s_lshl_b32 s58, s83, 7
    s_add_u32 s57, s84, s85
    s_mul_i32 s57, s57, 1280
    s_add_u32 s57, s57, s58
    v_add_u32 v216, s57, v7
    s_add_u32 s57, s84, s86
    s_mul_i32 s57, s57, 1280
    s_add_u32 s57, s57, s58
    v_add_u32 v217, s57, v7
    s_add_u32 s57, s84, s87
    s_mul_i32 s57, s57, 1280
    s_add_u32 s57, s57, s58
    v_add_u32 v218, s57, v7
    s_add_u32 s57, s84, s88
    s_mul_i32 s57, s57, 1280
    s_add_u32 s57, s57, s58
    v_add_u32 v219, s57, v7
    v_lshrrev_b32_e64 v8, 4, v1
    v_bfe_u32 v9, v1, 2, 2
    v_lshl_add_u32 v8, v8, 3, v9
    v_lshlrev_b32 v8, 7, v8
    v_and_b32 v9, 3, v1
    v_lshl_add_u32 v8, v9, 3, v8
    v_add_u32 v8, s81, v8
    v_add_u32 v220, 0, v8
    s_lshl_b32 s58, s83, 2
    s_add_u32 s58, s58, 0
    s_mul_i32 s59, s58, 13108
    s_lshr_b32 s59, s59, 16
    s_mul_i32 s60, s59, 5
    s_sub_u32 s60, s58, s60
    s_mul_i32 s59, s59, s91
    s_add_u32 s59, s59, s82
    s_mul_i32 s59, s59, 5
    s_add_u32 s59, s59, s60
    s_lshl_b32 s59, s59, 10
    s_add_u32 s76, s59, s89
    v_add_u32 v221, 32, v8
    s_lshl_b32 s58, s83, 2
    s_add_u32 s58, s58, 1
    s_mul_i32 s59, s58, 13108
    s_lshr_b32 s59, s59, 16
    s_mul_i32 s60, s59, 5
    s_sub_u32 s60, s58, s60
    s_mul_i32 s59, s59, s91
    s_add_u32 s59, s59, s82
    s_mul_i32 s59, s59, 5
    s_add_u32 s59, s59, s60
    s_lshl_b32 s59, s59, 10
    s_add_u32 s77, s59, s89
    v_add_u32 v222, 64, v8
    s_lshl_b32 s58, s83, 2
    s_add_u32 s58, s58, 2
    s_mul_i32 s59, s58, 13108
    s_lshr_b32 s59, s59, 16
    s_mul_i32 s60, s59, 5
    s_sub_u32 s60, s58, s60
    s_mul_i32 s59, s59, s91
    s_add_u32 s59, s59, s82
    s_mul_i32 s59, s59, 5
    s_add_u32 s59, s59, s60
    s_lshl_b32 s59, s59, 10
    s_add_u32 s78, s59, s89
    v_add_u32 v223, 96, v8
    s_lshl_b32 s58, s83, 2
    s_add_u32 s58, s58, 3
    s_mul_i32 s59, s58, 13108
    s_lshr_b32 s59, s59, 16
    s_mul_i32 s60, s59, 5
    s_sub_u32 s60, s58, s60
    s_mul_i32 s59, s59, s91
    s_add_u32 s59, s59, s82
    s_mul_i32 s59, s59, 5
    s_add_u32 s59, s59, s60
    s_lshl_b32 s59, s59, 10
    s_add_u32 s79, s59, s89
    s_branch RLD_27
RW1A_22:
    s_sub_u32 s57, s80, 480
    s_mul_i32 s58, s57, 2731
    s_lshr_b32 s58, s58, 16
    s_mul_i32 s59, s58, 24
    s_sub_u32 s59, s57, s59
    s_lshr_b32 s60, s58, 1
    s_and_b32 s58, s58, 1
    v_lshl_add_u32 v7, v6, 4, v5
    s_mul_i32 s84, s60, 80
    s_lshl_b32 s63, s58, 5
    s_add_u32 s84, s84, s63
    s_mov_b32 s85, 0
    s_mov_b32 s86, 4
    s_mov_b32 s87, 8
    s_mov_b32 s88, 12
    s_lshl_b32 s82, s59, 7
    s_mov_b32 s83, s82
    s_mul_i32 s89, s60, 5
    s_lshl_b32 s63, s58, 1
    s_add_u32 s89, s89, s63
    s_add_u32 s91, s89, 1
    s_lshl_b32 s61, s59, 1
    s_mov_b32 s62, s61
    s_branch RL32_25
RW1B_23:
    s_sub_u32 s57, s80, 864
    s_mul_i32 s60, s57, 5462
    s_lshr_b32 s60, s60, 16
    s_mul_i32 s59, s60, 12
    s_sub_u32 s59, s57, s59
    v_mov_b32_e64 v7, v3
    s_mul_i32 s84, s60, 80
    s_add_u32 s84, s84, 64
    s_mov_b32 s85, 0
    s_mov_b32 s86, 8
    s_mov_b32 s87, 0
    s_mov_b32 s88, 8
    s_lshl_b32 s82, s59, 8
    s_add_u32 s83, s82, 128
    s_mul_i32 s89, s60, 5
    s_add_u32 s89, s89, 4
    s_mov_b32 s91, s89
    s_lshl_b32 s61, s59, 2
    s_add_u32 s62, s61, 2
RL32_25:
    s_mov_b32 s72, s20
    s_mov_b32 s73, s21
    s_mov_b32 s74, s22
    s_mov_b32 s75, 0x20000
    v_mul_u32_u24 v7, 3072, v7
    v_lshl_add_u32 v7, v4, 4, v7
    s_add_u32 s57, s84, s85
    s_mul_i32 s57, s57, 3072
    s_add_u32 s57, s57, s82
    v_add_u32 v216, s57, v7
    s_add_u32 s57, s84, s86
    s_mul_i32 s57, s57, 3072
    s_add_u32 s57, s57, s82
    v_add_u32 v217, s57, v7
    s_add_u32 s57, s84, s87
    s_mul_i32 s57, s57, 3072
    s_add_u32 s57, s57, s83
    v_add_u32 v218, s57, v7
    s_add_u32 s57, s84, s88
    s_mul_i32 s57, s57, 3072
    s_add_u32 s57, s57, s83
    v_add_u32 v219, s57, v7
    v_lshrrev_b32_e64 v8, 5, v1
    v_bfe_u32 v9, v1, 2, 2
    v_lshl_add_u32 v8, v8, 3, v9
    v_lshlrev_b32_e64 v8, 7, v8
    v_bfe_u32 v9, v1, 4, 1
    v_lshl_add_u32 v8, v9, 5, v8
    v_and_b32_e64 v9, 3, v1
    v_lshl_add_u32 v8, v9, 3, v8
    v_add_u32 v8, s81, v8
    v_add_u32 v220, 0, v8
    s_add_u32 s57, s61, 0
    s_mul_i32 s57, s57, 40
    s_add_u32 s57, s57, s89
    s_lshl_b32 s57, s57, 10
    s_add_u32 s76, s57, 26214400
    v_add_u32 v221, 64, v8
    s_add_u32 s57, s61, 1
    s_mul_i32 s57, s57, 40
    s_add_u32 s57, s57, s89
    s_lshl_b32 s57, s57, 10
    s_add_u32 s77, s57, 26214400
    v_add_u32 v222, 2048, v8
    s_add_u32 s57, s62, 0
    s_mul_i32 s57, s57, 40
    s_add_u32 s57, s57, s91
    s_lshl_b32 s57, s57, 10
    s_add_u32 s78, s57, 26214400
    v_add_u32 v223, 2112, v8
    s_add_u32 s57, s62, 1
    s_mul_i32 s57, s57, 40
    s_add_u32 s57, s57, s91
    s_lshl_b32 s57, s57, 10
    s_add_u32 s79, s57, 26214400
    s_branch RLD_27
RLN_26:
    s_mov_b32 s72, s20
    s_mov_b32 s73, s21
    s_mov_b32 s74, s22
    s_mov_b32 s75, 0x20000
    v_mov_b32 v216, 0xf0000000
    v_add_u32 v220, s81, v2
    s_mov_b32 s76, 0x7ffff000
    v_mov_b32 v217, 0xf0000000
    v_add_u32_e64 v221, s81, v2
    s_mov_b32 s77, 0x7ffff000
    v_mov_b32 v218, 0xf0000000
    v_add_u32_e64 v222, s81, v2
    s_mov_b32 s78, 0x7ffff000
    v_mov_b32 v219, 0xf0000000
    v_add_u32_e64 v223, s81, v2
    s_mov_b32 s79, 0x7ffff000
RLD_27:
    s_mul_i32 s57, s56, 1639
    s_lshr_b32 s57, s57, 16
    s_mul_i32 s58, s57, 40
    s_sub_u32 s58, s56, s58
    s_add_u32 s58, s58, 20
    s_mul_i32 s59, s57, 160
    s_mul_i32 s60, s55, 40
    s_add_u32 s59, s59, s60
    s_lshl_b32 s5, s59, 1
    s_mul_i32 s4, s59, 7680
    s_lshl_b32 s60, s58, 7
    s_add_u32 s4, s4, s60
    s_mul_i32 s3, s57, 15360
    s_lshl_b32 s60, s58, 8
    s_add_u32 s3, s3, s60
    s_add_u32 s3, s3, 262144
    s_cmp_lt_u32 s56, 160
    s_cselect_b32 s60, 0, 0xf0000000
    s_cselect_b32 s3, s3, 0x7ffff000
    v_lshrrev_b32 v3, 3, v1
    v_and_b32_e64 v4, 7, v1
    v_mul_u32_u24 v5, 7680, v3
    v_lshl_add_u32 v5, v4, 4, v5
    v_or_b32 v234, s60, v5
    v_min_u32 v5, 39, v1
    v_lshlrev_b32 v5, 1, v5
    v_or_b32 v235, s60, v5
    s_cmp_eq_u32 s54, 15
    s_cbranch_scc1 P1SK_28
    v_lshrrev_b32_e64 v8, 5, v1
    v_bfe_u32 v9, v1, 2, 2
    v_lshl_add_u32 v5, v8, 3, v9
    v_lshlrev_b32 v5, 8, v5
    v_and_b32 v6, 1, v1
    v_lshl_add_u32 v5, v6, 3, v5
    v_bfe_u32 v6, v1, 4, 1
    v_bfe_u32 v7, v1, 1, 1
    v_lshl_add_u32 v6, v6, 1, v7
    v_lshl_add_u32 v6, v9, 2, v6
    v_add_u32 v7, 0, v6
    v_and_b32 v7, 15, v7
    v_lshl_add_u32 v228, v7, 4, v5
    v_add_u32 v7, 4, v6
    v_and_b32 v7, 15, v7
    v_lshl_add_u32 v229, v7, 4, v5
    v_add_u32 v7, 8, v6
    v_and_b32 v7, 15, v7
    v_lshl_add_u32 v230, v7, 4, v5
    v_add_u32 v7, 12, v6
    v_and_b32 v7, 15, v7
    v_lshl_add_u32 v231, v7, 4, v5
    v_lshlrev_b32_e64 v232, 4, v8
    v_add_u32 v232, 147456, v232
    s_cmp_lt_u32 s54, 5
    s_cselect_b32 s62, 0x3ea52b5c, 1.0
    s_mov_b32 s63, s62
    s_lshl_b32 s96, s54, 8
    s_mul_i32 s58, s55, 61440
    s_add_u32 s96, s96, s58
    s_lshl_b32 s97, s55, 12
    s_lshl_b32 s98, s53, 2
    s_add_u32 s98, s98, s55
    s_mul_i32 s98, s98, 40960
    s_add_u32 s98, s98, 1048576
    s_mov_b32 s6, 1.0
    v_lshrrev_b32 v3, 4, v1
    v_lshlrev_b32 v4, 2, v3
    v_sub_u32 v4, v1, v4
    v_and_b32 v4, 15, v4
    v_mul_u32_u24 v233, 3840, v3
    v_lshl_add_u32 v233, v4, 4, v233
    v_lshlrev_b32_e64 v236, 4, v0
    v_add_u32 v237, 4096, v236
    v_lshlrev_b32_e64 v12, 3, v0
    v_add_u32 v13, 148736, v12
    v_add_u32 v14, 146176, v12
    v_cmp_le_u32 vcc, 160, v0
    s_nop 1
    v_cndmask_b32 v15, 0, 1.0, vcc
    v_cndmask_b32 v4, v13, v14, vcc
    v_add_u32 v13, 148224, v12
    v_mov_b32_e64 v12, v4
    v_mov_b32 v3, 161792
    v_mov_b32_e64 v4, 0
    ds_write_b32 v3, v4
    s_waitcnt lgkmcnt(0)
    s_lshl_b32 s57, s53, 2
    s_mul_i32 s57, s57, 40960
    s_mul_i32 s58, s54, 10240
    s_add_u32 s99, s57, s58
    s_mul_i32 s58, s55, 2560
    s_add_u32 s99, s99, s58
    s_add_u32 s99, s99, 1048576
    v_lshlrev_b32_e64 v238, 7, v1
    v_mov_b32 v5, 0xf0000000
    v_cmp_gt_u32 vcc, 20, v1
    s_nop 1
    v_cndmask_b32 v238, v5, v238, vcc
    s_lshl_b32 s57, s53, 5
    v_add_u32 v3, s57, v1
    v_lshlrev_b32 v3, 7, v3
    v_add_u32 v3, 4096, v3
    v_subrev_u32 v4, 32, v1
    v_lshlrev_b32 v4, 7, v4
    v_add_u32 v4, 69632, v4
    v_cmp_gt_u32 vcc, 32, v1
    s_nop 1
    v_cndmask_b32 v8, v4, v3, vcc
    v_add_u32 v4, 32, v1
    v_min_u32 v4, 79, v4
    v_lshlrev_b32_e64 v4, 7, v4
    v_add_u32 v9, 69632, v4
    s_cmp_lg_u32 s55, 0
    s_cbranch_scc1 POLLS_30
    s_mov_b32 s57, 0
POLL_31:
    buffer_load_dword v10, v8, s[36:39], 0 offen sc1
    buffer_load_dword v11, v9, s[36:39], 0 offen sc1
    s_waitcnt vmcnt(0)
    v_cmp_ne_u32 vcc, s52, v10
    v_cmp_ne_u32 s[58:59], s52, v11
    s_nop 0
    s_or_b64 vcc, vcc, s[58:59]
    s_add_u32 s57, s57, 1
    s_cmp_gt_u32 s57, 400000
    s_cbranch_scc1 POLLD_32
    s_cbranch_vccnz POLL_31
POLLD_32:
POLLS_30:
    s_barrier
    s_nop 0
    s_mov_b32 s57, 262144
    buffer_load_dwordx4 v[128:131], v236, s[36:39], s57 offen sc1
    s_mov_b32 s57, 277504
    buffer_load_dwordx4 v[132:135], v236, s[36:39], s57 offen sc1
    s_mov_b32 s57, 292864
    buffer_load_dwordx4 v[136:139], v236, s[36:39], s57 offen sc1
    s_mov_b32 s57, 308224
    buffer_load_dwordx4 v[140:143], v236, s[36:39], s57 offen sc1
    s_cmp_lg_u32 s55, 0
    s_cbranch_scc1 MVA_33
    s_mov_b32 s57, 262144
    buffer_load_dwordx4 v[144:147], v237, s[36:39], s57 offen sc1
    s_mov_b32 s57, 277504
    buffer_load_dwordx4 v[148:151], v237, s[36:39], s57 offen sc1
    s_mov_b32 s57, 292864
    buffer_load_dwordx4 v[152:155], v237, s[36:39], s57 offen sc1
    s_mov_b32 s57, 308224
    buffer_load_dwordx4 v[156:159], v237, s[36:39], s57 offen sc1
MVA_33:
    buffer_load_dwordx4 v[16:19], v2, s[36:39], s98 offen offset:0 sc1
    buffer_load_dwordx4 v[20:23], v2, s[36:39], s98 offen offset:1024 sc1
    buffer_load_dwordx4 v[24:27], v2, s[36:39], s98 offen offset:2048 sc1
    buffer_load_dwordx4 v[28:31], v2, s[36:39], s98 offen offset:3072 sc1
    s_add_u32 s98, s98, 4096
    buffer_load_dwordx4 v[32:35], v2, s[36:39], s98 offen offset:0 sc1
    buffer_load_dwordx4 v[36:39], v2, s[36:39], s98 offen offset:1024 sc1
    s_waitcnt vmcnt(8)
    v_pk_add_f32 v[128:129], v[128:129], v[132:133]
    s_waitcnt vmcnt(6)
    v_pk_add_f32 v[136:137], v[136:137], v[140:141]
    v_pk_add_f32 v[130:131], v[130:131], v[134:135]
    v_pk_add_f32 v[138:139], v[138:139], v[142:143]
    v_pk_add_f32 v[128:129], v[128:129], v[136:137]
    v_pk_add_f32 v[130:131], v[130:131], v[138:139]
    v_cvt_pk_bf16_f32 v132, v128, v129
    v_cvt_pk_bf16_f32 v133, v130, v131
    v_lshlrev_b32_e64 v128, 16, v132
    v_and_b32 v129, 0xffff0000, v132
    v_lshlrev_b32_e64 v130, 16, v133
    v_and_b32 v131, 0xffff0000, v133
    v_add_f32 v128, v15, v128
    v_add_f32 v129, v15, v129
    v_add_f32 v130, v15, v130
    v_add_f32 v131, v15, v131
    v_cvt_pk_bf16_f32 v132, v128, v129
    v_cvt_pk_bf16_f32 v133, v130, v131
    v_lshlrev_b32_e64 v128, 16, v132
    v_and_b32 v129, 0xffff0000, v132
    v_lshlrev_b32_e64 v130, 16, v133
    v_and_b32 v131, 0xffff0000, v133
    v_mul_f32 v128, s62, v128
    v_mul_f32 v129, s62, v129
    v_mul_f32 v130, s62, v130
    v_mul_f32 v131, s62, v131
    v_max3_f32 v132, |v128|, |v129|, |v130|
    v_max_f32 v132, v132, |v131|
    v_mov_b32 v133, 0x47000000
    v_cmp_nle_f32 vcc, v132, v133
    s_nop 0
    s_cmp_lg_u64 vcc, 0
    s_cselect_b32 s60, 1, 0
    v_mov_b32 v133, 0x3b800000
    v_cmp_ge_f32 vcc, v132, v133
    s_nop 0
    s_cmp_lg_u64 vcc, 0
    s_cselect_b32 s59, 2, 0
    s_or_b32 s60, s60, s59
    v_cvt_pk_f16_f32 v132, v128, v129
    v_cvt_pk_f16_f32 v133, v130, v131
    ds_write_b64 v12, v[132:133]
    s_cmp_lg_u32 s55, 0
    s_cbranch_scc1 MVB_34
    s_nop 0
    v_pk_add_f32 v[144:145], v[144:145], v[148:149]
    v_pk_add_f32 v[152:153], v[152:153], v[156:157]
    v_pk_add_f32 v[146:147], v[146:147], v[150:151]
    v_pk_add_f32 v[154:155], v[154:155], v[158:159]
    v_pk_add_f32 v[144:145], v[144:145], v[152:153]
    v_pk_add_f32 v[146:147], v[146:147], v[154:155]
    v_cvt_pk_bf16_f32 v148, v144, v145
    v_cvt_pk_bf16_f32 v149, v146, v147
    v_lshlrev_b32_e64 v144, 16, v148
    v_and_b32 v145, 0xffff0000, v148
    v_lshlrev_b32_e64 v146, 16, v149
    v_and_b32 v147, 0xffff0000, v149
    v_add_f32 v144, 1.0, v144
    v_add_f32 v145, 1.0, v145
    v_add_f32 v146, 1.0, v146
    v_add_f32 v147, 1.0, v147
    v_cvt_pk_bf16_f32 v148, v144, v145
    v_cvt_pk_bf16_f32 v149, v146, v147
    v_lshlrev_b32_e64 v144, 16, v148
    v_and_b32 v145, 0xffff0000, v148
    v_lshlrev_b32_e64 v146, 16, v149
    v_and_b32 v147, 0xffff0000, v149
    v_mul_f32 v144, s62, v144
    v_mul_f32 v145, s62, v145
    v_mul_f32 v146, s62, v146
    v_mul_f32 v147, s62, v147
    v_max3_f32 v148, |v144|, |v145|, |v146|
    v_max_f32 v148, v148, |v147|
    v_mov_b32 v149, 0x47000000
    v_cmp_nle_f32 vcc, v148, v149
    s_nop 0
    s_cmp_lg_u64 vcc, 0
    s_cselect_b32 s61, 1, 0
    v_mov_b32 v149, 0x3b800000
    v_cmp_ge_f32 vcc, v148, v149
    s_nop 0
    s_cmp_lg_u64 vcc, 0
    s_cselect_b32 s59, 2, 0
    s_or_b32 s61, s61, s59
    s_or_b32 s60, s60, s61
    v_cvt_pk_f16_f32 v148, v144, v145
    v_cvt_pk_f16_f32 v149, v146, v147
    ds_write_b64 v13, v[148:149]
MVB_34:
    v_mov_b32 v3, 161792
    v_mov_b32 v4, s60
    s_mov_b64 exec, 1
    ds_or_b32 v3, v4
    s_mov_b64 exec, -1
    s_nop 0
    buffer_load_dwordx4 v[40:43], v2, s[36:39], s98 offen offset:2048 sc1
    buffer_load_dwordx4 v[44:47], v2, s[36:39], s98 offen offset:3072 sc1
    s_add_u32 s98, s98, 4096
    buffer_load_dwordx4 v[48:51], v2, s[36:39], s98 offen offset:0 sc1
    buffer_load_dwordx4 v[52:55], v2, s[36:39], s98 offen offset:1024 sc1
    buffer_load_dwordx4 v[56:59], v2, s[36:39], s98 offen offset:2048 sc1
    buffer_load_dwordx4 v[60:63], v2, s[36:39], s98 offen offset:3072 sc1
    s_waitcnt lgkmcnt(0)
    s_barrier
    ds_read_b32 v4, v3
    s_waitcnt lgkmcnt(0)
    v_readfirstlane_b32 s57, v4
    s_nop 0
    s_cmp_lg_u32 s57, 2
    s_cbranch_scc1 RSC_36
RSB_35:
    s_nop 0
    ds_read_b128 v[128:131], v232 offset:0
    ds_read_b128 v[132:135], v232 offset:1280
    ds_read_b64_tr_b16 v[160:161], v228 offset:0
    ds_read_b64_tr_b16 v[162:163], v228 offset:1024
    ds_read_b64_tr_b16 v[164:165], v229 offset:0
    ds_read_b64_tr_b16 v[166:167], v229 offset:1024
    ds_read_b64_tr_b16 v[168:169], v230 offset:0
    ds_read_b64_tr_b16 v[170:171], v230 offset:1024
    ds_read_b64_tr_b16 v[172:173], v231 offset:0
    ds_read_b64_tr_b16 v[174:175], v231 offset:1024
    ds_read_b128 v[136:139], v232 offset:32
    ds_read_b128 v[140:143], v232 offset:1312
    s_waitcnt vmcnt(11) lgkmcnt(10)
    s_nop 0
    v_fma_mix_f32 v224, v16, v128, v132 op_sel:[0,0,0] op_sel_hi:[1,1,1]
    v_fma_mix_f32 v225, v16, v128, v132 op_sel:[1,1,1] op_sel_hi:[1,1,1]
    v_cvt_pk_bf16_f32 v16, v224, v225
    v_fma_mix_f32 v226, v17, v129, v133 op_sel:[0,0,0] op_sel_hi:[1,1,1]
    v_fma_mix_f32 v227, v17, v129, v133 op_sel:[1,1,1] op_sel_hi:[1,1,1]
    v_cvt_pk_bf16_f32 v17, v226, v227
    v_fma_mix_f32 v224, v18, v130, v134 op_sel:[0,0,0] op_sel_hi:[1,1,1]
    v_fma_mix_f32 v225, v18, v130, v134 op_sel:[1,1,1] op_sel_hi:[1,1,1]
    v_cvt_pk_bf16_f32 v18, v224, v225
    v_fma_mix_f32 v226, v19, v131, v135 op_sel:[0,0,0] op_sel_hi:[1,1,1]
    v_fma_mix_f32 v227, v19, v131, v135 op_sel:[1,1,1] op_sel_hi:[1,1,1]
    v_cvt_pk_bf16_f32 v19, v226, v227
    s_waitcnt lgkmcnt(0)
    s_nop 0
    v_mfma_f32_32x32x16_bf16 v[64:79], v[160:163], v[16:19], 0
    ds_read_b128 v[128:131], v232 offset:64
    ds_read_b128 v[132:135], v232 offset:1344
    ds_read_b64_tr_b16 v[176:177], v228 offset:4096
    ds_read_b64_tr_b16 v[178:179], v228 offset:5120
    ds_read_b64_tr_b16 v[180:181], v229 offset:4096
    v_mfma_f32_32x32x16_bf16 v[80:95], v[164:167], v[16:19], 0
    ds_read_b64_tr_b16 v[182:183], v229 offset:5120
    ds_read_b64_tr_b16 v[184:185], v230 offset:4096
    ds_read_b64_tr_b16 v[186:187], v230 offset:5120
    ds_read_b64_tr_b16 v[188:189], v231 offset:4096
    ds_read_b64_tr_b16 v[190:191], v231 offset:5120
    v_mfma_f32_32x32x16_bf16 v[96:111], v[168:171], v[16:19], 0
    s_waitcnt vmcnt(10)
    s_nop 0
    v_fma_mix_f32 v224, v20, v136, v140 op_sel:[0,0,0] op_sel_hi:[1,1,1]
    v_fma_mix_f32 v225, v20, v136, v140 op_sel:[1,1,1] op_sel_hi:[1,1,1]
    v_cvt_pk_bf16_f32 v20, v224, v225
    v_fma_mix_f32 v226, v21, v137, v141 op_sel:[0,0,0] op_sel_hi:[1,1,1]
    v_fma_mix_f32 v227, v21, v137, v141 op_sel:[1,1,1] op_sel_hi:[1,1,1]
    v_cvt_pk_bf16_f32 v21, v226, v227
    s_add_u32 m0, s97, 65536
    s_add_u32 s57, s96, 983040
    buffer_load_dwordx4 v233, s[12:15], s57 offen lds
    v_mfma_f32_32x32x16_bf16 v[112:127], v[172:175], v[16:19], 0
    v_fma_mix_f32 v224, v22, v138, v142 op_sel:[0,0,0] op_sel_hi:[1,1,1]
    v_fma_mix_f32 v225, v22, v138, v142 op_sel:[1,1,1] op_sel_hi:[1,1,1]
    v_cvt_pk_bf16_f32 v22, v224, v225
    v_fma_mix_f32 v226, v23, v139, v143 op_sel:[0,0,0] op_sel_hi:[1,1,1]
    v_fma_mix_f32 v227, v23, v139, v143 op_sel:[1,1,1] op_sel_hi:[1,1,1]
    v_cvt_pk_bf16_f32 v23, v226, v227
    s_add_u32 s98, s98, 4096
    buffer_load_dwordx4 v[16:19], v2, s[36:39], s98 offen offset:0 sc1
    s_waitcnt lgkmcnt(0)
    s_nop 0
    v_mfma_f32_32x32x16_bf16 v[64:79], v[176:179], v[20:23], v[64:79]
    ds_read_b128 v[136:139], v232 offset:96
    ds_read_b128 v[140:143], v232 offset:1376
    ds_read_b64_tr_b16 v[160:161], v228 offset:8192
    ds_read_b64_tr_b16 v[162:163], v228 offset:9216
    ds_read_b64_tr_b16 v[164:165], v229 offset:8192
    v_mfma_f32_32x32x16_bf16 v[80:95], v[180:183], v[20:23], v[80:95]
    ds_read_b64_tr_b16 v[166:167], v229 offset:9216
    ds_read_b64_tr_b16 v[168:169], v230 offset:8192
    ds_read_b64_tr_b16 v[170:171], v230 offset:9216
    ds_read_b64_tr_b16 v[172:173], v231 offset:8192
    ds_read_b64_tr_b16 v[174:175], v231 offset:9216
    v_mfma_f32_32x32x16_bf16 v[96:111], v[184:187], v[20:23], v[96:111]
    s_waitcnt vmcnt(11)
    s_nop 0
    v_fma_mix_f32 v224, v24, v128, v132 op_sel:[0,0,0] op_sel_hi:[1,1,1]
    v_fma_mix_f32 v225, v24, v128, v132 op_sel:[1,1,1] op_sel_hi:[1,1,1]
    v_cvt_pk_bf16_f32 v24, v224, v225
    v_fma_mix_f32 v226, v25, v129, v133 op_sel:[0,0,0] op_sel_hi:[1,1,1]
    v_fma_mix_f32 v227, v25, v129, v133 op_sel:[1,1,1] op_sel_hi:[1,1,1]
    v_cvt_pk_bf16_f32 v25, v226, v227
    s_add_u32 m0, s97, 66560
    s_add_u32 s57, s96, 998400
    buffer_load_dwordx4 v233, s[12:15], s57 offen lds
    v_mfma_f32_32x32x16_bf16 v[112:127], v[188:191], v[20:23], v[112:127]
    v_fma_mix_f32 v224, v26, v130, v134 op_sel:[0,0,0] op_sel_hi:[1,1,1]
    v_fma_mix_f32 v225, v26, v130, v134 op_sel:[1,1,1] op_sel_hi:[1,1,1]
    v_cvt_pk_bf16_f32 v26, v224, v225
    v_fma_mix_f32 v226, v27, v131, v135 op_sel:[0,0,0] op_sel_hi:[1,1,1]
    v_fma_mix_f32 v227, v27, v131, v135 op_sel:[1,1,1] op_sel_hi:[1,1,1]
    v_cvt_pk_bf16_f32 v27, v226, v227
    buffer_load_dwordx4 v[20:23], v2, s[36:39], s98 offen offset:1024 sc1
    s_waitcnt lgkmcnt(0)
    s_nop 0
    v_mfma_f32_32x32x16_bf16 v[64:79], v[160:163], v[24:27], v[64:79]
    ds_read_b128 v[128:131], v232 offset:128
    ds_read_b128 v[132:135], v232 offset:1408
    ds_read_b64_tr_b16 v[176:177], v228 offset:12288
    ds_read_b64_tr_b16 v[178:179], v228 offset:13312
    ds_read_b64_tr_b16 v[180:181], v229 offset:12288
    v_mfma_f32_32x32x16_bf16 v[80:95], v[164:167], v[24:27], v[80:95]
    ds_read_b64_tr_b16 v[182:183], v229 offset:13312
    ds_read_b64_tr_b16 v[184:185], v230 offset:12288
    ds_read_b64_tr_b16 v[186:187], v230 offset:13312
    ds_read_b64_tr_b16 v[188:189], v231 offset:12288
    ds_read_b64_tr_b16 v[190:191], v231 offset:13312
    v_mfma_f32_32x32x16_bf16 v[96:111], v[168:171], v[24:27], v[96:111]
    s_waitcnt vmcnt(12)
    s_nop 0
    v_fma_mix_f32 v224, v28, v136, v140 op_sel:[0,0,0] op_sel_hi:[1,1,1]
    v_fma_mix_f32 v225, v28, v136, v140 op_sel:[1,1,1] op_sel_hi:[1,1,1]
    v_cvt_pk_bf16_f32 v28, v224, v225
    v_fma_mix_f32 v226, v29, v137, v141 op_sel:[0,0,0] op_sel_hi:[1,1,1]
    v_fma_mix_f32 v227, v29, v137, v141 op_sel:[1,1,1] op_sel_hi:[1,1,1]
    v_cvt_pk_bf16_f32 v29, v226, v227
    s_add_u32 m0, s97, 67584
    s_add_u32 s57, s96, 1013760
    buffer_load_dwordx4 v233, s[12:15], s57 offen lds
    v_mfma_f32_32x32x16_bf16 v[112:127], v[172:175], v[24:27], v[112:127]
    v_fma_mix_f32 v224, v30, v138, v142 op_sel:[0,0,0] op_sel_hi:[1,1,1]
    v_fma_mix_f32 v225, v30, v138, v142 op_sel:[1,1,1] op_sel_hi:[1,1,1]
    v_cvt_pk_bf16_f32 v30, v224, v225
    v_fma_mix_f32 v226, v31, v139, v143 op_sel:[0,0,0] op_sel_hi:[1,1,1]
    v_fma_mix_f32 v227, v31, v139, v143 op_sel:[1,1,1] op_sel_hi:[1,1,1]
    v_cvt_pk_bf16_f32 v31, v226, v227
    buffer_load_dwordx4 v[24:27], v2, s[36:39], s98 offen offset:2048 sc1
    s_waitcnt lgkmcnt(0)
    s_nop 0
    v_mfma_f32_32x32x16_bf16 v[64:79], v[176:179], v[28:31], v[64:79]
    ds_read_b128 v[136:139], v232 offset:160
    ds_read_b128 v[140:143], v232 offset:1440
    ds_read_b64_tr_b16 v[160:161], v228 offset:16384
    ds_read_b64_tr_b16 v[162:163], v228 offset:17408
    ds_read_b64_tr_b16 v[164:165], v229 offset:16384
    v_mfma_f32_32x32x16_bf16 v[80:95], v[180:183], v[28:31], v[80:95]
    ds_read_b64_tr_b16 v[166:167], v229 offset:17408
    ds_read_b64_tr_b16 v[168:169], v230 offset:16384
    ds_read_b64_tr_b16 v[170:171], v230 offset:17408
    ds_read_b64_tr_b16 v[172:173], v231 offset:16384
    ds_read_b64_tr_b16 v[174:175], v231 offset:17408
    v_mfma_f32_32x32x16_bf16 v[96:111], v[184:187], v[28:31], v[96:111]
    s_waitcnt vmcnt(13)
    s_nop 0
    v_fma_mix_f32 v224, v32, v128, v132 op_sel:[0,0,0] op_sel_hi:[1,1,1]
    v_fma_mix_f32 v225, v32, v128, v132 op_sel:[1,1,1] op_sel_hi:[1,1,1]
    v_cvt_pk_bf16_f32 v32, v224, v225
    v_fma_mix_f32 v226, v33, v129, v133 op_sel:[0,0,0] op_sel_hi:[1,1,1]
    v_fma_mix_f32 v227, v33, v129, v133 op_sel:[1,1,1] op_sel_hi:[1,1,1]
    v_cvt_pk_bf16_f32 v33, v226, v227
    s_add_u32 m0, s97, 68608
    s_add_u32 s57, s96, 1029120
    buffer_load_dwordx4 v233, s[12:15], s57 offen lds
    v_mfma_f32_32x32x16_bf16 v[112:127], v[188:191], v[28:31], v[112:127]
    v_fma_mix_f32 v224, v34, v130, v134 op_sel:[0,0,0] op_sel_hi:[1,1,1]
    v_fma_mix_f32 v225, v34, v130, v134 op_sel:[1,1,1] op_sel_hi:[1,1,1]
    v_cvt_pk_bf16_f32 v34, v224, v225
    v_fma_mix_f32 v226, v35, v131, v135 op_sel:[0,0,0] op_sel_hi:[1,1,1]
    v_fma_mix_f32 v227, v35, v131, v135 op_sel:[1,1,1] op_sel_hi:[1,1,1]
    v_cvt_pk_bf16_f32 v35, v226, v227
    buffer_load_dwordx4 v[28:31], v2, s[36:39], s98 offen offset:3072 sc1
    s_waitcnt lgkmcnt(0)
    s_nop 0
    v_mfma_f32_32x32x16_bf16 v[64:79], v[160:163], v[32:35], v[64:79]
    ds_read_b128 v[128:131], v232 offset:192
    ds_read_b128 v[132:135], v232 offset:1472
    ds_read_b64_tr_b16 v[176:177], v228 offset:20480
    ds_read_b64_tr_b16 v[178:179], v228 offset:21504
    ds_read_b64_tr_b16 v[180:181], v229 offset:20480
    v_mfma_f32_32x32x16_bf16 v[80:95], v[164:167], v[32:35], v[80:95]
    ds_read_b64_tr_b16 v[182:183], v229 offset:21504
    ds_read_b64_tr_b16 v[184:185], v230 offset:20480
    ds_read_b64_tr_b16 v[186:187], v230 offset:21504
    ds_read_b64_tr_b16 v[188:189], v231 offset:20480
    ds_read_b64_tr_b16 v[190:191], v231 offset:21504
    v_mfma_f32_32x32x16_bf16 v[96:111], v[168:171], v[32:35], v[96:111]
    s_waitcnt vmcnt(14)
    s_nop 0
    v_fma_mix_f32 v224, v36, v136, v140 op_sel:[0,0,0] op_sel_hi:[1,1,1]
    v_fma_mix_f32 v225, v36, v136, v140 op_sel:[1,1,1] op_sel_hi:[1,1,1]
    v_cvt_pk_bf16_f32 v36, v224, v225
    v_fma_mix_f32 v226, v37, v137, v141 op_sel:[0,0,0] op_sel_hi:[1,1,1]
    v_fma_mix_f32 v227, v37, v137, v141 op_sel:[1,1,1] op_sel_hi:[1,1,1]
    v_cvt_pk_bf16_f32 v37, v226, v227
    s_add_u32 m0, s97, 81920
    s_add_u32 s57, s96, 1228800
    buffer_load_dwordx4 v233, s[12:15], s57 offen lds
    v_mfma_f32_32x32x16_bf16 v[112:127], v[172:175], v[32:35], v[112:127]
    v_fma_mix_f32 v224, v38, v138, v142 op_sel:[0,0,0] op_sel_hi:[1,1,1]
    v_fma_mix_f32 v225, v38, v138, v142 op_sel:[1,1,1] op_sel_hi:[1,1,1]
    v_cvt_pk_bf16_f32 v38, v224, v225
    v_fma_mix_f32 v226, v39, v139, v143 op_sel:[0,0,0] op_sel_hi:[1,1,1]
    v_fma_mix_f32 v227, v39, v139, v143 op_sel:[1,1,1] op_sel_hi:[1,1,1]
    v_cvt_pk_bf16_f32 v39, v226, v227
    s_add_u32 s98, s98, 4096
    buffer_load_dwordx4 v[32:35], v2, s[36:39], s98 offen offset:0 sc1
    s_waitcnt lgkmcnt(0)
    s_nop 0
    v_mfma_f32_32x32x16_bf16 v[64:79], v[176:179], v[36:39], v[64:79]
    ds_read_b128 v[136:139], v232 offset:224
    ds_read_b128 v[140:143], v232 offset:1504
    ds_read_b64_tr_b16 v[160:161], v228 offset:24576
    ds_read_b64_tr_b16 v[162:163], v228 offset:25600
    ds_read_b64_tr_b16 v[164:165], v229 offset:24576
    v_mfma_f32_32x32x16_bf16 v[80:95], v[180:183], v[36:39], v[80:95]
    ds_read_b64_tr_b16 v[166:167], v229 offset:25600
    ds_read_b64_tr_b16 v[168:169], v230 offset:24576
    ds_read_b64_tr_b16 v[170:171], v230 offset:25600
    ds_read_b64_tr_b16 v[172:173], v231 offset:24576
    ds_read_b64_tr_b16 v[174:175], v231 offset:25600
    v_mfma_f32_32x32x16_bf16 v[96:111], v[184:187], v[36:39], v[96:111]
    s_waitcnt vmcnt(15)
    s_nop 0
    v_fma_mix_f32 v224, v40, v128, v132 op_sel:[0,0,0] op_sel_hi:[1,1,1]
    v_fma_mix_f32 v225, v40, v128, v132 op_sel:[1,1,1] op_sel_hi:[1,1,1]
    v_cvt_pk_bf16_f32 v40, v224, v225
    v_fma_mix_f32 v226, v41, v129, v133 op_sel:[0,0,0] op_sel_hi:[1,1,1]
    v_fma_mix_f32 v227, v41, v129, v133 op_sel:[1,1,1] op_sel_hi:[1,1,1]
    v_cvt_pk_bf16_f32 v41, v226, v227
    s_add_u32 m0, s97, 82944
    s_add_u32 s57, s96, 1244160
    buffer_load_dwordx4 v233, s[12:15], s57 offen lds
    v_mfma_f32_32x32x16_bf16 v[112:127], v[188:191], v[36:39], v[112:127]
    v_fma_mix_f32 v224, v42, v130, v134 op_sel:[0,0,0] op_sel_hi:[1,1,1]
    v_fma_mix_f32 v225, v42, v130, v134 op_sel:[1,1,1] op_sel_hi:[1,1,1]
    v_cvt_pk_bf16_f32 v42, v224, v225
    v_fma_mix_f32 v226, v43, v131, v135 op_sel:[0,0,0] op_sel_hi:[1,1,1]
    v_fma_mix_f32 v227, v43, v131, v135 op_sel:[1,1,1] op_sel_hi:[1,1,1]
    v_cvt_pk_bf16_f32 v43, v226, v227
    buffer_load_dwordx4 v[36:39], v2, s[36:39], s98 offen offset:1024 sc1
    s_waitcnt lgkmcnt(0)
    s_nop 0
    v_mfma_f32_32x32x16_bf16 v[64:79], v[160:163], v[40:43], v[64:79]
    ds_read_b128 v[128:131], v232 offset:256
    ds_read_b128 v[132:135], v232 offset:1536
    ds_read_b64_tr_b16 v[176:177], v228 offset:28672
    ds_read_b64_tr_b16 v[178:179], v228 offset:29696
    ds_read_b64_tr_b16 v[180:181], v229 offset:28672
    v_mfma_f32_32x32x16_bf16 v[80:95], v[164:167], v[40:43], v[80:95]
    ds_read_b64_tr_b16 v[182:183], v229 offset:29696
    ds_read_b64_tr_b16 v[184:185], v230 offset:28672
    ds_read_b64_tr_b16 v[186:187], v230 offset:29696
    ds_read_b64_tr_b16 v[188:189], v231 offset:28672
    ds_read_b64_tr_b16 v[190:191], v231 offset:29696
    v_mfma_f32_32x32x16_bf16 v[96:111], v[168:171], v[40:43], v[96:111]
    s_waitcnt vmcnt(16)
    s_nop 0
    v_fma_mix_f32 v224, v44, v136, v140 op_sel:[0,0,0] op_sel_hi:[1,1,1]
    v_fma_mix_f32 v225, v44, v136, v140 op_sel:[1,1,1] op_sel_hi:[1,1,1]
    v_cvt_pk_bf16_f32 v44, v224, v225
    v_fma_mix_f32 v226, v45, v137, v141 op_sel:[0,0,0] op_sel_hi:[1,1,1]
    v_fma_mix_f32 v227, v45, v137, v141 op_sel:[1,1,1] op_sel_hi:[1,1,1]
    v_cvt_pk_bf16_f32 v45, v226, v227
    s_add_u32 m0, s97, 83968
    s_add_u32 s57, s96, 1259520
    buffer_load_dwordx4 v233, s[12:15], s57 offen lds
    v_mfma_f32_32x32x16_bf16 v[112:127], v[172:175], v[40:43], v[112:127]
    v_fma_mix_f32 v224, v46, v138, v142 op_sel:[0,0,0] op_sel_hi:[1,1,1]
    v_fma_mix_f32 v225, v46, v138, v142 op_sel:[1,1,1] op_sel_hi:[1,1,1]
    v_cvt_pk_bf16_f32 v46, v224, v225
    v_fma_mix_f32 v226, v47, v139, v143 op_sel:[0,0,0] op_sel_hi:[1,1,1]
    v_fma_mix_f32 v227, v47, v139, v143 op_sel:[1,1,1] op_sel_hi:[1,1,1]
    v_cvt_pk_bf16_f32 v47, v226, v227
    buffer_load_dwordx4 v[40:43], v2, s[36:39], s98 offen offset:2048 sc1
    s_waitcnt lgkmcnt(0)
    s_nop 0
    v_mfma_f32_32x32x16_bf16 v[64:79], v[176:179], v[44:47], v[64:79]
    ds_read_b128 v[136:139], v232 offset:288
    ds_read_b128 v[140:143], v232 offset:1568
    ds_read_b64_tr_b16 v[160:161], v228 offset:32768
    ds_read_b64_tr_b16 v[162:163], v228 offset:33792
    ds_read_b64_tr_b16 v[164:165], v229 offset:32768
    v_mfma_f32_32x32x16_bf16 v[80:95], v[180:183], v[44:47], v[80:95]
    ds_read_b64_tr_b16 v[166:167], v229 offset:33792
    ds_read_b64_tr_b16 v[168:169], v230 offset:32768
    ds_read_b64_tr_b16 v[170:171], v230 offset:33792
    ds_read_b64_tr_b16 v[172:173], v231 offset:32768
    ds_read_b64_tr_b16 v[174:175], v231 offset:33792
    v_mfma_f32_32x32x16_bf16 v[96:111], v[184:187], v[44:47], v[96:111]
    s_waitcnt vmcnt(17)
    s_nop 0
    v_fma_mix_f32 v224, v48, v128, v132 op_sel:[0,0,0] op_sel_hi:[1,1,1]
    v_fma_mix_f32 v225, v48, v128, v132 op_sel:[1,1,1] op_sel_hi:[1,1,1]
    v_cvt_pk_bf16_f32 v48, v224, v225
    v_fma_mix_f32 v226, v49, v129, v133 op_sel:[0,0,0] op_sel_hi:[1,1,1]
    v_fma_mix_f32 v227, v49, v129, v133 op_sel:[1,1,1] op_sel_hi:[1,1,1]
    v_cvt_pk_bf16_f32 v49, v226, v227
    s_add_u32 m0, s97, 84992
    s_add_u32 s57, s96, 1274880
    buffer_load_dwordx4 v233, s[12:15], s57 offen lds
    v_mfma_f32_32x32x16_bf16 v[112:127], v[188:191], v[44:47], v[112:127]
    v_fma_mix_f32 v224, v50, v130, v134 op_sel:[0,0,0] op_sel_hi:[1,1,1]
    v_fma_mix_f32 v225, v50, v130, v134 op_sel:[1,1,1] op_sel_hi:[1,1,1]
    v_cvt_pk_bf16_f32 v50, v224, v225
    v_fma_mix_f32 v226, v51, v131, v135 op_sel:[0,0,0] op_sel_hi:[1,1,1]
    v_fma_mix_f32 v227, v51, v131, v135 op_sel:[1,1,1] op_sel_hi:[1,1,1]
    v_cvt_pk_bf16_f32 v51, v226, v227
    buffer_load_dwordx4 v[44:47], v2, s[36:39], s98 offen offset:3072 sc1
    s_waitcnt lgkmcnt(0)
    s_nop 0
    v_mfma_f32_32x32x16_bf16 v[64:79], v[160:163], v[48:51], v[64:79]
    ds_read_b128 v[128:131], v232 offset:320
    ds_read_b128 v[132:135], v232 offset:1600
    ds_read_b64_tr_b16 v[176:177], v228 offset:36864
    ds_read_b64_tr_b16 v[178:179], v228 offset:37888
    ds_read_b64_tr_b16 v[180:181], v229 offset:36864
    v_mfma_f32_32x32x16_bf16 v[80:95], v[164:167], v[48:51], v[80:95]
    ds_read_b64_tr_b16 v[182:183], v229 offset:37888
    ds_read_b64_tr_b16 v[184:185], v230 offset:36864
    ds_read_b64_tr_b16 v[186:187], v230 offset:37888
    ds_read_b64_tr_b16 v[188:189], v231 offset:36864
    ds_read_b64_tr_b16 v[190:191], v231 offset:37888
    v_mfma_f32_32x32x16_bf16 v[96:111], v[168:171], v[48:51], v[96:111]
    s_waitcnt vmcnt(18)
    s_nop 0
    v_fma_mix_f32 v224, v52, v136, v140 op_sel:[0,0,0] op_sel_hi:[1,1,1]
    v_fma_mix_f32 v225, v52, v136, v140 op_sel:[1,1,1] op_sel_hi:[1,1,1]
    v_cvt_pk_bf16_f32 v52, v224, v225
    v_fma_mix_f32 v226, v53, v137, v141 op_sel:[0,0,0] op_sel_hi:[1,1,1]
    v_fma_mix_f32 v227, v53, v137, v141 op_sel:[1,1,1] op_sel_hi:[1,1,1]
    v_cvt_pk_bf16_f32 v53, v226, v227
    s_add_u32 m0, s97, 98304
    s_add_u32 s57, s96, 1474560
    buffer_load_dwordx4 v233, s[12:15], s57 offen lds
    v_mfma_f32_32x32x16_bf16 v[112:127], v[172:175], v[48:51], v[112:127]
    v_fma_mix_f32 v224, v54, v138, v142 op_sel:[0,0,0] op_sel_hi:[1,1,1]
    v_fma_mix_f32 v225, v54, v138, v142 op_sel:[1,1,1] op_sel_hi:[1,1,1]
    v_cvt_pk_bf16_f32 v54, v224, v225
    v_fma_mix_f32 v226, v55, v139, v143 op_sel:[0,0,0] op_sel_hi:[1,1,1]
    v_fma_mix_f32 v227, v55, v139, v143 op_sel:[1,1,1] op_sel_hi:[1,1,1]
    v_cvt_pk_bf16_f32 v55, v226, v227
    s_add_u32 s98, s98, 4096
    buffer_load_dwordx4 v[48:51], v2, s[36:39], s98 offen offset:0 sc1
    s_waitcnt lgkmcnt(0)
    s_nop 0
    v_mfma_f32_32x32x16_bf16 v[64:79], v[176:179], v[52:55], v[64:79]
    ds_read_b128 v[136:139], v232 offset:352
    ds_read_b128 v[140:143], v232 offset:1632
    ds_read_b64_tr_b16 v[160:161], v228 offset:40960
    ds_read_b64_tr_b16 v[162:163], v228 offset:41984
    ds_read_b64_tr_b16 v[164:165], v229 offset:40960
    v_mfma_f32_32x32x16_bf16 v[80:95], v[180:183], v[52:55], v[80:95]
    ds_read_b64_tr_b16 v[166:167], v229 offset:41984
    ds_read_b64_tr_b16 v[168:169], v230 offset:40960
    ds_read_b64_tr_b16 v[170:171], v230 offset:41984
    ds_read_b64_tr_b16 v[172:173], v231 offset:40960
    ds_read_b64_tr_b16 v[174:175], v231 offset:41984
    v_mfma_f32_32x32x16_bf16 v[96:111], v[184:187], v[52:55], v[96:111]
    s_waitcnt vmcnt(19)
    s_nop 0
    v_fma_mix_f32 v224, v56, v128, v132 op_sel:[0,0,0] op_sel_hi:[1,1,1]
    v_fma_mix_f32 v225, v56, v128, v132 op_sel:[1,1,1] op_sel_hi:[1,1,1]
    v_cvt_pk_bf16_f32 v56, v224, v225
    v_fma_mix_f32 v226, v57, v129, v133 op_sel:[0,0,0] op_sel_hi:[1,1,1]
    v_fma_mix_f32 v227, v57, v129, v133 op_sel:[1,1,1] op_sel_hi:[1,1,1]
    v_cvt_pk_bf16_f32 v57, v226, v227
    s_add_u32 m0, s97, 99328
    s_add_u32 s57, s96, 1489920
    buffer_load_dwordx4 v233, s[12:15], s57 offen lds
    v_mfma_f32_32x32x16_bf16 v[112:127], v[188:191], v[52:55], v[112:127]
    v_fma_mix_f32 v224, v58, v130, v134 op_sel:[0,0,0] op_sel_hi:[1,1,1]
    v_fma_mix_f32 v225, v58, v130, v134 op_sel:[1,1,1] op_sel_hi:[1,1,1]
    v_cvt_pk_bf16_f32 v58, v224, v225
    v_fma_mix_f32 v226, v59, v131, v135 op_sel:[0,0,0] op_sel_hi:[1,1,1]
    v_fma_mix_f32 v227, v59, v131, v135 op_sel:[1,1,1] op_sel_hi:[1,1,1]
    v_cvt_pk_bf16_f32 v59, v226, v227
    buffer_load_dwordx4 v[52:55], v2, s[36:39], s98 offen offset:1024 sc1
    s_waitcnt lgkmcnt(0)
    s_nop 0
    v_mfma_f32_32x32x16_bf16 v[64:79], v[160:163], v[56:59], v[64:79]
    ds_read_b128 v[128:131], v232 offset:384
    ds_read_b128 v[132:135], v232 offset:1664
    ds_read_b64_tr_b16 v[176:177], v228 offset:45056
    ds_read_b64_tr_b16 v[178:179], v228 offset:46080
    ds_read_b64_tr_b16 v[180:181], v229 offset:45056
    v_mfma_f32_32x32x16_bf16 v[80:95], v[164:167], v[56:59], v[80:95]
    ds_read_b64_tr_b16 v[182:183], v229 offset:46080
    ds_read_b64_tr_b16 v[184:185], v230 offset:45056
    ds_read_b64_tr_b16 v[186:187], v230 offset:46080
    ds_read_b64_tr_b16 v[188:189], v231 offset:45056
    ds_read_b64_tr_b16 v[190:191], v231 offset:46080
    v_mfma_f32_32x32x16_bf16 v[96:111], v[168:171], v[56:59], v[96:111]
    s_waitcnt vmcnt(20)
    s_nop 0
    v_fma_mix_f32 v224, v60, v136, v140 op_sel:[0,0,0] op_sel_hi:[1,1,1]
    v_fma_mix_f32 v225, v60, v136, v140 op_sel:[1,1,1] op_sel_hi:[1,1,1]
    v_cvt_pk_bf16_f32 v60, v224, v225
    v_fma_mix_f32 v226, v61, v137, v141 op_sel:[0,0,0] op_sel_hi:[1,1,1]
    v_fma_mix_f32 v227, v61, v137, v141 op_sel:[1,1,1] op_sel_hi:[1,1,1]
    v_cvt_pk_bf16_f32 v61, v226, v227
    s_add_u32 m0, s97, 100352
    s_add_u32 s57, s96, 1505280
    buffer_load_dwordx4 v233, s[12:15], s57 offen lds
    v_mfma_f32_32x32x16_bf16 v[112:127], v[172:175], v[56:59], v[112:127]
    v_fma_mix_f32 v224, v62, v138, v142 op_sel:[0,0,0] op_sel_hi:[1,1,1]
    v_fma_mix_f32 v225, v62, v138, v142 op_sel:[1,1,1] op_sel_hi:[1,1,1]
    v_cvt_pk_bf16_f32 v62, v224, v225
    v_fma_mix_f32 v226, v63, v139, v143 op_sel:[0,0,0] op_sel_hi:[1,1,1]
    v_fma_mix_f32 v227, v63, v139, v143 op_sel:[1,1,1] op_sel_hi:[1,1,1]
    v_cvt_pk_bf16_f32 v63, v226, v227
    buffer_load_dwordx4 v[56:59], v2, s[36:39], s98 offen offset:2048 sc1
    s_waitcnt lgkmcnt(0)
    s_nop 0
    v_mfma_f32_32x32x16_bf16 v[64:79], v[176:179], v[60:63], v[64:79]
    ds_read_b128 v[136:139], v232 offset:416
    ds_read_b128 v[140:143], v232 offset:1696
    ds_read_b64_tr_b16 v[160:161], v228 offset:49152
    ds_read_b64_tr_b16 v[162:163], v228 offset:50176
    ds_read_b64_tr_b16 v[164:165], v229 offset:49152
    v_mfma_f32_32x32x16_bf16 v[80:95], v[180:183], v[60:63], v[80:95]
    ds_read_b64_tr_b16 v[166:167], v229 offset:50176
    ds_read_b64_tr_b16 v[168:169], v230 offset:49152
    ds_read_b64_tr_b16 v[170:171], v230 offset:50176
    ds_read_b64_tr_b16 v[172:173], v231 offset:49152
    ds_read_b64_tr_b16 v[174:175], v231 offset:50176
    v_mfma_f32_32x32x16_bf16 v[96:111], v[184:187], v[60:63], v[96:111]
    s_waitcnt vmcnt(20)
    s_nop 0
    v_fma_mix_f32 v224, v16, v128, v132 op_sel:[0,0,0] op_sel_hi:[1,1,1]
    v_fma_mix_f32 v225, v16, v128, v132 op_sel:[1,1,1] op_sel_hi:[1,1,1]
    v_cvt_pk_bf16_f32 v16, v224, v225
    v_fma_mix_f32 v226, v17, v129, v133 op_sel:[0,0,0] op_sel_hi:[1,1,1]
    v_fma_mix_f32 v227, v17, v129, v133 op_sel:[1,1,1] op_sel_hi:[1,1,1]
    v_cvt_pk_bf16_f32 v17, v226, v227
    s_add_u32 m0, s97, 101376
    s_add_u32 s57, s96, 1520640
    buffer_load_dwordx4 v233, s[12:15], s57 offen lds
    v_mfma_f32_32x32x16_bf16 v[112:127], v[188:191], v[60:63], v[112:127]
    v_fma_mix_f32 v224, v18, v130, v134 op_sel:[0,0,0] op_sel_hi:[1,1,1]
    v_fma_mix_f32 v225, v18, v130, v134 op_sel:[1,1,1] op_sel_hi:[1,1,1]
    v_cvt_pk_bf16_f32 v18, v224, v225
    v_fma_mix_f32 v226, v19, v131, v135 op_sel:[0,0,0] op_sel_hi:[1,1,1]
    v_fma_mix_f32 v227, v19, v131, v135 op_sel:[1,1,1] op_sel_hi:[1,1,1]
    v_cvt_pk_bf16_f32 v19, v226, v227
    buffer_load_dwordx4 v[60:63], v2, s[36:39], s98 offen offset:3072 sc1
    s_waitcnt lgkmcnt(0)
    s_nop 0
    v_mfma_f32_32x32x16_bf16 v[64:79], v[160:163], v[16:19], v[64:79]
    ds_read_b128 v[128:131], v232 offset:448
    ds_read_b128 v[132:135], v232 offset:1728
    ds_read_b64_tr_b16 v[176:177], v228 offset:53248
    ds_read_b64_tr_b16 v[178:179], v228 offset:54272
    ds_read_b64_tr_b16 v[180:181], v229 offset:53248
    v_mfma_f32_32x32x16_bf16 v[80:95], v[164:167], v[16:19], v[80:95]
    ds_read_b64_tr_b16 v[182:183], v229 offset:54272
    ds_read_b64_tr_b16 v[184:185], v230 offset:53248
    ds_read_b64_tr_b16 v[186:187], v230 offset:54272
    ds_read_b64_tr_b16 v[188:189], v231 offset:53248
    ds_read_b64_tr_b16 v[190:191], v231 offset:54272
    v_mfma_f32_32x32x16_bf16 v[96:111], v[168:171], v[16:19], v[96:111]
    s_waitcnt vmcnt(20)
    s_nop 0
    v_fma_mix_f32 v224, v20, v136, v140 op_sel:[0,0,0] op_sel_hi:[1,1,1]
    v_fma_mix_f32 v225, v20, v136, v140 op_sel:[1,1,1] op_sel_hi:[1,1,1]
    v_cvt_pk_bf16_f32 v20, v224, v225
    v_fma_mix_f32 v226, v21, v137, v141 op_sel:[0,0,0] op_sel_hi:[1,1,1]
    v_fma_mix_f32 v227, v21, v137, v141 op_sel:[1,1,1] op_sel_hi:[1,1,1]
    v_cvt_pk_bf16_f32 v21, v226, v227
    s_add_u32 m0, s97, 114688
    s_add_u32 s57, s96, 1720320
    buffer_load_dwordx4 v233, s[12:15], s57 offen lds
    v_mfma_f32_32x32x16_bf16 v[112:127], v[172:175], v[16:19], v[112:127]
    v_fma_mix_f32 v224, v22, v138, v142 op_sel:[0,0,0] op_sel_hi:[1,1,1]
    v_fma_mix_f32 v225, v22, v138, v142 op_sel:[1,1,1] op_sel_hi:[1,1,1]
    v_cvt_pk_bf16_f32 v22, v224, v225
    v_fma_mix_f32 v226, v23, v139, v143 op_sel:[0,0,0] op_sel_hi:[1,1,1]
    v_fma_mix_f32 v227, v23, v139, v143 op_sel:[1,1,1] op_sel_hi:[1,1,1]
    v_cvt_pk_bf16_f32 v23, v226, v227
    s_add_u32 s98, s98, 4096
    buffer_load_dwordx4 v[16:19], v2, s[36:39], s98 offen offset:0 sc1
    s_waitcnt lgkmcnt(0)
    s_nop 0
    v_mfma_f32_32x32x16_bf16 v[64:79], v[176:179], v[20:23], v[64:79]
    ds_read_b128 v[136:139], v232 offset:480
    ds_read_b128 v[140:143], v232 offset:1760
    ds_read_b64_tr_b16 v[160:161], v228 offset:57344
    ds_read_b64_tr_b16 v[162:163], v228 offset:58368
    ds_read_b64_tr_b16 v[164:165], v229 offset:57344
    v_mfma_f32_32x32x16_bf16 v[80:95], v[180:183], v[20:23], v[80:95]
    ds_read_b64_tr_b16 v[166:167], v229 offset:58368
    ds_read_b64_tr_b16 v[168:169], v230 offset:57344
    ds_read_b64_tr_b16 v[170:171], v230 offset:58368
    ds_read_b64_tr_b16 v[172:173], v231 offset:57344
    ds_read_b64_tr_b16 v[174:175], v231 offset:58368
    v_mfma_f32_32x32x16_bf16 v[96:111], v[184:187], v[20:23], v[96:111]
    s_waitcnt vmcnt(20)
    s_nop 0
    v_fma_mix_f32 v224, v24, v128, v132 op_sel:[0,0,0] op_sel_hi:[1,1,1]
    v_fma_mix_f32 v225, v24, v128, v132 op_sel:[1,1,1] op_sel_hi:[1,1,1]
    v_cvt_pk_bf16_f32 v24, v224, v225
    v_fma_mix_f32 v226, v25, v129, v133 op_sel:[0,0,0] op_sel_hi:[1,1,1]
    v_fma_mix_f32 v227, v25, v129, v133 op_sel:[1,1,1] op_sel_hi:[1,1,1]
    v_cvt_pk_bf16_f32 v25, v226, v227
    s_add_u32 m0, s97, 115712
    s_add_u32 s57, s96, 1735680
    buffer_load_dwordx4 v233, s[12:15], s57 offen lds
    v_mfma_f32_32x32x16_bf16 v[112:127], v[188:191], v[20:23], v[112:127]
    v_fma_mix_f32 v224, v26, v130, v134 op_sel:[0,0,0] op_sel_hi:[1,1,1]
    v_fma_mix_f32 v225, v26, v130, v134 op_sel:[1,1,1] op_sel_hi:[1,1,1]
    v_cvt_pk_bf16_f32 v26, v224, v225
    v_fma_mix_f32 v226, v27, v131, v135 op_sel:[0,0,0] op_sel_hi:[1,1,1]
    v_fma_mix_f32 v227, v27, v131, v135 op_sel:[1,1,1] op_sel_hi:[1,1,1]
    v_cvt_pk_bf16_f32 v27, v226, v227
    buffer_load_dwordx4 v[20:23], v2, s[36:39], s98 offen offset:1024 sc1
    s_waitcnt lgkmcnt(0)
    s_nop 0
    v_mfma_f32_32x32x16_bf16 v[64:79], v[160:163], v[24:27], v[64:79]
    ds_read_b128 v[128:131], v232 offset:512
    ds_read_b128 v[132:135], v232 offset:1792
    ds_read_b64_tr_b16 v[176:177], v228 offset:61440
    ds_read_b64_tr_b16 v[178:179], v228 offset:62464
    ds_read_b64_tr_b16 v[180:181], v229 offset:61440
    v_mfma_f32_32x32x16_bf16 v[80:95], v[164:167], v[24:27], v[80:95]
    ds_read_b64_tr_b16 v[182:183], v229 offset:62464
    ds_read_b64_tr_b16 v[184:185], v230 offset:61440
    ds_read_b64_tr_b16 v[186:187], v230 offset:62464
    ds_read_b64_tr_b16 v[188:189], v231 offset:61440
    ds_read_b64_tr_b16 v[190:191], v231 offset:62464
    v_mfma_f32_32x32x16_bf16 v[96:111], v[168:171], v[24:27], v[96:111]
    s_waitcnt vmcnt(20)
    s_nop 0
    v_fma_mix_f32 v224, v28, v136, v140 op_sel:[0,0,0] op_sel_hi:[1,1,1]
    v_fma_mix_f32 v225, v28, v136, v140 op_sel:[1,1,1] op_sel_hi:[1,1,1]
    v_cvt_pk_bf16_f32 v28, v224, v225
    v_fma_mix_f32 v226, v29, v137, v141 op_sel:[0,0,0] op_sel_hi:[1,1,1]
    v_fma_mix_f32 v227, v29, v137, v141 op_sel:[1,1,1] op_sel_hi:[1,1,1]
    v_cvt_pk_bf16_f32 v29, v226, v227
    s_add_u32 m0, s97, 116736
    s_add_u32 s57, s96, 1751040
    buffer_load_dwordx4 v233, s[12:15], s57 offen lds
    v_mfma_f32_32x32x16_bf16 v[112:127], v[172:175], v[24:27], v[112:127]
    v_fma_mix_f32 v224, v30, v138, v142 op_sel:[0,0,0] op_sel_hi:[1,1,1]
    v_fma_mix_f32 v225, v30, v138, v142 op_sel:[1,1,1] op_sel_hi:[1,1,1]
    v_cvt_pk_bf16_f32 v30, v224, v225
    v_fma_mix_f32 v226, v31, v139, v143 op_sel:[0,0,0] op_sel_hi:[1,1,1]
    v_fma_mix_f32 v227, v31, v139, v143 op_sel:[1,1,1] op_sel_hi:[1,1,1]
    v_cvt_pk_bf16_f32 v31, v226, v227
    buffer_load_dwordx4 v[24:27], v2, s[36:39], s98 offen offset:2048 sc1
    s_waitcnt lgkmcnt(0)
    s_barrier
    v_mfma_f32_32x32x16_bf16 v[64:79], v[176:179], v[28:31], v[64:79]
    v_add_u32 v228, 0x10000, v228
    v_add_u32 v229, 0x10000, v229
    v_add_u32 v230, 0x10000, v230
    v_add_u32 v231, 0x10000, v231
    ds_read_b128 v[136:139], v232 offset:544
    ds_read_b128 v[140:143], v232 offset:1824
    ds_read_b64_tr_b16 v[160:161], v228 offset:0
    ds_read_b64_tr_b16 v[162:163], v228 offset:1024
    ds_read_b64_tr_b16 v[164:165], v229 offset:0
    v_mfma_f32_32x32x16_bf16 v[80:95], v[180:183], v[28:31], v[80:95]
    ds_read_b64_tr_b16 v[166:167], v229 offset:1024
    ds_read_b64_tr_b16 v[168:169], v230 offset:0
    ds_read_b64_tr_b16 v[170:171], v230 offset:1024
    ds_read_b64_tr_b16 v[172:173], v231 offset:0
    ds_read_b64_tr_b16 v[174:175], v231 offset:1024
    v_mfma_f32_32x32x16_bf16 v[96:111], v[184:187], v[28:31], v[96:111]
    s_waitcnt vmcnt(20)
    s_nop 0
    v_fma_mix_f32 v224, v32, v128, v132 op_sel:[0,0,0] op_sel_hi:[1,1,1]
    v_fma_mix_f32 v225, v32, v128, v132 op_sel:[1,1,1] op_sel_hi:[1,1,1]
    v_cvt_pk_bf16_f32 v32, v224, v225
    v_fma_mix_f32 v226, v33, v129, v133 op_sel:[0,0,0] op_sel_hi:[1,1,1]
    v_fma_mix_f32 v227, v33, v129, v133 op_sel:[1,1,1] op_sel_hi:[1,1,1]
    v_cvt_pk_bf16_f32 v33, v226, v227
    s_add_u32 m0, s97, 16384
    s_nop 0
    buffer_load_dwordx4 v208, s[64:67], 0 offen lds
    s_add_u32 m0, s97, 17408
    s_nop 0
    buffer_load_dwordx4 v209, s[64:67], 0 offen lds
    s_add_u32 m0, s97, 18432
    s_nop 0
    buffer_load_dwordx4 v210, s[64:67], 0 offen lds
    s_add_u32 m0, s97, 19456
    s_nop 0
    buffer_load_dwordx4 v211, s[64:67], 0 offen lds
    s_add_u32 m0, s97, 117760
    s_add_u32 s57, s96, 1766400
    buffer_load_dwordx4 v233, s[12:15], s57 offen lds
    v_mfma_f32_32x32x16_bf16 v[112:127], v[188:191], v[28:31], v[112:127]
    v_fma_mix_f32 v224, v34, v130, v134 op_sel:[0,0,0] op_sel_hi:[1,1,1]
    v_fma_mix_f32 v225, v34, v130, v134 op_sel:[1,1,1] op_sel_hi:[1,1,1]
    v_cvt_pk_bf16_f32 v34, v224, v225
    v_fma_mix_f32 v226, v35, v131, v135 op_sel:[0,0,0] op_sel_hi:[1,1,1]
    v_fma_mix_f32 v227, v35, v131, v135 op_sel:[1,1,1] op_sel_hi:[1,1,1]
    v_cvt_pk_bf16_f32 v35, v226, v227
    buffer_load_dwordx4 v[28:31], v2, s[36:39], s98 offen offset:3072 sc1
    s_waitcnt lgkmcnt(0)
    s_nop 0
    v_mfma_f32_32x32x16_bf16 v[64:79], v[160:163], v[32:35], v[64:79]
    ds_read_b128 v[128:131], v232 offset:576
    ds_read_b128 v[132:135], v232 offset:1856
    ds_read_b64_tr_b16 v[176:177], v228 offset:4096
    ds_read_b64_tr_b16 v[178:179], v228 offset:5120
    ds_read_b64_tr_b16 v[180:181], v229 offset:4096
    v_mfma_f32_32x32x16_bf16 v[80:95], v[164:167], v[32:35], v[80:95]
    ds_read_b64_tr_b16 v[182:183], v229 offset:5120
    ds_read_b64_tr_b16 v[184:185], v230 offset:4096
    ds_read_b64_tr_b16 v[186:187], v230 offset:5120
    ds_read_b64_tr_b16 v[188:189], v231 offset:4096
    ds_read_b64_tr_b16 v[190:191], v231 offset:5120
    v_mfma_f32_32x32x16_bf16 v[96:111], v[168:171], v[32:35], v[96:111]
    s_waitcnt vmcnt(24)
    s_nop 0
    v_fma_mix_f32 v224, v36, v136, v140 op_sel:[0,0,0] op_sel_hi:[1,1,1]
    v_fma_mix_f32 v225, v36, v136, v140 op_sel:[1,1,1] op_sel_hi:[1,1,1]
    v_cvt_pk_bf16_f32 v36, v224, v225
    v_fma_mix_f32 v226, v37, v137, v141 op_sel:[0,0,0] op_sel_hi:[1,1,1]
    v_fma_mix_f32 v227, v37, v137, v141 op_sel:[1,1,1] op_sel_hi:[1,1,1]
    v_cvt_pk_bf16_f32 v37, v226, v227
    s_add_u32 m0, s97, 131072
    s_add_u32 s57, s96, 1966080
    buffer_load_dwordx4 v233, s[12:15], s57 offen lds
    v_mfma_f32_32x32x16_bf16 v[112:127], v[172:175], v[32:35], v[112:127]
    v_fma_mix_f32 v224, v38, v138, v142 op_sel:[0,0,0] op_sel_hi:[1,1,1]
    v_fma_mix_f32 v225, v38, v138, v142 op_sel:[1,1,1] op_sel_hi:[1,1,1]
    v_cvt_pk_bf16_f32 v38, v224, v225
    v_fma_mix_f32 v226, v39, v139, v143 op_sel:[0,0,0] op_sel_hi:[1,1,1]
    v_fma_mix_f32 v227, v39, v139, v143 op_sel:[1,1,1] op_sel_hi:[1,1,1]
    v_cvt_pk_bf16_f32 v39, v226, v227
    s_add_u32 s98, s98, 4096
    buffer_load_dwordx4 v[32:35], v2, s[36:39], s98 offen offset:0 sc1
    s_waitcnt lgkmcnt(0)
    s_nop 0
    v_mfma_f32_32x32x16_bf16 v[64:79], v[176:179], v[36:39], v[64:79]
    ds_read_b128 v[136:139], v232 offset:608
    ds_read_b128 v[140:143], v232 offset:1888
    ds_read_b64_tr_b16 v[160:161], v228 offset:8192
    ds_read_b64_tr_b16 v[162:163], v228 offset:9216
    ds_read_b64_tr_b16 v[164:165], v229 offset:8192
    v_mfma_f32_32x32x16_bf16 v[80:95], v[180:183], v[36:39], v[80:95]
    ds_read_b64_tr_b16 v[166:167], v229 offset:9216
    ds_read_b64_tr_b16 v[168:169], v230 offset:8192
    ds_read_b64_tr_b16 v[170:171], v230 offset:9216
    ds_read_b64_tr_b16 v[172:173], v231 offset:8192
    ds_read_b64_tr_b16 v[174:175], v231 offset:9216
    v_mfma_f32_32x32x16_bf16 v[96:111], v[184:187], v[36:39], v[96:111]
    s_waitcnt vmcnt(24)
    s_nop 0
    v_fma_mix_f32 v224, v40, v128, v132 op_sel:[0,0,0] op_sel_hi:[1,1,1]
    v_fma_mix_f32 v225, v40, v128, v132 op_sel:[1,1,1] op_sel_hi:[1,1,1]
    v_cvt_pk_bf16_f32 v40, v224, v225
    v_fma_mix_f32 v226, v41, v129, v133 op_sel:[0,0,0] op_sel_hi:[1,1,1]
    v_fma_mix_f32 v227, v41, v129, v133 op_sel:[1,1,1] op_sel_hi:[1,1,1]
    v_cvt_pk_bf16_f32 v41, v226, v227
    s_add_u32 m0, s97, 132096
    s_add_u32 s57, s96, 1981440
    buffer_load_dwordx4 v233, s[12:15], s57 offen lds
    v_mfma_f32_32x32x16_bf16 v[112:127], v[188:191], v[36:39], v[112:127]
    v_fma_mix_f32 v224, v42, v130, v134 op_sel:[0,0,0] op_sel_hi:[1,1,1]
    v_fma_mix_f32 v225, v42, v130, v134 op_sel:[1,1,1] op_sel_hi:[1,1,1]
    v_cvt_pk_bf16_f32 v42, v224, v225
    v_fma_mix_f32 v226, v43, v131, v135 op_sel:[0,0,0] op_sel_hi:[1,1,1]
    v_fma_mix_f32 v227, v43, v131, v135 op_sel:[1,1,1] op_sel_hi:[1,1,1]
    v_cvt_pk_bf16_f32 v43, v226, v227
    buffer_load_dwordx4 v[36:39], v2, s[36:39], s98 offen offset:1024 sc1
    s_lshl_b32 s57, s56, 2
    s_add_u32 s57, s57, s55
    s_cmp_ge_u32 s57, 136
    s_cbranch_scc1 RL1_37
    s_add_u32 m0, s97, 32768
    s_nop 0
    buffer_load_dwordx4 v216, s[72:75], 0 offen lds
    s_add_u32 m0, s97, 33792
    s_nop 0
    buffer_load_dwordx4 v217, s[72:75], 0 offen lds
    s_add_u32 m0, s97, 34816
    s_nop 0
    buffer_load_dwordx4 v218, s[72:75], 0 offen lds
    s_add_u32 m0, s97, 35840
    s_nop 0
    buffer_load_dwordx4 v219, s[72:75], 0 offen lds
RL1_37:
    s_waitcnt lgkmcnt(0)
    v_mfma_f32_32x32x16_bf16 v[64:79], v[160:163], v[40:43], v[64:79]
    ds_read_b128 v[128:131], v232 offset:640
    ds_read_b128 v[132:135], v232 offset:1920
    ds_read_b64_tr_b16 v[176:177], v228 offset:12288
    ds_read_b64_tr_b16 v[178:179], v228 offset:13312
    ds_read_b64_tr_b16 v[180:181], v229 offset:12288
    v_mfma_f32_32x32x16_bf16 v[80:95], v[164:167], v[40:43], v[80:95]
    ds_read_b64_tr_b16 v[182:183], v229 offset:13312
    ds_read_b64_tr_b16 v[184:185], v230 offset:12288
    ds_read_b64_tr_b16 v[186:187], v230 offset:13312
    ds_read_b64_tr_b16 v[188:189], v231 offset:12288
    ds_read_b64_tr_b16 v[190:191], v231 offset:13312
    v_mfma_f32_32x32x16_bf16 v[96:111], v[168:171], v[40:43], v[96:111]
    s_waitcnt vmcnt(24)
    s_nop 0
    v_fma_mix_f32 v224, v44, v136, v140 op_sel:[0,0,0] op_sel_hi:[1,1,1]
    v_fma_mix_f32 v225, v44, v136, v140 op_sel:[1,1,1] op_sel_hi:[1,1,1]
    v_cvt_pk_bf16_f32 v44, v224, v225
    v_fma_mix_f32 v226, v45, v137, v141 op_sel:[0,0,0] op_sel_hi:[1,1,1]
    v_fma_mix_f32 v227, v45, v137, v141 op_sel:[1,1,1] op_sel_hi:[1,1,1]
    v_cvt_pk_bf16_f32 v45, v226, v227
    s_add_u32 m0, s97, 133120
    s_add_u32 s57, s96, 1996800
    buffer_load_dwordx4 v233, s[12:15], s57 offen lds
    v_mfma_f32_32x32x16_bf16 v[112:127], v[172:175], v[40:43], v[112:127]
    v_fma_mix_f32 v224, v46, v138, v142 op_sel:[0,0,0] op_sel_hi:[1,1,1]
    v_fma_mix_f32 v225, v46, v138, v142 op_sel:[1,1,1] op_sel_hi:[1,1,1]
    v_cvt_pk_bf16_f32 v46, v224, v225
    v_fma_mix_f32 v226, v47, v139, v143 op_sel:[0,0,0] op_sel_hi:[1,1,1]
    v_fma_mix_f32 v227, v47, v139, v143 op_sel:[1,1,1] op_sel_hi:[1,1,1]
    v_cvt_pk_bf16_f32 v47, v226, v227
    buffer_load_dwordx4 v[40:43], v2, s[36:39], s98 offen offset:2048 sc1
    s_barrier
    s_waitcnt lgkmcnt(0)
    v_mfma_f32_32x32x16_bf16 v[64:79], v[176:179], v[44:47], v[64:79]
    ds_read_b128 v[136:139], v232 offset:672
    ds_read_b128 v[140:143], v232 offset:1952
    ds_read_b64_tr_b16 v[160:161], v228 offset:16384
    ds_read_b64_tr_b16 v[162:163], v228 offset:17408
    ds_read_b64_tr_b16 v[164:165], v229 offset:16384
    v_mfma_f32_32x32x16_bf16 v[80:95], v[180:183], v[44:47], v[80:95]
    ds_read_b64_tr_b16 v[166:167], v229 offset:17408
    ds_read_b64_tr_b16 v[168:169], v230 offset:16384
    ds_read_b64_tr_b16 v[170:171], v230 offset:17408
    ds_read_b64_tr_b16 v[172:173], v231 offset:16384
    ds_read_b64_tr_b16 v[174:175], v231 offset:17408
    v_mfma_f32_32x32x16_bf16 v[96:111], v[184:187], v[44:47], v[96:111]
    s_waitcnt vmcnt(24)
    s_nop 0
    v_fma_mix_f32 v224, v48, v128, v132 op_sel:[0,0,0] op_sel_hi:[1,1,1]
    v_fma_mix_f32 v225, v48, v128, v132 op_sel:[1,1,1] op_sel_hi:[1,1,1]
    v_cvt_pk_bf16_f32 v48, v224, v225
    v_fma_mix_f32 v226, v49, v129, v133 op_sel:[0,0,0] op_sel_hi:[1,1,1]
    v_fma_mix_f32 v227, v49, v129, v133 op_sel:[1,1,1] op_sel_hi:[1,1,1]
    v_cvt_pk_bf16_f32 v49, v226, v227
    s_add_u32 m0, s97, 134144
    s_add_u32 s57, s96, 2012160
    buffer_load_dwordx4 v233, s[12:15], s57 offen lds
    v_mfma_f32_32x32x16_bf16 v[112:127], v[188:191], v[44:47], v[112:127]
    v_fma_mix_f32 v224, v50, v130, v134 op_sel:[0,0,0] op_sel_hi:[1,1,1]
    v_fma_mix_f32 v225, v50, v130, v134 op_sel:[1,1,1] op_sel_hi:[1,1,1]
    v_cvt_pk_bf16_f32 v50, v224, v225
    v_fma_mix_f32 v226, v51, v131, v135 op_sel:[0,0,0] op_sel_hi:[1,1,1]
    v_fma_mix_f32 v227, v51, v131, v135 op_sel:[1,1,1] op_sel_hi:[1,1,1]
    v_cvt_pk_bf16_f32 v51, v226, v227
    buffer_load_dwordx4 v[44:47], v2, s[36:39], s98 offen offset:3072 sc1
    s_waitcnt lgkmcnt(0)
    s_nop 0
    v_mfma_f32_32x32x16_bf16 v[64:79], v[160:163], v[48:51], v[64:79]
    ds_read_b128 v[128:131], v232 offset:704
    ds_read_b128 v[132:135], v232 offset:1984
    ds_read_b64_tr_b16 v[176:177], v228 offset:20480
    ds_read_b64_tr_b16 v[178:179], v228 offset:21504
    ds_read_b64_tr_b16 v[180:181], v229 offset:20480
    v_mfma_f32_32x32x16_bf16 v[80:95], v[164:167], v[48:51], v[80:95]
    ds_read_b64_tr_b16 v[182:183], v229 offset:21504
    ds_read_b64_tr_b16 v[184:185], v230 offset:20480
    ds_read_b64_tr_b16 v[186:187], v230 offset:21504
    ds_read_b64_tr_b16 v[188:189], v231 offset:20480
    ds_read_b64_tr_b16 v[190:191], v231 offset:21504
    v_mfma_f32_32x32x16_bf16 v[96:111], v[168:171], v[48:51], v[96:111]
    s_waitcnt vmcnt(24)
    s_nop 0
    v_fma_mix_f32 v224, v52, v136, v140 op_sel:[0,0,0] op_sel_hi:[1,1,1]
    v_fma_mix_f32 v225, v52, v136, v140 op_sel:[1,1,1] op_sel_hi:[1,1,1]
    v_cvt_pk_bf16_f32 v52, v224, v225
    v_fma_mix_f32 v226, v53, v137, v141 op_sel:[0,0,0] op_sel_hi:[1,1,1]
    v_fma_mix_f32 v227, v53, v137, v141 op_sel:[1,1,1] op_sel_hi:[1,1,1]
    v_cvt_pk_bf16_f32 v53, v226, v227
    s_add_u32 m0, s97, 0
    s_nop 0
    s_add_u32 s57, s96, 2211840
    buffer_load_dwordx4 v233, s[12:15], s57 offen lds
    v_mfma_f32_32x32x16_bf16 v[112:127], v[172:175], v[48:51], v[112:127]
    v_fma_mix_f32 v224, v54, v138, v142 op_sel:[0,0,0] op_sel_hi:[1,1,1]
    v_fma_mix_f32 v225, v54, v138, v142 op_sel:[1,1,1] op_sel_hi:[1,1,1]
    v_cvt_pk_bf16_f32 v54, v224, v225
    v_fma_mix_f32 v226, v55, v139, v143 op_sel:[0,0,0] op_sel_hi:[1,1,1]
    v_fma_mix_f32 v227, v55, v139, v143 op_sel:[1,1,1] op_sel_hi:[1,1,1]
    v_cvt_pk_bf16_f32 v55, v226, v227
    s_add_u32 s98, s98, 4096
    buffer_load_dwordx4 v[48:51], v2, s[36:39], s98 offen offset:0 sc1
    s_waitcnt lgkmcnt(0)
    s_nop 0
    v_mfma_f32_32x32x16_bf16 v[64:79], v[176:179], v[52:55], v[64:79]
    ds_read_b128 v[136:139], v232 offset:736
    ds_read_b128 v[140:143], v232 offset:2016
    ds_read_b64_tr_b16 v[160:161], v228 offset:24576
    ds_read_b64_tr_b16 v[162:163], v228 offset:25600
    ds_read_b64_tr_b16 v[164:165], v229 offset:24576
    v_mfma_f32_32x32x16_bf16 v[80:95], v[180:183], v[52:55], v[80:95]
    ds_read_b64_tr_b16 v[166:167], v229 offset:25600
    ds_read_b64_tr_b16 v[168:169], v230 offset:24576
    ds_read_b64_tr_b16 v[170:171], v230 offset:25600
    ds_read_b64_tr_b16 v[172:173], v231 offset:24576
    ds_read_b64_tr_b16 v[174:175], v231 offset:25600
    v_mfma_f32_32x32x16_bf16 v[96:111], v[184:187], v[52:55], v[96:111]
    s_waitcnt vmcnt(24)
    s_nop 0
    v_fma_mix_f32 v224, v56, v128, v132 op_sel:[0,0,0] op_sel_hi:[1,1,1]
    v_fma_mix_f32 v225, v56, v128, v132 op_sel:[1,1,1] op_sel_hi:[1,1,1]
    v_cvt_pk_bf16_f32 v56, v224, v225
    v_fma_mix_f32 v226, v57, v129, v133 op_sel:[0,0,0] op_sel_hi:[1,1,1]
    v_fma_mix_f32 v227, v57, v129, v133 op_sel:[1,1,1] op_sel_hi:[1,1,1]
    v_cvt_pk_bf16_f32 v57, v226, v227
    s_add_u32 m0, s97, 1024
    s_add_u32 s57, s96, 2227200
    buffer_load_dwordx4 v233, s[12:15], s57 offen lds
    v_mfma_f32_32x32x16_bf16 v[112:127], v[188:191], v[52:55], v[112:127]
    v_fma_mix_f32 v224, v58, v130, v134 op_sel:[0,0,0] op_sel_hi:[1,1,1]
    v_fma_mix_f32 v225, v58, v130, v134 op_sel:[1,1,1] op_sel_hi:[1,1,1]
    v_cvt_pk_bf16_f32 v58, v224, v225
    v_fma_mix_f32 v226, v59, v131, v135 op_sel:[0,0,0] op_sel_hi:[1,1,1]
    v_fma_mix_f32 v227, v59, v131, v135 op_sel:[1,1,1] op_sel_hi:[1,1,1]
    v_cvt_pk_bf16_f32 v59, v226, v227
    buffer_load_dwordx4 v[52:55], v2, s[36:39], s98 offen offset:1024 sc1
    s_waitcnt lgkmcnt(0)
    s_nop 0
    v_mfma_f32_32x32x16_bf16 v[64:79], v[160:163], v[56:59], v[64:79]
    ds_read_b128 v[128:131], v232 offset:768
    ds_read_b128 v[132:135], v232 offset:2048
    ds_read_b64_tr_b16 v[176:177], v228 offset:28672
    ds_read_b64_tr_b16 v[178:179], v228 offset:29696
    ds_read_b64_tr_b16 v[180:181], v229 offset:28672
    v_mfma_f32_32x32x16_bf16 v[80:95], v[164:167], v[56:59], v[80:95]
    ds_read_b64_tr_b16 v[182:183], v229 offset:29696
    ds_read_b64_tr_b16 v[184:185], v230 offset:28672
    ds_read_b64_tr_b16 v[186:187], v230 offset:29696
    ds_read_b64_tr_b16 v[188:189], v231 offset:28672
    ds_read_b64_tr_b16 v[190:191], v231 offset:29696
    v_mfma_f32_32x32x16_bf16 v[96:111], v[168:171], v[56:59], v[96:111]
    s_waitcnt vmcnt(24)
    s_nop 0
    v_fma_mix_f32 v224, v60, v136, v140 op_sel:[0,0,0] op_sel_hi:[1,1,1]
    v_fma_mix_f32 v225, v60, v136, v140 op_sel:[1,1,1] op_sel_hi:[1,1,1]
    v_cvt_pk_bf16_f32 v60, v224, v225
    v_fma_mix_f32 v226, v61, v137, v141 op_sel:[0,0,0] op_sel_hi:[1,1,1]
    v_fma_mix_f32 v227, v61, v137, v141 op_sel:[1,1,1] op_sel_hi:[1,1,1]
    v_cvt_pk_bf16_f32 v61, v226, v227
    s_add_u32 m0, s97, 2048
    s_add_u32 s57, s96, 2242560
    buffer_load_dwordx4 v233, s[12:15], s57 offen lds
    v_mfma_f32_32x32x16_bf16 v[112:127], v[172:175], v[56:59], v[112:127]
    v_fma_mix_f32 v224, v62, v138, v142 op_sel:[0,0,0] op_sel_hi:[1,1,1]
    v_fma_mix_f32 v225, v62, v138, v142 op_sel:[1,1,1] op_sel_hi:[1,1,1]
    v_cvt_pk_bf16_f32 v62, v224, v225
    v_fma_mix_f32 v226, v63, v139, v143 op_sel:[0,0,0] op_sel_hi:[1,1,1]
    v_fma_mix_f32 v227, v63, v139, v143 op_sel:[1,1,1] op_sel_hi:[1,1,1]
    v_cvt_pk_bf16_f32 v63, v226, v227
    buffer_load_dwordx4 v[56:59], v2, s[36:39], s98 offen offset:2048 sc1
    s_barrier
    s_waitcnt lgkmcnt(0)
    v_mfma_f32_32x32x16_bf16 v[64:79], v[176:179], v[60:63], v[64:79]
    ds_read_b128 v[136:139], v232 offset:800
    ds_read_b128 v[140:143], v232 offset:2080
    ds_read_b64_tr_b16 v[160:161], v228 offset:32768
    ds_read_b64_tr_b16 v[162:163], v228 offset:33792
    ds_read_b64_tr_b16 v[164:165], v229 offset:32768
    v_mfma_f32_32x32x16_bf16 v[80:95], v[180:183], v[60:63], v[80:95]
    ds_read_b64_tr_b16 v[166:167], v229 offset:33792
    ds_read_b64_tr_b16 v[168:169], v230 offset:32768
    ds_read_b64_tr_b16 v[170:171], v230 offset:33792
    ds_read_b64_tr_b16 v[172:173], v231 offset:32768
    ds_read_b64_tr_b16 v[174:175], v231 offset:33792
    v_mfma_f32_32x32x16_bf16 v[96:111], v[184:187], v[60:63], v[96:111]
    s_waitcnt vmcnt(24)
    s_nop 0
    v_fma_mix_f32 v224, v16, v128, v132 op_sel:[0,0,0] op_sel_hi:[1,1,1]
    v_fma_mix_f32 v225, v16, v128, v132 op_sel:[1,1,1] op_sel_hi:[1,1,1]
    v_cvt_pk_bf16_f32 v16, v224, v225
    v_fma_mix_f32 v226, v17, v129, v133 op_sel:[0,0,0] op_sel_hi:[1,1,1]
    v_fma_mix_f32 v227, v17, v129, v133 op_sel:[1,1,1] op_sel_hi:[1,1,1]
    v_cvt_pk_bf16_f32 v17, v226, v227
    s_add_u32 m0, s97, 3072
    s_add_u32 s57, s96, 2257920
    buffer_load_dwordx4 v233, s[12:15], s57 offen lds
    v_mfma_f32_32x32x16_bf16 v[112:127], v[188:191], v[60:63], v[112:127]
    v_fma_mix_f32 v224, v18, v130, v134 op_sel:[0,0,0] op_sel_hi:[1,1,1]
    v_fma_mix_f32 v225, v18, v130, v134 op_sel:[1,1,1] op_sel_hi:[1,1,1]
    v_cvt_pk_bf16_f32 v18, v224, v225
    v_fma_mix_f32 v226, v19, v131, v135 op_sel:[0,0,0] op_sel_hi:[1,1,1]
    v_fma_mix_f32 v227, v19, v131, v135 op_sel:[1,1,1] op_sel_hi:[1,1,1]
    v_cvt_pk_bf16_f32 v19, v226, v227
    buffer_load_dwordx4 v[60:63], v2, s[36:39], s98 offen offset:3072 sc1
    s_waitcnt lgkmcnt(0)
    s_nop 0
    v_mfma_f32_32x32x16_bf16 v[64:79], v[160:163], v[16:19], v[64:79]
    ds_read_b128 v[128:131], v232 offset:832
    ds_read_b128 v[132:135], v232 offset:2112
    ds_read_b64_tr_b16 v[176:177], v228 offset:36864
    ds_read_b64_tr_b16 v[178:179], v228 offset:37888
    ds_read_b64_tr_b16 v[180:181], v229 offset:36864
    v_mfma_f32_32x32x16_bf16 v[80:95], v[164:167], v[16:19], v[80:95]
    ds_read_b64_tr_b16 v[182:183], v229 offset:37888
    ds_read_b64_tr_b16 v[184:185], v230 offset:36864
    ds_read_b64_tr_b16 v[186:187], v230 offset:37888
    ds_read_b64_tr_b16 v[188:189], v231 offset:36864
    ds_read_b64_tr_b16 v[190:191], v231 offset:37888
    v_mfma_f32_32x32x16_bf16 v[96:111], v[168:171], v[16:19], v[96:111]
    s_waitcnt vmcnt(24)
    s_nop 0
    v_fma_mix_f32 v224, v20, v136, v140 op_sel:[0,0,0] op_sel_hi:[1,1,1]
    v_fma_mix_f32 v225, v20, v136, v140 op_sel:[1,1,1] op_sel_hi:[1,1,1]
    v_cvt_pk_bf16_f32 v20, v224, v225
    v_fma_mix_f32 v226, v21, v137, v141 op_sel:[0,0,0] op_sel_hi:[1,1,1]
    v_fma_mix_f32 v227, v21, v137, v141 op_sel:[1,1,1] op_sel_hi:[1,1,1]
    v_cvt_pk_bf16_f32 v21, v226, v227
    buffer_load_ushort a116, v235, s[40:43], s5 offen
    s_add_u32 s57, s4, 0
    s_nop 0
    buffer_load_dwordx4 a[96:99], v234, s[28:31], s57 offen
    v_mfma_f32_32x32x16_bf16 v[112:127], v[172:175], v[16:19], v[112:127]
    v_fma_mix_f32 v224, v22, v138, v142 op_sel:[0,0,0] op_sel_hi:[1,1,1]
    v_fma_mix_f32 v225, v22, v138, v142 op_sel:[1,1,1] op_sel_hi:[1,1,1]
    v_cvt_pk_bf16_f32 v22, v224, v225
    v_fma_mix_f32 v226, v23, v139, v143 op_sel:[0,0,0] op_sel_hi:[1,1,1]
    v_fma_mix_f32 v227, v23, v139, v143 op_sel:[1,1,1] op_sel_hi:[1,1,1]
    v_cvt_pk_bf16_f32 v23, v226, v227
    s_add_u32 s98, s98, 4096
    buffer_load_dwordx4 v[16:19], v2, s[36:39], s98 offen offset:0 sc1
    s_waitcnt lgkmcnt(0)
    s_nop 0
    v_mfma_f32_32x32x16_bf16 v[64:79], v[176:179], v[20:23], v[64:79]
    ds_read_b128 v[136:139], v232 offset:864
    ds_read_b128 v[140:143], v232 offset:2144
    ds_read_b64_tr_b16 v[160:161], v228 offset:40960
    ds_read_b64_tr_b16 v[162:163], v228 offset:41984
    ds_read_b64_tr_b16 v[164:165], v229 offset:40960
    v_mfma_f32_32x32x16_bf16 v[80:95], v[180:183], v[20:23], v[80:95]
    ds_read_b64_tr_b16 v[166:167], v229 offset:41984
    ds_read_b64_tr_b16 v[168:169], v230 offset:40960
    ds_read_b64_tr_b16 v[170:171], v230 offset:41984
    ds_read_b64_tr_b16 v[172:173], v231 offset:40960
    ds_read_b64_tr_b16 v[174:175], v231 offset:41984
    v_mfma_f32_32x32x16_bf16 v[96:111], v[184:187], v[20:23], v[96:111]
    s_waitcnt vmcnt(25)
    s_nop 0
    v_fma_mix_f32 v224, v24, v128, v132 op_sel:[0,0,0] op_sel_hi:[1,1,1]
    v_fma_mix_f32 v225, v24, v128, v132 op_sel:[1,1,1] op_sel_hi:[1,1,1]
    v_cvt_pk_bf16_f32 v24, v224, v225
    v_fma_mix_f32 v226, v25, v129, v133 op_sel:[0,0,0] op_sel_hi:[1,1,1]
    v_fma_mix_f32 v227, v25, v129, v133 op_sel:[1,1,1] op_sel_hi:[1,1,1]
    v_cvt_pk_bf16_f32 v25, v226, v227
    s_add_u32 s57, s4, 61440
    buffer_load_dwordx4 a[100:103], v234, s[28:31], s57 offen
    v_mfma_f32_32x32x16_bf16 v[112:127], v[188:191], v[20:23], v[112:127]
    v_fma_mix_f32 v224, v26, v130, v134 op_sel:[0,0,0] op_sel_hi:[1,1,1]
    v_fma_mix_f32 v225, v26, v130, v134 op_sel:[1,1,1] op_sel_hi:[1,1,1]
    v_cvt_pk_bf16_f32 v26, v224, v225
    v_fma_mix_f32 v226, v27, v131, v135 op_sel:[0,0,0] op_sel_hi:[1,1,1]
    v_fma_mix_f32 v227, v27, v131, v135 op_sel:[1,1,1] op_sel_hi:[1,1,1]
    v_cvt_pk_bf16_f32 v27, v226, v227
    buffer_load_dwordx4 v[20:23], v2, s[36:39], s98 offen offset:1024 sc1
    s_waitcnt lgkmcnt(0)
    s_nop 0
    v_mfma_f32_32x32x16_bf16 v[64:79], v[160:163], v[24:27], v[64:79]
    ds_read_b128 v[128:131], v232 offset:896
    ds_read_b128 v[132:135], v232 offset:2176
    ds_read_b64_tr_b16 v[176:177], v228 offset:45056
    ds_read_b64_tr_b16 v[178:179], v228 offset:46080
    ds_read_b64_tr_b16 v[180:181], v229 offset:45056
    v_mfma_f32_32x32x16_bf16 v[80:95], v[164:167], v[24:27], v[80:95]
    ds_read_b64_tr_b16 v[182:183], v229 offset:46080
    ds_read_b64_tr_b16 v[184:185], v230 offset:45056
    ds_read_b64_tr_b16 v[186:187], v230 offset:46080
    ds_read_b64_tr_b16 v[188:189], v231 offset:45056
    ds_read_b64_tr_b16 v[190:191], v231 offset:46080
    v_mfma_f32_32x32x16_bf16 v[96:111], v[168:171], v[24:27], v[96:111]
    s_waitcnt vmcnt(21)
    s_nop 0
    v_fma_mix_f32 v224, v28, v136, v140 op_sel:[0,0,0] op_sel_hi:[1,1,1]
    v_fma_mix_f32 v225, v28, v136, v140 op_sel:[1,1,1] op_sel_hi:[1,1,1]
    v_cvt_pk_bf16_f32 v28, v224, v225
    v_fma_mix_f32 v226, v29, v137, v141 op_sel:[0,0,0] op_sel_hi:[1,1,1]
    v_fma_mix_f32 v227, v29, v137, v141 op_sel:[1,1,1] op_sel_hi:[1,1,1]
    v_cvt_pk_bf16_f32 v29, v226, v227
    s_add_u32 s57, s4, 122880
    buffer_load_dwordx4 a[104:107], v234, s[28:31], s57 offen
    v_mfma_f32_32x32x16_bf16 v[112:127], v[172:175], v[24:27], v[112:127]
    v_fma_mix_f32 v224, v30, v138, v142 op_sel:[0,0,0] op_sel_hi:[1,1,1]
    v_fma_mix_f32 v225, v30, v138, v142 op_sel:[1,1,1] op_sel_hi:[1,1,1]
    v_cvt_pk_bf16_f32 v30, v224, v225
    v_fma_mix_f32 v226, v31, v139, v143 op_sel:[0,0,0] op_sel_hi:[1,1,1]
    v_fma_mix_f32 v227, v31, v139, v143 op_sel:[1,1,1] op_sel_hi:[1,1,1]
    v_cvt_pk_bf16_f32 v31, v226, v227
    buffer_load_dwordx4 v[24:27], v2, s[36:39], s98 offen offset:2048 sc1
    s_barrier
    s_waitcnt lgkmcnt(0)
    v_mfma_f32_32x32x16_bf16 v[64:79], v[176:179], v[28:31], v[64:79]
    ds_read_b128 v[136:139], v232 offset:928
    ds_read_b128 v[140:143], v232 offset:2208
    ds_read_b64_tr_b16 v[160:161], v228 offset:49152
    ds_read_b64_tr_b16 v[162:163], v228 offset:50176
    ds_read_b64_tr_b16 v[164:165], v229 offset:49152
    v_mfma_f32_32x32x16_bf16 v[80:95], v[180:183], v[28:31], v[80:95]
    ds_read_b64_tr_b16 v[166:167], v229 offset:50176
    ds_read_b64_tr_b16 v[168:169], v230 offset:49152
    ds_read_b64_tr_b16 v[170:171], v230 offset:50176
    ds_read_b64_tr_b16 v[172:173], v231 offset:49152
    ds_read_b64_tr_b16 v[174:175], v231 offset:50176
    v_mfma_f32_32x32x16_bf16 v[96:111], v[184:187], v[28:31], v[96:111]
    s_waitcnt vmcnt(21)
    s_nop 0
    v_fma_mix_f32 v224, v32, v128, v132 op_sel:[0,0,0] op_sel_hi:[1,1,1]
    v_fma_mix_f32 v225, v32, v128, v132 op_sel:[1,1,1] op_sel_hi:[1,1,1]
    v_cvt_pk_bf16_f32 v32, v224, v225
    v_fma_mix_f32 v226, v33, v129, v133 op_sel:[0,0,0] op_sel_hi:[1,1,1]
    v_fma_mix_f32 v227, v33, v129, v133 op_sel:[1,1,1] op_sel_hi:[1,1,1]
    v_cvt_pk_bf16_f32 v33, v226, v227
    s_add_u32 s57, s4, 184320
    buffer_load_dwordx4 a[108:111], v234, s[28:31], s57 offen
    v_mfma_f32_32x32x16_bf16 v[112:127], v[188:191], v[28:31], v[112:127]
    v_fma_mix_f32 v224, v34, v130, v134 op_sel:[0,0,0] op_sel_hi:[1,1,1]
    v_fma_mix_f32 v225, v34, v130, v134 op_sel:[1,1,1] op_sel_hi:[1,1,1]
    v_cvt_pk_bf16_f32 v34, v224, v225
    v_fma_mix_f32 v226, v35, v131, v135 op_sel:[0,0,0] op_sel_hi:[1,1,1]
    v_fma_mix_f32 v227, v35, v131, v135 op_sel:[1,1,1] op_sel_hi:[1,1,1]
    v_cvt_pk_bf16_f32 v35, v226, v227
    buffer_load_dwordx4 v[28:31], v2, s[36:39], s98 offen offset:3072 sc1
    s_waitcnt lgkmcnt(0)
    s_nop 0
    v_mfma_f32_32x32x16_bf16 v[64:79], v[160:163], v[32:35], v[64:79]
    ds_read_b128 v[128:131], v232 offset:960
    ds_read_b128 v[132:135], v232 offset:2240
    ds_read_b64_tr_b16 v[176:177], v228 offset:53248
    ds_read_b64_tr_b16 v[178:179], v228 offset:54272
    ds_read_b64_tr_b16 v[180:181], v229 offset:53248
    v_mfma_f32_32x32x16_bf16 v[80:95], v[164:167], v[32:35], v[80:95]
    ds_read_b64_tr_b16 v[182:183], v229 offset:54272
    ds_read_b64_tr_b16 v[184:185], v230 offset:53248
    ds_read_b64_tr_b16 v[186:187], v230 offset:54272
    ds_read_b64_tr_b16 v[188:189], v231 offset:53248
    ds_read_b64_tr_b16 v[190:191], v231 offset:54272
    v_mfma_f32_32x32x16_bf16 v[96:111], v[168:171], v[32:35], v[96:111]
    s_waitcnt vmcnt(21)
    s_nop 0
    v_fma_mix_f32 v224, v36, v136, v140 op_sel:[0,0,0] op_sel_hi:[1,1,1]
    v_fma_mix_f32 v225, v36, v136, v140 op_sel:[1,1,1] op_sel_hi:[1,1,1]
    v_cvt_pk_bf16_f32 v36, v224, v225
    v_fma_mix_f32 v226, v37, v137, v141 op_sel:[0,0,0] op_sel_hi:[1,1,1]
    v_fma_mix_f32 v227, v37, v137, v141 op_sel:[1,1,1] op_sel_hi:[1,1,1]
    v_cvt_pk_bf16_f32 v37, v226, v227
    s_add_u32 s57, s4, 245760
    buffer_load_dwordx4 a[112:115], v234, s[28:31], s57 offen
    v_mfma_f32_32x32x16_bf16 v[112:127], v[172:175], v[32:35], v[112:127]
    v_fma_mix_f32 v224, v38, v138, v142 op_sel:[0,0,0] op_sel_hi:[1,1,1]
    v_fma_mix_f32 v225, v38, v138, v142 op_sel:[1,1,1] op_sel_hi:[1,1,1]
    v_cvt_pk_bf16_f32 v38, v224, v225
    v_fma_mix_f32 v226, v39, v139, v143 op_sel:[0,0,0] op_sel_hi:[1,1,1]
    v_fma_mix_f32 v227, v39, v139, v143 op_sel:[1,1,1] op_sel_hi:[1,1,1]
    v_cvt_pk_bf16_f32 v39, v226, v227
    s_waitcnt lgkmcnt(0)
    s_nop 0
    v_mfma_f32_32x32x16_bf16 v[64:79], v[176:179], v[36:39], v[64:79]
    ds_read_b128 v[136:139], v232 offset:992
    ds_read_b128 v[140:143], v232 offset:2272
    ds_read_b64_tr_b16 v[160:161], v228 offset:57344
    ds_read_b64_tr_b16 v[162:163], v228 offset:58368
    ds_read_b64_tr_b16 v[164:165], v229 offset:57344
    v_mfma_f32_32x32x16_bf16 v[80:95], v[180:183], v[36:39], v[80:95]
    ds_read_b64_tr_b16 v[166:167], v229 offset:58368
    ds_read_b64_tr_b16 v[168:169], v230 offset:57344
    ds_read_b64_tr_b16 v[170:171], v230 offset:58368
    ds_read_b64_tr_b16 v[172:173], v231 offset:57344
    ds_read_b64_tr_b16 v[174:175], v231 offset:58368
    v_mfma_f32_32x32x16_bf16 v[96:111], v[184:187], v[36:39], v[96:111]
    s_waitcnt vmcnt(20)
    s_nop 0
    v_fma_mix_f32 v224, v40, v128, v132 op_sel:[0,0,0] op_sel_hi:[1,1,1]
    v_fma_mix_f32 v225, v40, v128, v132 op_sel:[1,1,1] op_sel_hi:[1,1,1]
    v_cvt_pk_bf16_f32 v40, v224, v225
    v_fma_mix_f32 v226, v41, v129, v133 op_sel:[0,0,0] op_sel_hi:[1,1,1]
    v_fma_mix_f32 v227, v41, v129, v133 op_sel:[1,1,1] op_sel_hi:[1,1,1]
    v_cvt_pk_bf16_f32 v41, v226, v227
    v_mfma_f32_32x32x16_bf16 v[112:127], v[188:191], v[36:39], v[112:127]
    v_fma_mix_f32 v224, v42, v130, v134 op_sel:[0,0,0] op_sel_hi:[1,1,1]
    v_fma_mix_f32 v225, v42, v130, v134 op_sel:[1,1,1] op_sel_hi:[1,1,1]
    v_cvt_pk_bf16_f32 v42, v224, v225
    v_fma_mix_f32 v226, v43, v131, v135 op_sel:[0,0,0] op_sel_hi:[1,1,1]
    v_fma_mix_f32 v227, v43, v131, v135 op_sel:[1,1,1] op_sel_hi:[1,1,1]
    v_cvt_pk_bf16_f32 v43, v226, v227
    s_waitcnt lgkmcnt(0)
    s_nop 0
    v_mfma_f32_32x32x16_bf16 v[64:79], v[160:163], v[40:43], v[64:79]
    ds_read_b128 v[128:131], v232 offset:1024
    ds_read_b128 v[132:135], v232 offset:2304
    ds_read_b64_tr_b16 v[176:177], v228 offset:61440
    ds_read_b64_tr_b16 v[178:179], v228 offset:62464
    ds_read_b64_tr_b16 v[180:181], v229 offset:61440
    v_mfma_f32_32x32x16_bf16 v[80:95], v[164:167], v[40:43], v[80:95]
    ds_read_b64_tr_b16 v[182:183], v229 offset:62464
    ds_read_b64_tr_b16 v[184:185], v230 offset:61440
    ds_read_b64_tr_b16 v[186:187], v230 offset:62464
    ds_read_b64_tr_b16 v[188:189], v231 offset:61440
    ds_read_b64_tr_b16 v[190:191], v231 offset:62464
    v_mfma_f32_32x32x16_bf16 v[96:111], v[168:171], v[40:43], v[96:111]
    s_waitcnt vmcnt(18)
    s_nop 0
    v_fma_mix_f32 v224, v44, v136, v140 op_sel:[0,0,0] op_sel_hi:[1,1,1]
    v_fma_mix_f32 v225, v44, v136, v140 op_sel:[1,1,1] op_sel_hi:[1,1,1]
    v_cvt_pk_bf16_f32 v44, v224, v225
    v_fma_mix_f32 v226, v45, v137, v141 op_sel:[0,0,0] op_sel_hi:[1,1,1]
    v_fma_mix_f32 v227, v45, v137, v141 op_sel:[1,1,1] op_sel_hi:[1,1,1]
    v_cvt_pk_bf16_f32 v45, v226, v227
    v_mfma_f32_32x32x16_bf16 v[112:127], v[172:175], v[40:43], v[112:127]
    v_fma_mix_f32 v224, v46, v138, v142 op_sel:[0,0,0] op_sel_hi:[1,1,1]
    v_fma_mix_f32 v225, v46, v138, v142 op_sel:[1,1,1] op_sel_hi:[1,1,1]
    v_cvt_pk_bf16_f32 v46, v224, v225
    v_fma_mix_f32 v226, v47, v139, v143 op_sel:[0,0,0] op_sel_hi:[1,1,1]
    v_fma_mix_f32 v227, v47, v139, v143 op_sel:[1,1,1] op_sel_hi:[1,1,1]
    v_cvt_pk_bf16_f32 v47, v226, v227
    s_barrier
    s_waitcnt lgkmcnt(0)
    v_mfma_f32_32x32x16_bf16 v[64:79], v[176:179], v[44:47], v[64:79]
    v_add_u32 v228, 0x10000, v228
    v_add_u32 v229, 0x10000, v229
    v_add_u32 v230, 0x10000, v230
    v_add_u32 v231, 0x10000, v231
    ds_read_b128 v[136:139], v232 offset:1056
    ds_read_b128 v[140:143], v232 offset:2336
    ds_read_b64_tr_b16 v[160:161], v228 offset:0
    ds_read_b64_tr_b16 v[162:163], v228 offset:1024
    ds_read_b64_tr_b16 v[164:165], v229 offset:0
    v_mfma_f32_32x32x16_bf16 v[80:95], v[180:183], v[44:47], v[80:95]
    ds_read_b64_tr_b16 v[166:167], v229 offset:1024
    ds_read_b64_tr_b16 v[168:169], v230 offset:0
    ds_read_b64_tr_b16 v[170:171], v230 offset:1024
    ds_read_b64_tr_b16 v[172:173], v231 offset:0
    ds_read_b64_tr_b16 v[174:175], v231 offset:1024
    v_mfma_f32_32x32x16_bf16 v[96:111], v[184:187], v[44:47], v[96:111]
    s_waitcnt vmcnt(16)
    s_nop 0
    v_fma_mix_f32 v224, v48, v128, v132 op_sel:[0,0,0] op_sel_hi:[1,1,1]
    v_fma_mix_f32 v225, v48, v128, v132 op_sel:[1,1,1] op_sel_hi:[1,1,1]
    v_cvt_pk_bf16_f32 v48, v224, v225
    v_fma_mix_f32 v226, v49, v129, v133 op_sel:[0,0,0] op_sel_hi:[1,1,1]
    v_fma_mix_f32 v227, v49, v129, v133 op_sel:[1,1,1] op_sel_hi:[1,1,1]
    v_cvt_pk_bf16_f32 v49, v226, v227
    v_mfma_f32_32x32x16_bf16 v[112:127], v[188:191], v[44:47], v[112:127]
    v_fma_mix_f32 v224, v50, v130, v134 op_sel:[0,0,0] op_sel_hi:[1,1,1]
    v_fma_mix_f32 v225, v50, v130, v134 op_sel:[1,1,1] op_sel_hi:[1,1,1]
    v_cvt_pk_bf16_f32 v50, v224, v225
    v_fma_mix_f32 v226, v51, v131, v135 op_sel:[0,0,0] op_sel_hi:[1,1,1]
    v_fma_mix_f32 v227, v51, v131, v135 op_sel:[1,1,1] op_sel_hi:[1,1,1]
    v_cvt_pk_bf16_f32 v51, v226, v227
    s_waitcnt lgkmcnt(0)
    s_nop 0
    v_mfma_f32_32x32x16_bf16 v[64:79], v[160:163], v[48:51], v[64:79]
    ds_read_b128 v[128:131], v232 offset:1088
    ds_read_b128 v[132:135], v232 offset:2368
    ds_read_b64_tr_b16 v[176:177], v228 offset:4096
    ds_read_b64_tr_b16 v[178:179], v228 offset:5120
    ds_read_b64_tr_b16 v[180:181], v229 offset:4096
    v_mfma_f32_32x32x16_bf16 v[80:95], v[164:167], v[48:51], v[80:95]
    ds_read_b64_tr_b16 v[182:183], v229 offset:5120
    ds_read_b64_tr_b16 v[184:185], v230 offset:4096
    ds_read_b64_tr_b16 v[186:187], v230 offset:5120
    ds_read_b64_tr_b16 v[188:189], v231 offset:4096
    ds_read_b64_tr_b16 v[190:191], v231 offset:5120
    v_mfma_f32_32x32x16_bf16 v[96:111], v[168:171], v[48:51], v[96:111]
    s_waitcnt vmcnt(14)
    s_nop 0
    v_fma_mix_f32 v224, v52, v136, v140 op_sel:[0,0,0] op_sel_hi:[1,1,1]
    v_fma_mix_f32 v225, v52, v136, v140 op_sel:[1,1,1] op_sel_hi:[1,1,1]
    v_cvt_pk_bf16_f32 v52, v224, v225
    v_fma_mix_f32 v226, v53, v137, v141 op_sel:[0,0,0] op_sel_hi:[1,1,1]
    v_fma_mix_f32 v227, v53, v137, v141 op_sel:[1,1,1] op_sel_hi:[1,1,1]
    v_cvt_pk_bf16_f32 v53, v226, v227
    ds_read_b64_tr_b16 v[192:193], v212
    ds_read_b64_tr_b16 v[194:195], v212 offset:512
    ds_read_b64_tr_b16 v[196:197], v213
    ds_read_b64_tr_b16 v[198:199], v213 offset:512
    ds_read_b64_tr_b16 v[200:201], v214
    s_waitcnt lgkmcnt(14)
    ds_read_b64_tr_b16 v[202:203], v214 offset:512
    s_waitcnt lgkmcnt(14)
    ds_read_b64_tr_b16 v[204:205], v215
    s_waitcnt lgkmcnt(14)
    s_nop 0
    ds_read_b64_tr_b16 v[206:207], v215 offset:512
    v_mfma_f32_32x32x16_bf16 v[112:127], v[172:175], v[48:51], v[112:127]
    v_fma_mix_f32 v224, v54, v138, v142 op_sel:[0,0,0] op_sel_hi:[1,1,1]
    v_fma_mix_f32 v225, v54, v138, v142 op_sel:[1,1,1] op_sel_hi:[1,1,1]
    v_cvt_pk_bf16_f32 v54, v224, v225
    v_fma_mix_f32 v226, v55, v139, v143 op_sel:[0,0,0] op_sel_hi:[1,1,1]
    v_fma_mix_f32 v227, v55, v139, v143 op_sel:[1,1,1] op_sel_hi:[1,1,1]
    v_cvt_pk_bf16_f32 v55, v226, v227
    s_waitcnt lgkmcnt(0)
    s_nop 0
    v_mfma_f32_32x32x16_bf16 v[64:79], v[176:179], v[52:55], v[64:79]
    ds_read_b128 v[136:139], v232 offset:1120
    ds_read_b128 v[140:143], v232 offset:2400
    ds_read_b64_tr_b16 v[160:161], v228 offset:8192
    ds_read_b64_tr_b16 v[162:163], v228 offset:9216
    ds_read_b64_tr_b16 v[164:165], v229 offset:8192
    v_mfma_f32_32x32x16_bf16 v[80:95], v[180:183], v[52:55], v[80:95]
    ds_read_b64_tr_b16 v[166:167], v229 offset:9216
    ds_read_b64_tr_b16 v[168:169], v230 offset:8192
    ds_read_b64_tr_b16 v[170:171], v230 offset:9216
    ds_read_b64_tr_b16 v[172:173], v231 offset:8192
    ds_read_b64_tr_b16 v[174:175], v231 offset:9216
    v_mfma_f32_32x32x16_bf16 v[96:111], v[184:187], v[52:55], v[96:111]
    s_waitcnt vmcnt(12)
    s_nop 0
    v_fma_mix_f32 v224, v56, v128, v132 op_sel:[0,0,0] op_sel_hi:[1,1,1]
    v_fma_mix_f32 v225, v56, v128, v132 op_sel:[1,1,1] op_sel_hi:[1,1,1]
    v_cvt_pk_bf16_f32 v56, v224, v225
    v_fma_mix_f32 v226, v57, v129, v133 op_sel:[0,0,0] op_sel_hi:[1,1,1]
    v_fma_mix_f32 v227, v57, v129, v133 op_sel:[1,1,1] op_sel_hi:[1,1,1]
    v_cvt_pk_bf16_f32 v57, v226, v227
    v_mfma_f32_32x32x16_bf16 v[112:127], v[188:191], v[52:55], v[112:127]
    v_fma_mix_f32 v224, v58, v130, v134 op_sel:[0,0,0] op_sel_hi:[1,1,1]
    v_fma_mix_f32 v225, v58, v130, v134 op_sel:[1,1,1] op_sel_hi:[1,1,1]
    v_cvt_pk_bf16_f32 v58, v224, v225
    v_fma_mix_f32 v226, v59, v131, v135 op_sel:[0,0,0] op_sel_hi:[1,1,1]
    v_fma_mix_f32 v227, v59, v131, v135 op_sel:[1,1,1] op_sel_hi:[1,1,1]
    v_cvt_pk_bf16_f32 v59, v226, v227
    s_waitcnt lgkmcnt(0)
    s_nop 0
    v_mfma_f32_32x32x16_bf16 v[64:79], v[160:163], v[56:59], v[64:79]
    ds_read_b128 v[128:131], v232 offset:1152
    ds_read_b128 v[132:135], v232 offset:2432
    ds_read_b64_tr_b16 v[176:177], v228 offset:12288
    ds_read_b64_tr_b16 v[178:179], v228 offset:13312
    ds_read_b64_tr_b16 v[180:181], v229 offset:12288
    v_mfma_f32_32x32x16_bf16 v[80:95], v[164:167], v[56:59], v[80:95]
    ds_read_b64_tr_b16 v[182:183], v229 offset:13312
    ds_read_b64_tr_b16 v[184:185], v230 offset:12288
    ds_read_b64_tr_b16 v[186:187], v230 offset:13312
    ds_read_b64_tr_b16 v[188:189], v231 offset:12288
    ds_read_b64_tr_b16 v[190:191], v231 offset:13312
    v_mfma_f32_32x32x16_bf16 v[96:111], v[168:171], v[56:59], v[96:111]
    s_waitcnt vmcnt(10)
    s_nop 0
    v_fma_mix_f32 v224, v60, v136, v140 op_sel:[0,0,0] op_sel_hi:[1,1,1]
    v_fma_mix_f32 v225, v60, v136, v140 op_sel:[1,1,1] op_sel_hi:[1,1,1]
    v_cvt_pk_bf16_f32 v60, v224, v225
    v_fma_mix_f32 v226, v61, v137, v141 op_sel:[0,0,0] op_sel_hi:[1,1,1]
    v_fma_mix_f32 v227, v61, v137, v141 op_sel:[1,1,1] op_sel_hi:[1,1,1]
    v_cvt_pk_bf16_f32 v61, v226, v227
    buffer_store_dwordx4 v[192:195], v2, s[36:39], s68 offen sc1
    buffer_store_dwordx4 v[196:199], v2, s[36:39], s69 offen sc1
    buffer_store_dwordx4 v[200:203], v2, s[36:39], s70 offen sc1
    buffer_store_dwordx4 v[204:207], v2, s[36:39], s71 offen sc1
    v_mfma_f32_32x32x16_bf16 v[112:127], v[172:175], v[56:59], v[112:127]
    v_fma_mix_f32 v224, v62, v138, v142 op_sel:[0,0,0] op_sel_hi:[1,1,1]
    v_fma_mix_f32 v225, v62, v138, v142 op_sel:[1,1,1] op_sel_hi:[1,1,1]
    v_cvt_pk_bf16_f32 v62, v224, v225
    v_fma_mix_f32 v226, v63, v139, v143 op_sel:[0,0,0] op_sel_hi:[1,1,1]
    v_fma_mix_f32 v227, v63, v139, v143 op_sel:[1,1,1] op_sel_hi:[1,1,1]
    v_cvt_pk_bf16_f32 v63, v226, v227
    s_barrier
    s_waitcnt lgkmcnt(0)
    v_mfma_f32_32x32x16_bf16 v[64:79], v[176:179], v[60:63], v[64:79]
    v_add_u32 v228, 0xfffe0000, v228
    v_add_u32 v229, 0xfffe0000, v229
    v_add_u32 v230, 0xfffe0000, v230
    v_add_u32 v231, 0xfffe0000, v231
    ds_read_b128 v[136:139], v232 offset:1184
    ds_read_b128 v[140:143], v232 offset:2464
    ds_read_b64_tr_b16 v[160:161], v228 offset:0
    ds_read_b64_tr_b16 v[162:163], v228 offset:1024
    ds_read_b64_tr_b16 v[164:165], v229 offset:0
    v_mfma_f32_32x32x16_bf16 v[80:95], v[180:183], v[60:63], v[80:95]
    ds_read_b64_tr_b16 v[166:167], v229 offset:1024
    ds_read_b64_tr_b16 v[168:169], v230 offset:0
    ds_read_b64_tr_b16 v[170:171], v230 offset:1024
    ds_read_b64_tr_b16 v[172:173], v231 offset:0
    ds_read_b64_tr_b16 v[174:175], v231 offset:1024
    v_mfma_f32_32x32x16_bf16 v[96:111], v[184:187], v[60:63], v[96:111]
    s_waitcnt vmcnt(11)
    s_nop 0
    v_fma_mix_f32 v224, v16, v128, v132 op_sel:[0,0,0] op_sel_hi:[1,1,1]
    v_fma_mix_f32 v225, v16, v128, v132 op_sel:[1,1,1] op_sel_hi:[1,1,1]
    v_cvt_pk_bf16_f32 v16, v224, v225
    v_fma_mix_f32 v226, v17, v129, v133 op_sel:[0,0,0] op_sel_hi:[1,1,1]
    v_fma_mix_f32 v227, v17, v129, v133 op_sel:[1,1,1] op_sel_hi:[1,1,1]
    v_cvt_pk_bf16_f32 v17, v226, v227
    v_mfma_f32_32x32x16_bf16 v[112:127], v[188:191], v[60:63], v[112:127]
    v_fma_mix_f32 v224, v18, v130, v134 op_sel:[0,0,0] op_sel_hi:[1,1,1]
    v_fma_mix_f32 v225, v18, v130, v134 op_sel:[1,1,1] op_sel_hi:[1,1,1]
    v_cvt_pk_bf16_f32 v18, v224, v225
    v_fma_mix_f32 v226, v19, v131, v135 op_sel:[0,0,0] op_sel_hi:[1,1,1]
    v_fma_mix_f32 v227, v19, v131, v135 op_sel:[1,1,1] op_sel_hi:[1,1,1]
    v_cvt_pk_bf16_f32 v19, v226, v227
    s_waitcnt lgkmcnt(0)
    s_nop 0
    v_mfma_f32_32x32x16_bf16 v[64:79], v[160:163], v[16:19], v[64:79]
    ds_read_b128 v[128:131], v232 offset:1216
    ds_read_b128 v[132:135], v232 offset:2496
    ds_read_b64_tr_b16 v[176:177], v228 offset:4096
    ds_read_b64_tr_b16 v[178:179], v228 offset:5120
    ds_read_b64_tr_b16 v[180:181], v229 offset:4096
    v_mfma_f32_32x32x16_bf16 v[80:95], v[164:167], v[16:19], v[80:95]
    ds_read_b64_tr_b16 v[182:183], v229 offset:5120
    ds_read_b64_tr_b16 v[184:185], v230 offset:4096
    ds_read_b64_tr_b16 v[186:187], v230 offset:5120
    ds_read_b64_tr_b16 v[188:189], v231 offset:4096
    ds_read_b64_tr_b16 v[190:191], v231 offset:5120
    v_mfma_f32_32x32x16_bf16 v[96:111], v[168:171], v[16:19], v[96:111]
    s_waitcnt vmcnt(9)
    s_nop 0
    v_fma_mix_f32 v224, v20, v136, v140 op_sel:[0,0,0] op_sel_hi:[1,1,1]
    v_fma_mix_f32 v225, v20, v136, v140 op_sel:[1,1,1] op_sel_hi:[1,1,1]
    v_cvt_pk_bf16_f32 v20, v224, v225
    v_fma_mix_f32 v226, v21, v137, v141 op_sel:[0,0,0] op_sel_hi:[1,1,1]
    v_fma_mix_f32 v227, v21, v137, v141 op_sel:[1,1,1] op_sel_hi:[1,1,1]
    v_cvt_pk_bf16_f32 v21, v226, v227
    v_mfma_f32_32x32x16_bf16 v[112:127], v[172:175], v[16:19], v[112:127]
    v_fma_mix_f32 v224, v22, v138, v142 op_sel:[0,0,0] op_sel_hi:[1,1,1]
    v_fma_mix_f32 v225, v22, v138, v142 op_sel:[1,1,1] op_sel_hi:[1,1,1]
    v_cvt_pk_bf16_f32 v22, v224, v225
    v_fma_mix_f32 v226, v23, v139, v143 op_sel:[0,0,0] op_sel_hi:[1,1,1]
    v_fma_mix_f32 v227, v23, v139, v143 op_sel:[1,1,1] op_sel_hi:[1,1,1]
    v_cvt_pk_bf16_f32 v23, v226, v227
    s_lshl_b32 s57, s56, 2
    s_add_u32 s57, s57, s55
    s_cmp_ge_u32 s57, 136
    s_cbranch_scc1 RL2_38
    s_nop 0
    ds_read_b64_tr_b16 v[192:193], v220
    ds_read_b64_tr_b16 v[194:195], v220 offset:512
    ds_read_b64_tr_b16 v[196:197], v221
    ds_read_b64_tr_b16 v[198:199], v221 offset:512
    ds_read_b64_tr_b16 v[200:201], v222
    ds_read_b64_tr_b16 v[202:203], v222 offset:512
    ds_read_b64_tr_b16 v[204:205], v223
    ds_read_b64_tr_b16 v[206:207], v223 offset:512
    s_waitcnt lgkmcnt(0)
    buffer_store_dwordx4 v[192:195], v2, s[36:39], s76 offen sc1
    buffer_store_dwordx4 v[196:199], v2, s[36:39], s77 offen sc1
    buffer_store_dwordx4 v[200:203], v2, s[36:39], s78 offen sc1
    buffer_store_dwordx4 v[204:207], v2, s[36:39], s79 offen sc1
RL2_38:
    s_waitcnt lgkmcnt(0)
    v_mfma_f32_32x32x16_bf16 v[64:79], v[176:179], v[20:23], v[64:79]
    ds_read_b128 v[136:139], v232 offset:1248
    ds_read_b128 v[140:143], v232 offset:2528
    ds_read_b64_tr_b16 v[160:161], v228 offset:8192
    ds_read_b64_tr_b16 v[162:163], v228 offset:9216
    ds_read_b64_tr_b16 v[164:165], v229 offset:8192
    v_mfma_f32_32x32x16_bf16 v[80:95], v[180:183], v[20:23], v[80:95]
    ds_read_b64_tr_b16 v[166:167], v229 offset:9216
    ds_read_b64_tr_b16 v[168:169], v230 offset:8192
    ds_read_b64_tr_b16 v[170:171], v230 offset:9216
    ds_read_b64_tr_b16 v[172:173], v231 offset:8192
    ds_read_b64_tr_b16 v[174:175], v231 offset:9216
    v_mfma_f32_32x32x16_bf16 v[96:111], v[184:187], v[20:23], v[96:111]
    s_waitcnt vmcnt(7)
    s_nop 0
    v_fma_mix_f32 v224, v24, v128, v132 op_sel:[0,0,0] op_sel_hi:[1,1,1]
    v_fma_mix_f32 v225, v24, v128, v132 op_sel:[1,1,1] op_sel_hi:[1,1,1]
    v_cvt_pk_bf16_f32 v24, v224, v225
    v_fma_mix_f32 v226, v25, v129, v133 op_sel:[0,0,0] op_sel_hi:[1,1,1]
    v_fma_mix_f32 v227, v25, v129, v133 op_sel:[1,1,1] op_sel_hi:[1,1,1]
    v_cvt_pk_bf16_f32 v25, v226, v227
    v_mfma_f32_32x32x16_bf16 v[112:127], v[188:191], v[20:23], v[112:127]
    v_fma_mix_f32 v224, v26, v130, v134 op_sel:[0,0,0] op_sel_hi:[1,1,1]
    v_fma_mix_f32 v225, v26, v130, v134 op_sel:[1,1,1] op_sel_hi:[1,1,1]
    v_cvt_pk_bf16_f32 v26, v224, v225
    v_fma_mix_f32 v226, v27, v131, v135 op_sel:[0,0,0] op_sel_hi:[1,1,1]
    v_fma_mix_f32 v227, v27, v131, v135 op_sel:[1,1,1] op_sel_hi:[1,1,1]
    v_cvt_pk_bf16_f32 v27, v226, v227
    s_waitcnt lgkmcnt(0)
    s_nop 0
    v_mfma_f32_32x32x16_bf16 v[64:79], v[160:163], v[24:27], v[64:79]
    ds_read_b64_tr_b16 v[176:177], v228 offset:12288
    ds_read_b64_tr_b16 v[178:179], v228 offset:13312
    ds_read_b64_tr_b16 v[180:181], v229 offset:12288
    v_mfma_f32_32x32x16_bf16 v[80:95], v[164:167], v[24:27], v[80:95]
    ds_read_b64_tr_b16 v[182:183], v229 offset:13312
    ds_read_b64_tr_b16 v[184:185], v230 offset:12288
    ds_read_b64_tr_b16 v[186:187], v230 offset:13312
    ds_read_b64_tr_b16 v[188:189], v231 offset:12288
    ds_read_b64_tr_b16 v[190:191], v231 offset:13312
    v_mfma_f32_32x32x16_bf16 v[96:111], v[168:171], v[24:27], v[96:111]
    s_waitcnt vmcnt(5)
    s_nop 0
    v_fma_mix_f32 v224, v28, v136, v140 op_sel:[0,0,0] op_sel_hi:[1,1,1]
    v_fma_mix_f32 v225, v28, v136, v140 op_sel:[1,1,1] op_sel_hi:[1,1,1]
    v_cvt_pk_bf16_f32 v28, v224, v225
    v_fma_mix_f32 v226, v29, v137, v141 op_sel:[0,0,0] op_sel_hi:[1,1,1]
    v_fma_mix_f32 v227, v29, v137, v141 op_sel:[1,1,1] op_sel_hi:[1,1,1]
    v_cvt_pk_bf16_f32 v29, v226, v227
    v_mfma_f32_32x32x16_bf16 v[112:127], v[172:175], v[24:27], v[112:127]
    v_fma_mix_f32 v224, v30, v138, v142 op_sel:[0,0,0] op_sel_hi:[1,1,1]
    v_fma_mix_f32 v225, v30, v138, v142 op_sel:[1,1,1] op_sel_hi:[1,1,1]
    v_cvt_pk_bf16_f32 v30, v224, v225
    v_fma_mix_f32 v226, v31, v139, v143 op_sel:[0,0,0] op_sel_hi:[1,1,1]
    v_fma_mix_f32 v227, v31, v139, v143 op_sel:[1,1,1] op_sel_hi:[1,1,1]
    v_cvt_pk_bf16_f32 v31, v226, v227
    s_waitcnt lgkmcnt(0)
    s_nop 0
    v_mfma_f32_32x32x16_bf16 v[64:79], v[176:179], v[28:31], v[64:79]
    v_mfma_f32_32x32x16_bf16 v[80:95], v[180:183], v[28:31], v[80:95]
    v_mfma_f32_32x32x16_bf16 v[96:111], v[184:187], v[28:31], v[96:111]
    v_mfma_f32_32x32x16_bf16 v[112:127], v[188:191], v[28:31], v[112:127]
    s_lshl_b32 s57, s54, 19
    s_lshl_b32 s62, s53, 7
    s_lshl_b32 s63, s55, 5
    s_add_u32 s62, s62, s63
    s_lshl_b32 s62, s62, 4
    s_add_u32 s57, s57, s62
    s_add_u32 s57, s57, 4194304
    v_lshrrev_b32 v3, 5, v1
    v_lshlrev_b32 v3, 15, v3
    v_and_b32_e64 v4, 31, v1
    v_lshl_add_u32 v3, v4, 4, v3
    s_nop 0
    s_cmp_lg_u32 s6, 1.0
    s_cbranch_scc1 US_39
USB_40:
    s_nop 0
    v_cvt_pk_bf16_f32 v16, v64, v65
    v_cvt_pk_bf16_f32 v17, v66, v67
    v_cvt_pk_bf16_f32 v18, v68, v69
    v_cvt_pk_bf16_f32 v19, v70, v71
    buffer_store_dwordx4 v[16:19], v3, s[36:39], s57 offen sc1
    s_add_u32 s57, s57, 65536
    v_cvt_pk_bf16_f32 v20, v72, v73
    v_cvt_pk_bf16_f32 v21, v74, v75
    v_cvt_pk_bf16_f32 v22, v76, v77
    v_cvt_pk_bf16_f32 v23, v78, v79
    buffer_store_dwordx4 v[20:23], v3, s[36:39], s57 offen sc1
    s_add_u32 s57, s57, 65536
    v_cvt_pk_bf16_f32 v24, v80, v81
    v_cvt_pk_bf16_f32 v25, v82, v83
    v_cvt_pk_bf16_f32 v26, v84, v85
    v_cvt_pk_bf16_f32 v27, v86, v87
    buffer_store_dwordx4 v[24:27], v3, s[36:39], s57 offen sc1
    s_add_u32 s57, s57, 65536
    v_cvt_pk_bf16_f32 v28, v88, v89
    v_cvt_pk_bf16_f32 v29, v90, v91
    v_cvt_pk_bf16_f32 v30, v92, v93
    v_cvt_pk_bf16_f32 v31, v94, v95
    buffer_store_dwordx4 v[28:31], v3, s[36:39], s57 offen sc1
    s_add_u32 s57, s57, 65536
    v_cvt_pk_bf16_f32 v32, v96, v97
    v_cvt_pk_bf16_f32 v33, v98, v99
    v_cvt_pk_bf16_f32 v34, v100, v101
    v_cvt_pk_bf16_f32 v35, v102, v103
    buffer_store_dwordx4 v[32:35], v3, s[36:39], s57 offen sc1
    s_add_u32 s57, s57, 65536
    v_cvt_pk_bf16_f32 v36, v104, v105
    v_cvt_pk_bf16_f32 v37, v106, v107
    v_cvt_pk_bf16_f32 v38, v108, v109
    v_cvt_pk_bf16_f32 v39, v110, v111
    buffer_store_dwordx4 v[36:39], v3, s[36:39], s57 offen sc1
    s_add_u32 s57, s57, 65536
    v_cvt_pk_bf16_f32 v40, v112, v113
    v_cvt_pk_bf16_f32 v41, v114, v115
    v_cvt_pk_bf16_f32 v42, v116, v117
    v_cvt_pk_bf16_f32 v43, v118, v119
    buffer_store_dwordx4 v[40:43], v3, s[36:39], s57 offen sc1
    s_add_u32 s57, s57, 65536
    v_cvt_pk_bf16_f32 v44, v120, v121
    v_cvt_pk_bf16_f32 v45, v122, v123
    v_cvt_pk_bf16_f32 v46, v124, v125
    v_cvt_pk_bf16_f32 v47, v126, v127
    buffer_store_dwordx4 v[44:47], v3, s[36:39], s57 offen sc1
    s_add_u32 s57, s57, 65536
    s_waitcnt vmcnt(0) lgkmcnt(0)
    s_barrier
    s_cmp_lg_u32 s55, 0
    s_cbranch_scc1 PF_41
    s_lshl_b32 s57, s53, 4
    s_add_u32 s57, s57, s54
    s_lshl_b32 s57, s57, 7
    s_add_u32 s57, s57, 86016
    s_lshl_b32 s58, s56, 2
    s_add_u32 s58, s58, 217088
    v_mov_b32 v3, s52
    v_mov_b32 v4, 0
    s_mov_b64 exec, 1
    buffer_store_dword v3, v4, s[36:39], s57 offen sc1
    buffer_store_dword v3, v4, s[36:39], s58 offen sc1
    s_nop 1
    s_mov_b64 exec, -1
PF_41:
    s_branch P1D_29
P1SK_28:
    s_lshl_b32 s97, s55, 12
    s_add_u32 m0, s97, 16384
    s_nop 0
    buffer_load_dwordx4 v208, s[64:67], 0 offen lds
    s_add_u32 m0, s97, 17408
    s_nop 0
    buffer_load_dwordx4 v209, s[64:67], 0 offen lds
    s_add_u32 m0, s97, 18432
    s_nop 0
    buffer_load_dwordx4 v210, s[64:67], 0 offen lds
    s_add_u32 m0, s97, 19456
    s_nop 0
    buffer_load_dwordx4 v211, s[64:67], 0 offen lds
    s_add_u32 m0, s97, 32768
    s_nop 0
    buffer_load_dwordx4 v216, s[72:75], 0 offen lds
    s_add_u32 m0, s97, 33792
    s_nop 0
    buffer_load_dwordx4 v217, s[72:75], 0 offen lds
    s_add_u32 m0, s97, 34816
    s_nop 0
    buffer_load_dwordx4 v218, s[72:75], 0 offen lds
    s_add_u32 m0, s97, 35840
    s_nop 0
    buffer_load_dwordx4 v219, s[72:75], 0 offen lds
    buffer_load_ushort a116, v235, s[40:43], s5 offen
    s_add_u32 s57, s4, 0
    buffer_load_dwordx4 a[96:99], v234, s[28:31], s57 offen
    s_add_u32 s57, s4, 61440
    buffer_load_dwordx4 a[100:103], v234, s[28:31], s57 offen
    s_add_u32 s57, s4, 122880
    buffer_load_dwordx4 a[104:107], v234, s[28:31], s57 offen
    s_add_u32 s57, s4, 184320
    buffer_load_dwordx4 a[108:111], v234, s[28:31], s57 offen
    s_add_u32 s57, s4, 245760
    buffer_load_dwordx4 a[112:115], v234, s[28:31], s57 offen
    s_waitcnt vmcnt(0)
    s_nop 0
    ds_read_b64_tr_b16 v[16:17], v212
    ds_read_b64_tr_b16 v[18:19], v212 offset:512
    ds_read_b64_tr_b16 v[20:21], v213
    ds_read_b64_tr_b16 v[22:23], v213 offset:512
    ds_read_b64_tr_b16 v[24:25], v214
    ds_read_b64_tr_b16 v[26:27], v214 offset:512
    ds_read_b64_tr_b16 v[28:29], v215
    ds_read_b64_tr_b16 v[30:31], v215 offset:512
    ds_read_b64_tr_b16 v[32:33], v220
    ds_read_b64_tr_b16 v[34:35], v220 offset:512
    ds_read_b64_tr_b16 v[36:37], v221
    ds_read_b64_tr_b16 v[38:39], v221 offset:512
    ds_read_b64_tr_b16 v[40:41], v222
    ds_read_b64_tr_b16 v[42:43], v222 offset:512
    ds_read_b64_tr_b16 v[44:45], v223
    s_waitcnt lgkmcnt(14)
    ds_read_b64_tr_b16 v[46:47], v223 offset:512
    s_waitcnt lgkmcnt(14)
    buffer_store_dwordx4 v[16:19], v2, s[36:39], s68 offen sc1
    s_waitcnt lgkmcnt(12)
    buffer_store_dwordx4 v[20:23], v2, s[36:39], s69 offen sc1
    s_waitcnt lgkmcnt(10)
    buffer_store_dwordx4 v[24:27], v2, s[36:39], s70 offen sc1
    s_waitcnt lgkmcnt(8)
    buffer_store_dwordx4 v[28:31], v2, s[36:39], s71 offen sc1
    s_waitcnt lgkmcnt(6)
    buffer_store_dwordx4 v[32:35], v2, s[36:39], s76 offen sc1
    s_waitcnt lgkmcnt(4)
    buffer_store_dwordx4 v[36:39], v2, s[36:39], s77 offen sc1
    s_waitcnt lgkmcnt(2)
    buffer_store_dwordx4 v[40:43], v2, s[36:39], s78 offen sc1
    s_waitcnt lgkmcnt(0)
    buffer_store_dwordx4 v[44:47], v2, s[36:39], s79 offen sc1
    s_waitcnt vmcnt(0) lgkmcnt(0)
    s_barrier
    s_cmp_lg_u32 s55, 0
    s_cbranch_scc1 PF_42
    s_lshl_b32 s57, s53, 4
    s_add_u32 s57, s57, s54
    s_lshl_b32 s57, s57, 7
    s_add_u32 s57, s57, 86016
    s_lshl_b32 s58, s56, 2
    s_add_u32 s58, s58, 217088
    v_mov_b32 v3, s52
    v_mov_b32 v4, 0
    s_mov_b64 exec, 1
    buffer_store_dword v3, v4, s[36:39], s57 offen sc1
    buffer_store_dword v3, v4, s[36:39], s58 offen sc1
    s_nop 1
    s_mov_b64 exec, -1
PF_42:
P1D_29:
    v_accvgpr_read_b32 v40, a116
    v_lshlrev_b32_e64 v40, 16, v40
    v_mul_f32 v41, 0xbfb8aa3b, v40
    v_exp_f32 v41, v41
    s_nop 0
    v_add_f32 v41, 1.0, v41
    v_rcp_f32 v41, v41
    s_nop 0
    v_mul_f32 v41, v40, v41
    v_cvt_pk_bf16_f32 v41, v41, v41
    v_lshlrev_b32_e64 v41, 16, v41
    s_mul_i32 s57, s55, 160
    s_add_u32 s57, s57, 151552
    v_min_u32 v5, 39, v1
    v_lshlrev_b32 v5, 2, v5
    v_add_u32_e64 v5, s57, v5
    ds_write_b32 v5, v41
    v_lshrrev_b32 v3, 3, v1
    v_lshlrev_b32 v5, 2, v3
    v_add_u32_e64 v5, s57, v5
    v_accvgpr_read_b32 v16, a96
    v_accvgpr_read_b32 v17, a97
    v_accvgpr_read_b32 v18, a98
    v_accvgpr_read_b32 v19, a99
    v_accvgpr_read_b32 v20, a100
    v_accvgpr_read_b32 v21, a101
    v_accvgpr_read_b32 v22, a102
    v_accvgpr_read_b32 v23, a103
    v_accvgpr_read_b32 v24, a104
    v_accvgpr_read_b32 v25, a105
    v_accvgpr_read_b32 v26, a106
    v_accvgpr_read_b32 v27, a107
    v_accvgpr_read_b32 v28, a108
    v_accvgpr_read_b32 v29, a109
    v_accvgpr_read_b32 v30, a110
    v_accvgpr_read_b32 v31, a111
    v_accvgpr_read_b32 v32, a112
    v_accvgpr_read_b32 v33, a113
    v_accvgpr_read_b32 v34, a114
    v_accvgpr_read_b32 v35, a115
    s_waitcnt lgkmcnt(0)
    s_nop 0
    ds_read_b32 v44, v5 offset:0
    ds_read_b32 v46, v5 offset:32
    ds_read_b32 v48, v5 offset:64
    ds_read_b32 v50, v5 offset:96
    ds_read_b32 v52, v5 offset:128
    v_lshlrev_b32_e64 v56, 16, v16
    v_and_b32 v57, 0xffff0000, v16
    s_waitcnt lgkmcnt(4)
    v_pk_mul_f32 v[8:9], v[56:57], v[44:45] op_sel_hi:[1,0]
    v_lshlrev_b32 v58, 16, v17
    v_and_b32 v59, 0xffff0000, v17
    v_pk_mul_f32 v[10:11], v[58:59], v[44:45] op_sel_hi:[1,0]
    v_lshlrev_b32_e64 v56, 16, v18
    v_and_b32 v57, 0xffff0000, v18
    v_pk_mul_f32 v[12:13], v[56:57], v[44:45] op_sel_hi:[1,0]
    v_lshlrev_b32_e64 v58, 16, v19
    v_and_b32 v59, 0xffff0000, v19
    v_pk_mul_f32 v[14:15], v[58:59], v[44:45] op_sel_hi:[1,0]
    v_lshlrev_b32_e64 v60, 16, v20
    v_and_b32 v61, 0xffff0000, v20
    s_waitcnt lgkmcnt(3)
    v_pk_fma_f32 v[8:9], v[60:61], v[46:47], v[8:9] op_sel_hi:[1,0,1]
    v_lshlrev_b32 v62, 16, v21
    v_and_b32 v63, 0xffff0000, v21
    v_pk_fma_f32 v[10:11], v[62:63], v[46:47], v[10:11] op_sel_hi:[1,0,1]
    v_lshlrev_b32_e64 v60, 16, v22
    v_and_b32 v61, 0xffff0000, v22
    v_pk_fma_f32 v[12:13], v[60:61], v[46:47], v[12:13] op_sel_hi:[1,0,1]
    v_lshlrev_b32_e64 v62, 16, v23
    v_and_b32 v63, 0xffff0000, v23
    v_pk_fma_f32 v[14:15], v[62:63], v[46:47], v[14:15] op_sel_hi:[1,0,1]
    v_lshlrev_b32_e64 v56, 16, v24
    v_and_b32 v57, 0xffff0000, v24
    s_waitcnt lgkmcnt(2)
    v_pk_fma_f32 v[8:9], v[56:57], v[48:49], v[8:9] op_sel_hi:[1,0,1]
    v_lshlrev_b32 v58, 16, v25
    v_and_b32 v59, 0xffff0000, v25
    v_pk_fma_f32 v[10:11], v[58:59], v[48:49], v[10:11] op_sel_hi:[1,0,1]
    v_lshlrev_b32_e64 v56, 16, v26
    v_and_b32 v57, 0xffff0000, v26
    v_pk_fma_f32 v[12:13], v[56:57], v[48:49], v[12:13] op_sel_hi:[1,0,1]
    v_lshlrev_b32_e64 v58, 16, v27
    v_and_b32 v59, 0xffff0000, v27
    v_pk_fma_f32 v[14:15], v[58:59], v[48:49], v[14:15] op_sel_hi:[1,0,1]
    v_lshlrev_b32_e64 v60, 16, v28
    v_and_b32 v61, 0xffff0000, v28
    s_waitcnt lgkmcnt(1)
    v_pk_fma_f32 v[8:9], v[60:61], v[50:51], v[8:9] op_sel_hi:[1,0,1]
    v_lshlrev_b32 v62, 16, v29
    v_and_b32 v63, 0xffff0000, v29
    v_pk_fma_f32 v[10:11], v[62:63], v[50:51], v[10:11] op_sel_hi:[1,0,1]
    v_lshlrev_b32_e64 v60, 16, v30
    v_and_b32 v61, 0xffff0000, v30
    v_pk_fma_f32 v[12:13], v[60:61], v[50:51], v[12:13] op_sel_hi:[1,0,1]
    v_lshlrev_b32_e64 v62, 16, v31
    v_and_b32 v63, 0xffff0000, v31
    v_pk_fma_f32 v[14:15], v[62:63], v[50:51], v[14:15] op_sel_hi:[1,0,1]
    v_lshlrev_b32_e64 v56, 16, v32
    v_and_b32 v57, 0xffff0000, v32
    s_waitcnt lgkmcnt(0)
    v_pk_fma_f32 v[8:9], v[56:57], v[52:53], v[8:9] op_sel_hi:[1,0,1]
    v_lshlrev_b32 v58, 16, v33
    v_and_b32 v59, 0xffff0000, v33
    v_pk_fma_f32 v[10:11], v[58:59], v[52:53], v[10:11] op_sel_hi:[1,0,1]
    v_lshlrev_b32_e64 v56, 16, v34
    v_and_b32 v57, 0xffff0000, v34
    v_pk_fma_f32 v[12:13], v[56:57], v[52:53], v[12:13] op_sel_hi:[1,0,1]
    v_lshlrev_b32_e64 v58, 16, v35
    v_and_b32 v59, 0xffff0000, v35
    v_pk_fma_f32 v[14:15], v[58:59], v[52:53], v[14:15] op_sel_hi:[1,0,1]
    v_add_f32_dpp v8, v8, v8 row_ror:8 row_mask:0xf bank_mask:0xf
    v_add_f32_dpp v9, v9, v9 row_ror:8 row_mask:0xf bank_mask:0xf
    v_add_f32_dpp v10, v10, v10 row_ror:8 row_mask:0xf bank_mask:0xf
    v_add_f32_dpp v11, v11, v11 row_ror:8 row_mask:0xf bank_mask:0xf
    v_add_f32_dpp v12, v12, v12 row_ror:8 row_mask:0xf bank_mask:0xf
    v_add_f32_dpp v13, v13, v13 row_ror:8 row_mask:0xf bank_mask:0xf
    v_add_f32_dpp v14, v14, v14 row_ror:8 row_mask:0xf bank_mask:0xf
    v_add_f32_dpp v15, v15, v15 row_ror:8 row_mask:0xf bank_mask:0xf
    v_mov_b32 v20, v8
    v_mov_b32 v21, v9
    v_mov_b32 v22, v10
    v_mov_b32 v23, v11
    v_mov_b32 v24, v12
    v_mov_b32 v25, v13
    v_mov_b32 v26, v14
    v_mov_b32 v27, v15
    v_permlane16_swap_b32 v8, v20
    v_permlane16_swap_b32 v9, v21
    v_permlane16_swap_b32 v10, v22
    v_permlane16_swap_b32 v11, v23
    v_permlane16_swap_b32 v12, v24
    v_permlane16_swap_b32 v13, v25
    v_permlane16_swap_b32 v14, v26
    v_permlane16_swap_b32 v15, v27
    v_add_f32 v8, v8, v20
    v_add_f32 v9, v9, v21
    v_add_f32 v10, v10, v22
    v_add_f32 v11, v11, v23
    v_add_f32 v12, v12, v24
    v_add_f32 v13, v13, v25
    v_add_f32 v14, v14, v26
    v_add_f32 v15, v15, v27
    v_mov_b32 v20, v8
    v_mov_b32 v21, v9
    v_mov_b32 v22, v10
    v_mov_b32 v23, v11
    v_mov_b32 v24, v12
    v_mov_b32 v25, v13
    v_mov_b32 v26, v14
    v_mov_b32 v27, v15
    v_permlane32_swap_b32 v8, v20
    v_permlane32_swap_b32 v9, v21
    v_permlane32_swap_b32 v10, v22
    v_permlane32_swap_b32 v11, v23
    v_permlane32_swap_b32 v12, v24
    v_permlane32_swap_b32 v13, v25
    v_permlane32_swap_b32 v14, v26
    v_permlane32_swap_b32 v15, v27
    v_add_f32 v8, v8, v20
    v_add_f32 v9, v9, v21
    v_add_f32 v10, v10, v22
    v_add_f32 v11, v11, v23
    v_add_f32 v12, v12, v24
    v_add_f32 v13, v13, v25
    v_add_f32 v14, v14, v26
    v_add_f32 v15, v15, v27
    s_lshl_b32 s57, s55, 8
    s_add_u32 s57, s57, 152576
    v_and_b32 v5, 7, v1
    v_lshlrev_b32 v5, 5, v5
    v_add_u32 v5, s57, v5
    ds_write_b128 v5, v[8:11]
    ds_write_b128 v5, v[12:15] offset:16
    s_waitcnt lgkmcnt(0)
    s_mul_i32 s60, s54, 5
    s_lshr_b32 s60, s60, 1
    s_and_b32 s61, s54, 1
    s_lshl_b32 s61, s61, 1
    v_mov_b32 v8, 0x3f80
    v_mov_b32 v9, 0
    v_mov_b32 v10, 0
    v_mov_b32 v11, 0
    v_lshlrev_b32_e64 v3, 4, v0
    v_add_u32 v3, 74176, v3
    ds_write_b128 v3, v[8:11]
    v_and_b32 v4, 127, v0
    v_lshlrev_b32_e64 v4, 4, v4
    v_add_u32 v4, 78272, v4
    ds_write_b128 v4, v[8:11]
    v_lshrrev_b32 v3, 5, v1
    v_and_b32 v4, 31, v1
    s_lshl_b32 s57, s55, 5
    v_mul_u32_u24 v5, 6144, v3
    v_add_u32 v6, s57, v4
    v_lshl_add_u32 v244, v6, 4, v5
    v_add_u32 v244, 0, v244
    v_lshlrev_b32 v5, 2, v3
    v_sub_u32_e64 v247, v4, v5
    v_cmp_le_i32 s[64:65], 0, v247
    v_cmp_le_i32 s[66:67], 1, v247
    v_cmp_le_i32 s[68:69], 2, v247
    v_cmp_le_i32 s[70:71], 3, v247
    v_cmp_le_i32 s[72:73], 8, v247
    v_cmp_le_i32 s[74:75], 9, v247
    v_cmp_le_i32 s[76:77], 10, v247
    v_cmp_le_i32 s[78:79], 11, v247
    v_cmp_le_i32 s[80:81], 16, v247
    v_cmp_le_i32 s[82:83], 17, v247
    v_cmp_le_i32 s[84:85], 18, v247
    v_cmp_le_i32 s[86:87], 19, v247
    v_cmp_le_i32 s[88:89], 24, v247
    v_cmp_le_i32 s[90:91], 25, v247
    v_cmp_le_i32 s[92:93], 26, v247
    v_cmp_le_i32 s[94:95], 27, v247
    v_mov_b32 v8, 0xffff
    v_mov_b32 v9, 0xffff0000
    v_cndmask_b32 v8, 0, v8, s[64:65]
    v_cndmask_b32 v9, 0, v9, s[66:67]
    v_or_b32_e64 v220, v8, v9
    v_mov_b32 v8, 0xffff
    v_mov_b32 v9, 0xffff0000
    v_cndmask_b32 v8, 0, v8, s[68:69]
    v_cndmask_b32 v9, 0, v9, s[70:71]
    v_or_b32_e64 v221, v8, v9
    v_mov_b32 v8, 0xffff
    v_mov_b32 v9, 0xffff0000
    v_cndmask_b32 v8, 0, v8, s[72:73]
    v_cndmask_b32 v9, 0, v9, s[74:75]
    v_or_b32_e64 v222, v8, v9
    v_mov_b32 v8, 0xffff
    v_mov_b32 v9, 0xffff0000
    v_cndmask_b32 v8, 0, v8, s[76:77]
    v_cndmask_b32 v9, 0, v9, s[78:79]
    v_or_b32_e64 v223, v8, v9
    v_mov_b32 v8, 0xffff
    v_mov_b32 v9, 0xffff0000
    v_cndmask_b32 v8, 0, v8, s[80:81]
    v_cndmask_b32 v9, 0, v9, s[82:83]
    v_or_b32_e64 v224, v8, v9
    v_mov_b32 v8, 0xffff
    v_mov_b32 v9, 0xffff0000
    v_cndmask_b32 v8, 0, v8, s[84:85]
    v_cndmask_b32 v9, 0, v9, s[86:87]
    v_or_b32_e64 v225, v8, v9
    v_mov_b32 v8, 0xffff
    v_mov_b32 v9, 0xffff0000
    v_cndmask_b32 v8, 0, v8, s[88:89]
    v_cndmask_b32 v9, 0, v9, s[90:91]
    v_or_b32_e64 v226, v8, v9
    v_mov_b32 v8, 0xffff
    v_mov_b32 v9, 0xffff0000
    v_cndmask_b32 v8, 0, v8, s[92:93]
    v_cndmask_b32 v9, 0, v9, s[94:95]
    v_or_b32_e64 v227, v8, v9
    v_bfe_u32 v5, v1, 2, 2
    v_lshl_add_u32 v5, v3, 2, v5
    v_add_u32 v5, s57, v5
    v_lshlrev_b32 v5, 4, v5
    v_bfe_u32 v6, v1, 4, 1
    v_and_b32_e64 v7, 3, v1
    v_lshl_add_u32 v6, v6, 2, v7
    v_add_u32 v7, s61, v6
    v_add_u32 v7, 0, v7
    v_lshrrev_b32 v8, 2, v7
    v_lshlrev_b32 v8, 1, v8
    v_and_b32 v9, 1, v7
    v_add_u32 v8, v8, v9
    v_mul_u32_u24 v8, 6208, v8
    v_bfe_u32 v9, v7, 1, 1
    v_lshl_add_u32 v8, v9, 3, v8
    v_add_u32 v8, 36864, v8
    v_bfe_u32 v9, v6, 1, 1
    v_lshlrev_b32_e64 v9, 3, v9
    v_add_u32 v9, 74176, v9
    v_cmp_le_u32 vcc, 5, v6
    s_nop 1
    v_cndmask_b32 v8, v8, v9, vcc
    v_add_u32 v245, v8, v5
    v_add_u32 v7, s61, v6
    v_add_u32 v7, 5, v7
    v_lshrrev_b32 v8, 2, v7
    v_lshlrev_b32 v8, 1, v8
    v_and_b32 v9, 1, v7
    v_add_u32 v8, v8, v9
    v_mul_u32_u24 v8, 6208, v8
    v_bfe_u32 v9, v7, 1, 1
    v_lshl_add_u32 v8, v9, 3, v8
    v_add_u32 v8, 36864, v8
    v_bfe_u32 v9, v6, 1, 1
    v_lshlrev_b32_e64 v9, 3, v9
    v_add_u32 v9, 74176, v9
    v_cmp_le_u32 vcc, 5, v6
    s_nop 1
    v_cndmask_b32 v8, v8, v9, vcc
    v_add_u32 v246, v8, v5
    s_lshl_b32 s57, s53, 7
    s_lshl_b32 s58, s55, 5
    s_add_u32 s57, s57, s58
    s_lshl_b32 s57, s57, 4
    s_lshl_b32 s58, s60, 16
    s_add_u32 s57, s57, s58
    s_add_u32 s98, s57, 4194304
    v_lshrrev_b32 v3, 5, v1
    v_and_b32 v4, 31, v1
    v_lshlrev_b32_e64 v5, 15, v3
    v_lshl_add_u32 v13, v4, 4, v5
    s_add_u32 s57, s53, s55
    s_cmp_ge_u32 s57, 2
    s_cselect_b32 s58, 0, 0xf0000000
    v_or_b32 v12, s58, v2
    s_add_u32 s99, s60, 40
    s_lshl_b32 s99, s99, 16
    s_lshl_b32 s63, s57, 11
    s_add_u32 s99, s99, s63
    s_add_u32 s99, s99, 4190208
    s_lshl_b32 s62, s53, 3
    s_lshl_b32 s63, s55, 1
    s_add_u32 s62, s62, s63
    s_mul_i32 s62, s62, 20480
    s_add_u32 s62, s62, 12582912
    s_lshl_b32 s63, s54, 10
    s_add_u32 s96, s62, s63
    s_lshr_b32 s63, s54, 2
    s_add_u32 s63, s63, 16
    s_lshl_b32 s63, s63, 10
    s_add_u32 s97, s62, s63
    s_and_b32 s63, s54, 3
    s_lshl_b32 s63, s63, 8
    s_add_u32 s97, s97, s63
    v_bfe_u32 v3, v1, 4, 1
    v_mul_u32_u24 v3, 20480, v3
    v_and_b32 v4, 15, v1
    v_lshl_add_u32 v3, v4, 4, v3
    v_lshrrev_b32_e64 v4, 5, v1
    v_lshl_add_u32 v252, v4, 8, v3
    v_mov_b32 v5, 0xf0000000
    v_cmp_eq_u32 vcc, 0, v4
    s_nop 1
    v_cndmask_b32 v253, v5, v3, vcc
    s_lshr_b32 s62, s60, 3
    s_add_u32 s63, s60, 2
    s_lshr_b32 s63, s63, 3
    v_and_b32 v3, 15, v1
    v_lshrrev_b32 v4, 2, v3
    v_and_b32 v5, 1, v3
    v_mov_b32 v6, s62
    v_mov_b32 v7, s63
    v_cmp_eq_u32 vcc, 1, v5
    s_nop 1
    v_cndmask_b32 v6, v6, v7, vcc
    v_bfe_u32 v5, v3, 1, 1
    v_mul_u32_u24 v5, 5, v5
    v_add_u32 v5, 5, v5
    v_cmp_eq_u32 vcc, 3, v4
    s_nop 1
    v_cndmask_b32 v5, v5, 0, vcc
    v_cndmask_b32 v4, v4, 0, vcc
    v_add_u32 v6, v6, v5
    v_sub_u32 v7, s53, v4
    v_max_i32_e64 v7, 0, v7
    v_lshl_add_u32 v7, v7, 4, v6
    v_lshlrev_b32_e64 v8, 7, v7
    v_add_u32 v8, 86016, v8
    s_lshl_b32 s63, s55, 11
    s_cmp_lg_u32 s55, 0
    s_cbranch_scc1 POLLS_43
    s_mov_b32 s57, 0
POLL_44:
    buffer_load_dword v9, v8, s[36:39], 0 offen sc1
    s_waitcnt vmcnt(0)
    v_cmp_ne_u32 vcc, s52, v9
    s_add_u32 s57, s57, 1
    s_cmp_gt_u32 s57, 400000
    s_cbranch_scc1 POLLD_45
    s_cbranch_vccnz POLL_44
POLLD_45:
POLLS_43:
    s_barrier
    s_cmp_lg_u32 s55, 3
    s_cbranch_scc1 LS_46
    v_lshlrev_b32_e64 v5, 2, v1
    v_add_u32 v6, 152576, v5
    ds_read_b32 v16, v6 offset:0
    ds_read_b32 v17, v6 offset:256
    ds_read_b32 v18, v6 offset:512
    ds_read_b32 v19, v6 offset:768
    s_waitcnt lgkmcnt(0)
    v_add_f32 v16, v16, v17
    v_add_f32 v18, v18, v19
    v_add_f32 v16, v16, v18
    buffer_store_dword v16, v5, s[36:39], s3 offen sc1
LS_46:
    buffer_load_dwordx4 v[160:163], v13, s[36:39], s98 offen sc1
    s_add_u32 s98, s98, 65536
    buffer_load_dwordx4 v[164:167], v13, s[36:39], s98 offen sc1
    s_add_u32 s98, s98, 65536
    buffer_load_dwordx4 v[168:171], v13, s[36:39], s98 offen sc1
    s_cmp_eq_u32 s55, 3
    s_cbranch_scc1 KV3_47
    s_add_u32 m0, s63, 0
    s_add_u32 s57, s99, 0
    buffer_load_dwordx4 v12, s[36:39], s57 offen sc1 lds
    s_add_u32 m0, s63, 1024
    s_add_u32 s57, s99, 1024
    buffer_load_dwordx4 v12, s[36:39], s57 offen sc1 lds
    s_add_u32 m0, s63, 6144
    s_add_u32 s57, s99, 32768
    buffer_load_dwordx4 v12, s[36:39], s57 offen sc1 lds
    s_add_u32 m0, s63, 7168
    s_add_u32 s57, s99, 33792
    buffer_load_dwordx4 v12, s[36:39], s57 offen sc1 lds
    s_add_u32 m0, s63, 12288
    s_add_u32 s57, s99, 65536
    buffer_load_dwordx4 v12, s[36:39], s57 offen sc1 lds
    s_add_u32 m0, s63, 13312
    s_add_u32 s57, s99, 66560
    buffer_load_dwordx4 v12, s[36:39], s57 offen sc1 lds
    s_add_u32 m0, s63, 18432
    s_add_u32 s57, s99, 98304
    buffer_load_dwordx4 v12, s[36:39], s57 offen sc1 lds
    s_add_u32 m0, s63, 19456
    s_add_u32 s57, s99, 99328
    buffer_load_dwordx4 v12, s[36:39], s57 offen sc1 lds
    s_add_u32 m0, s63, 24576
    s_add_u32 s57, s99, 131072
    buffer_load_dwordx4 v12, s[36:39], s57 offen sc1 lds
    s_add_u32 m0, s63, 25600
    s_add_u32 s57, s99, 132096
    buffer_load_dwordx4 v12, s[36:39], s57 offen sc1 lds
    s_add_u32 m0, s63, 30720
    s_add_u32 s57, s99, 163840
    buffer_load_dwordx4 v12, s[36:39], s57 offen sc1 lds
    s_add_u32 m0, s63, 31744
    s_add_u32 s57, s99, 164864
    buffer_load_dwordx4 v12, s[36:39], s57 offen sc1 lds
    s_add_u32 m0, s63, 36864
    s_add_u32 s57, s99, 2621440
    buffer_load_dwordx4 v12, s[36:39], s57 offen sc1 lds
    s_add_u32 m0, s63, 37888
    s_add_u32 s57, s99, 2622464
    buffer_load_dwordx4 v12, s[36:39], s57 offen sc1 lds
    s_add_u32 m0, s63, 43072
    s_add_u32 s57, s99, 2654208
    buffer_load_dwordx4 v12, s[36:39], s57 offen sc1 lds
    s_add_u32 m0, s63, 44096
    s_add_u32 s57, s99, 2655232
    buffer_load_dwordx4 v12, s[36:39], s57 offen sc1 lds
    s_add_u32 m0, s63, 49280
    s_add_u32 s57, s99, 2686976
    buffer_load_dwordx4 v12, s[36:39], s57 offen sc1 lds
    s_add_u32 m0, s63, 50304
    s_add_u32 s57, s99, 2688000
    buffer_load_dwordx4 v12, s[36:39], s57 offen sc1 lds
    s_add_u32 m0, s63, 55488
    s_add_u32 s57, s99, 2719744
    buffer_load_dwordx4 v12, s[36:39], s57 offen sc1 lds
    s_add_u32 m0, s63, 56512
    s_add_u32 s57, s99, 2720768
    buffer_load_dwordx4 v12, s[36:39], s57 offen sc1 lds
    s_add_u32 m0, s63, 61696
    s_add_u32 s57, s99, 2752512
    buffer_load_dwordx4 v12, s[36:39], s57 offen sc1 lds
    s_add_u32 m0, s63, 62720
    s_add_u32 s57, s99, 2753536
    buffer_load_dwordx4 v12, s[36:39], s57 offen sc1 lds
    s_add_u32 m0, s63, 67904
    s_add_u32 s57, s99, 2785280
    buffer_load_dwordx4 v12, s[36:39], s57 offen sc1 lds
    s_add_u32 m0, s63, 68928
    s_add_u32 s57, s99, 2786304
    buffer_load_dwordx4 v12, s[36:39], s57 offen sc1 lds
    s_waitcnt vmcnt(12)
    s_branch KVJ_48
KV3_47:
    v_lshlrev_b32_e64 v4, 2, v1
    v_add_u32 v4, 217088, v4
    v_add_u32 v5, 256, v4
    v_add_u32 v6, 512, v4
    v_add_u32 v7, 768, v4
    s_mov_b32 s57, 0
POLL_49:
    buffer_load_dword v8, v4, s[36:39], 0 offen sc1
    buffer_load_dword v9, v5, s[36:39], 0 offen sc1
    buffer_load_dword v10, v6, s[36:39], 0 offen sc1
    buffer_load_dword v11, v7, s[36:39], 0 offen sc1
    s_waitcnt vmcnt(0)
    v_cmp_ne_u32 vcc, s52, v8
    v_cmp_ne_u32 s[58:59], s52, v9
    s_nop 0
    s_or_b64 vcc, vcc, s[58:59]
    v_cmp_ne_u32 s[58:59], s52, v10
    s_nop 0
    s_or_b64 vcc, vcc, s[58:59]
    v_cmp_ne_u32 s[58:59], s52, v11
    s_nop 0
    s_or_b64 vcc, vcc, s[58:59]
    s_add_u32 s57, s57, 1
    s_cmp_gt_u32 s57, 400000
    s_cbranch_scc1 POLLD_50
    s_cbranch_vccnz POLL_49
POLLD_50:
KVJ_48:
    v_lshrrev_b32 v3, 5, v1
    v_subrev_u32 v5, s61, v3
    v_add_u32 v6, 0, v5
    v_cmp_gt_u32 vcc, 5, v6
    s_nop 1
    v_cndmask_b32 v172, 0, v160, vcc
    v_cndmask_b32 v173, 0, v161, vcc
    v_add_u32 v6, 2, v5
    v_cmp_gt_u32 vcc, 5, v6
    s_nop 1
    v_cndmask_b32 v174, 0, v162, vcc
    v_cndmask_b32 v175, 0, v163, vcc
    v_add_u32 v6, 4, v5
    v_cmp_gt_u32 vcc, 5, v6
    s_nop 1
    v_cndmask_b32 v176, 0, v164, vcc
    v_cndmask_b32 v177, 0, v165, vcc
    v_add_u32 v6, 6, v5
    v_cmp_gt_u32 vcc, 5, v6
    s_nop 1
    v_cndmask_b32 v178, 0, v166, vcc
    v_cndmask_b32 v179, 0, v167, vcc
    v_add_u32 v6, 4294967295, v5
    v_cmp_gt_u32 vcc, 5, v6
    s_nop 1
    v_cndmask_b32 v180, 0, v164, vcc
    v_cndmask_b32 v181, 0, v165, vcc
    v_add_u32 v6, 1, v5
    v_cmp_gt_u32 vcc, 5, v6
    s_nop 1
    v_cndmask_b32 v182, 0, v166, vcc
    v_cndmask_b32 v183, 0, v167, vcc
    v_add_u32 v6, 3, v5
    v_cmp_gt_u32 vcc, 5, v6
    s_nop 1
    v_cndmask_b32 v184, 0, v168, vcc
    v_cndmask_b32 v185, 0, v169, vcc
    v_add_u32 v6, 5, v5
    v_cmp_gt_u32 vcc, 5, v6
    s_nop 1
    v_cndmask_b32 v186, 0, v170, vcc
    v_cndmask_b32 v187, 0, v171, vcc
    s_waitcnt lgkmcnt(0)
    s_barrier
    s_cmp_lg_u32 s55, 0
    s_cbranch_scc1 PF_51
    s_lshl_b32 s57, s56, 2
    s_add_u32 s57, s57, 218112
    v_mov_b32 v3, s52
    v_mov_b32 v4, 0
    s_mov_b64 exec, 1
    buffer_store_dword v3, v4, s[36:39], s57 offen sc1
    s_nop 1
    s_mov_b64 exec, -1
PF_51:
    s_and_b32 s60, s54, 1
    s_lshr_b32 s61, s54, 1
    s_lshl_b32 s62, s53, 3
    s_lshl_b32 s63, s60, 2
    s_add_u32 s62, s62, s63
    s_mul_i32 s98, s61, 20
    s_and_b32 s58, s55, 1
    s_mul_i32 s58, s58, 10
    s_add_u32 s98, s98, s58
    s_mul_i32 s98, s98, 5120
    s_add_u32 s98, s98, 25165824
    s_add_u32 s57, s62, s55
    s_lshl_b32 s57, s57, 4
    s_mul_i32 s63, s57, 1280
    s_mul_i32 s58, s61, 160
    s_add_u32 s63, s63, s58
    v_and_b32 v4, 15, v1
    v_lshrrev_b32 v5, 4, v1
    v_mul_u32_u24 v7, 1280, v4
    v_lshl_add_u32 v7, v5, 3, v7
    v_lshlrev_b32_e64 v4, 4, v0
    v_add_u32 v5, 11776, v4
    s_mul_i32 s58, s61, 320
    s_add_u32 s59, s58, 4096
    v_add_u32_e64 v6, s59, v4
    s_add_u32 s59, s58, 11456
    v_add_u32_e64 v8, s59, v4
    v_cmp_gt_u32 vcc, 84, v0
    s_nop 1
    v_cndmask_b32 v6, v8, v6, vcc
    v_cmp_gt_u32 vcc, 64, v0
    s_nop 1
    v_cndmask_b32_e64 v5, v6, v5, vcc
    v_add_u32 v4, 7680, v4
    s_mul_i32 s99, s54, 122880
    s_mul_i32 s60, s55, 10240
    s_add_u32 s60, s60, 81920
    s_add_u32 s99, s99, s60
    s_add_u32 s99, s99, 26214400
    v_min_u32 v8, 95, v0
    v_lshlrev_b32 v6, 1, v8
    s_lshl_b32 s57, s53, 2
    s_add_u32 s57, s57, s55
    s_sub_i32 s58, 8, s57
    s_nop 0
    ds_read_b128 v[188:191], v244 offset:0
    ds_read_b128 v[192:195], v244 offset:12288
    ds_read_b128 v[196:199], v244 offset:4096
    ds_read_b128 v[200:203], v244 offset:16384
    ds_read_b128 v[204:207], v244 offset:512
    ds_read_b128 v[208:211], v244 offset:12800
    s_waitcnt lgkmcnt(5)
    v_mfma_f32_32x32x16_bf16 v[16:31], v[188:191], v[172:175], 0
    s_waitcnt lgkmcnt(4)
    v_mfma_f32_32x32x16_bf16 v[16:31], v[192:195], v[176:179], v[16:31]
    ds_read_b128 v[212:215], v244 offset:1024
    ds_read_b128 v[216:219], v244 offset:13312
    s_waitcnt lgkmcnt(5)
    v_mfma_f32_32x32x16_bf16 v[144:159], v[196:199], v[172:175], 0
    s_waitcnt lgkmcnt(4)
    v_mfma_f32_32x32x16_bf16 v[144:159], v[200:203], v[176:179], v[144:159]
    ds_read_b128 v[188:191], v244 offset:1536
    ds_read_b128 v[192:195], v244 offset:13824
    s_nop 3
    s_cmp_gt_i32 s58, 0
    s_cbranch_scc1 FX_52
FXB_53:
    s_waitcnt lgkmcnt(5)
    v_mfma_f32_32x32x16_bf16 v[32:47], v[204:207], v[172:175], 0
    s_waitcnt lgkmcnt(4)
    v_mfma_f32_32x32x16_bf16 v[32:47], v[208:211], v[176:179], v[32:47]
    ds_read_b128 v[196:199], v244 offset:2048
    ds_read_b128 v[200:203], v244 offset:14336
    s_waitcnt lgkmcnt(5)
    v_mfma_f32_32x32x16_bf16 v[48:63], v[212:215], v[172:175], 0
    v_cndmask_b32 v144, v16, v144, s[64:65]
    v_cndmask_b32 v145, v17, v145, s[66:67]
    v_cndmask_b32 v146, v18, v146, s[68:69]
    v_cndmask_b32 v147, v19, v147, s[70:71]
    v_cndmask_b32 v148, v20, v148, s[72:73]
    v_cndmask_b32 v149, v21, v149, s[74:75]
    v_cndmask_b32 v150, v22, v150, s[76:77]
    v_cndmask_b32 v151, v23, v151, s[78:79]
    v_cndmask_b32 v152, v24, v152, s[80:81]
    v_cndmask_b32 v153, v25, v153, s[82:83]
    v_cndmask_b32 v154, v26, v154, s[84:85]
    v_cndmask_b32 v155, v27, v155, s[86:87]
    s_waitcnt lgkmcnt(4)
    s_nop 0
    v_mfma_f32_32x32x16_bf16 v[48:63], v[216:219], v[176:179], v[48:63]
    ds_read_b128 v[204:207], v244 offset:2560
    ds_read_b128 v[208:211], v244 offset:14848
    v_cndmask_b32 v156, v28, v156, s[88:89]
    v_cndmask_b32 v157, v29, v157, s[90:91]
    v_cndmask_b32 v158, v30, v158, s[92:93]
    v_cndmask_b32 v159, v31, v159, s[94:95]
    v_max3_f32 v248, v144, v145, v146
    v_max3_f32 v249, v147, v148, v149
    v_max3_f32 v248, v150, v151, v248
    v_max3_f32 v249, v152, v153, v249
    v_max3_f32 v248, v154, v155, v248
    v_max3_f32 v249, v156, v157, v249
    v_max3_f32 v248, v158, v159, v248
    s_cmp_gt_i32 s58, 1
    s_cbranch_scc1 FX_54
FXB_55:
    s_waitcnt lgkmcnt(5)
    s_nop 0
    v_mfma_f32_32x32x16_bf16 v[64:79], v[188:191], v[172:175], 0
    v_max3_f32 v248, v32, v33, v248
    v_max3_f32 v249, v34, v35, v249
    v_max3_f32 v248, v36, v37, v248
    v_max3_f32 v249, v38, v39, v249
    s_waitcnt lgkmcnt(4)
    s_nop 0
    v_mfma_f32_32x32x16_bf16 v[64:79], v[192:195], v[176:179], v[64:79]
    ds_read_b128 v[212:215], v244 offset:3072
    ds_read_b128 v[216:219], v244 offset:15360
    v_max3_f32 v248, v40, v41, v248
    v_max3_f32 v249, v42, v43, v249
    v_max3_f32 v248, v44, v45, v248
    v_max3_f32 v249, v46, v47, v249
    s_cmp_gt_i32 s58, 2
    s_cbranch_scc1 FX_56
FXB_57:
    s_waitcnt lgkmcnt(5)
    s_nop 0
    v_mfma_f32_32x32x16_bf16 v[80:95], v[196:199], v[172:175], 0
    v_max3_f32 v248, v48, v49, v248
    v_max3_f32 v249, v50, v51, v249
    v_max3_f32 v248, v52, v53, v248
    v_max3_f32 v249, v54, v55, v249
    s_waitcnt lgkmcnt(4)
    s_nop 0
    v_mfma_f32_32x32x16_bf16 v[80:95], v[200:203], v[176:179], v[80:95]
    ds_read_b128 v[188:191], v244 offset:3584
    ds_read_b128 v[192:195], v244 offset:15872
    v_max3_f32 v248, v56, v57, v248
    v_max3_f32 v249, v58, v59, v249
    v_max3_f32 v248, v60, v61, v248
    v_max3_f32 v249, v62, v63, v249
    s_cmp_gt_i32 s58, 3
    s_cbranch_scc1 FX_58
FXB_59:
    s_waitcnt lgkmcnt(5)
    s_nop 0
    v_mfma_f32_32x32x16_bf16 v[96:111], v[204:207], v[172:175], 0
    v_max3_f32 v248, v64, v65, v248
    v_max3_f32 v249, v66, v67, v249
    v_max3_f32 v248, v68, v69, v248
    v_max3_f32 v249, v70, v71, v249
    s_waitcnt lgkmcnt(4)
    s_nop 0
    v_mfma_f32_32x32x16_bf16 v[96:111], v[208:211], v[176:179], v[96:111]
    v_max3_f32 v248, v72, v73, v248
    v_max3_f32 v249, v74, v75, v249
    v_max3_f32 v248, v76, v77, v248
    v_max3_f32 v249, v78, v79, v249
    s_cmp_gt_i32 s58, 4
    s_cbranch_scc1 FX_60
FXB_61:
    s_waitcnt lgkmcnt(3)
    s_nop 0
    v_mfma_f32_32x32x16_bf16 v[112:127], v[212:215], v[172:175], 0
    v_max3_f32 v248, v80, v81, v248
    v_max3_f32 v249, v82, v83, v249
    v_max3_f32 v248, v84, v85, v248
    v_max3_f32 v249, v86, v87, v249
    s_waitcnt lgkmcnt(2)
    s_nop 0
    v_mfma_f32_32x32x16_bf16 v[112:127], v[216:219], v[176:179], v[112:127]
    v_max3_f32 v248, v88, v89, v248
    v_max3_f32 v249, v90, v91, v249
    v_max3_f32 v248, v92, v93, v248
    v_max3_f32 v249, v94, v95, v249
    s_cmp_gt_i32 s58, 5
    s_cbranch_scc1 FX_62
FXB_63:
    s_waitcnt lgkmcnt(1)
    s_nop 0
    v_mfma_f32_32x32x16_bf16 v[128:143], v[188:191], v[172:175], 0
    v_max3_f32 v248, v96, v97, v248
    v_max3_f32 v249, v98, v99, v249
    v_max3_f32 v248, v100, v101, v248
    v_max3_f32 v249, v102, v103, v249
    s_waitcnt lgkmcnt(0)
    s_nop 0
    v_mfma_f32_32x32x16_bf16 v[128:143], v[192:195], v[176:179], v[128:143]
    v_max3_f32 v248, v104, v105, v248
    v_max3_f32 v249, v106, v107, v249
    v_max3_f32 v248, v108, v109, v248
    v_max3_f32 v249, v110, v111, v249
    s_cmp_gt_i32 s58, 6
    s_cbranch_scc1 FX_64
FXB_65:
    v_max3_f32 v248, v112, v113, v248
    v_max3_f32 v249, v114, v115, v249
    v_max3_f32 v248, v116, v117, v248
    v_max3_f32 v249, v118, v119, v249
    v_max3_f32 v248, v120, v121, v248
    v_max3_f32 v249, v122, v123, v249
    v_max3_f32 v248, v124, v125, v248
    v_max3_f32 v249, v126, v127, v249
    s_cmp_gt_i32 s58, 7
    s_cbranch_scc1 FX_66
FXB_67:
    v_max3_f32 v248, v128, v129, v248
    v_max3_f32 v249, v130, v131, v249
    v_max3_f32 v248, v132, v133, v248
    v_max3_f32 v249, v134, v135, v249
    v_max3_f32 v248, v136, v137, v248
    v_max3_f32 v249, v138, v139, v249
    v_max3_f32 v248, v140, v141, v248
    v_max3_f32 v249, v142, v143, v249
    v_max_f32 v248, v248, v249
    v_mov_b32 v249, v248
    s_nop 1
    v_permlane32_swap_b32 v248, v249
    v_max_f32 v248, v248, v249
    s_waitcnt vmcnt(0)
    s_barrier
    s_nop 0
    ds_read_b64_tr_b16 v[204:205], v245 offset:512
    ds_read_b64_tr_b16 v[206:207], v245 offset:640
    ds_read_b64_tr_b16 v[208:209], v245 offset:768
    ds_read_b64_tr_b16 v[210:211], v245 offset:896
    v_pk_add_f32 v[32:33], v[32:33], v[248:249] op_sel_hi:[1,0] neg_lo:[0,1] neg_hi:[0,1]
    v_pk_add_f32 v[34:35], v[34:35], v[248:249] op_sel_hi:[1,0] neg_lo:[0,1] neg_hi:[0,1]
    v_pk_add_f32 v[36:37], v[36:37], v[248:249] op_sel_hi:[1,0] neg_lo:[0,1] neg_hi:[0,1]
    v_pk_add_f32 v[38:39], v[38:39], v[248:249] op_sel_hi:[1,0] neg_lo:[0,1] neg_hi:[0,1]
    v_pk_add_f32 v[40:41], v[40:41], v[248:249] op_sel_hi:[1,0] neg_lo:[0,1] neg_hi:[0,1]
    v_pk_add_f32 v[42:43], v[42:43], v[248:249] op_sel_hi:[1,0] neg_lo:[0,1] neg_hi:[0,1]
    v_pk_add_f32 v[44:45], v[44:45], v[248:249] op_sel_hi:[1,0] neg_lo:[0,1] neg_hi:[0,1]
    v_pk_add_f32 v[46:47], v[46:47], v[248:249] op_sel_hi:[1,0] neg_lo:[0,1] neg_hi:[0,1]
    v_exp_f32 v32, v32
    v_exp_f32 v33, v33
    v_exp_f32 v34, v34
    v_exp_f32 v35, v35
    s_mul_i32 s57, s54, 192
    buffer_load_ushort a242, v6, s[44:47], s57 offen
    v_cvt_pk_bf16_f32 v32, v32, v33
    v_exp_f32 v36, v36
    v_exp_f32 v37, v37
    v_cvt_pk_bf16_f32 v33, v34, v35
    v_exp_f32 v38, v38
    v_exp_f32 v39, v39
    v_cvt_pk_bf16_f32 v34, v36, v37
    ds_read_b64_tr_b16 v[212:213], v245 offset:1024
    v_exp_f32 v40, v40
    v_exp_f32 v41, v41
    v_exp_f32 v42, v42
    v_exp_f32 v43, v43
    ds_read_b64_tr_b16 v[214:215], v245 offset:1152
    v_cvt_pk_bf16_f32 v35, v38, v39
    buffer_load_dwordx4 a[0:3], v2, s[36:39], s98 offen offset:0 sc1
    v_exp_f32 v44, v44
    v_exp_f32 v45, v45
    v_cvt_pk_bf16_f32 v36, v40, v41
    ds_read_b64_tr_b16 v[216:217], v245 offset:1280
    buffer_load_dwordx4 a[4:7], v2, s[36:39], s98 offen offset:1024 sc1
    v_exp_f32 v46, v46
    v_exp_f32 v47, v47
    v_cvt_pk_bf16_f32 v37, v42, v43
    ds_read_b64_tr_b16 v[218:219], v245 offset:1408
    buffer_load_dwordx4 a[8:11], v2, s[36:39], s98 offen offset:2048 sc1
    v_cvt_pk_bf16_f32 v38, v44, v45
    buffer_load_dwordx4 a[12:15], v2, s[36:39], s98 offen offset:3072 sc1
    v_cvt_pk_bf16_f32 v39, v46, v47
    v_pk_add_f32 v[48:49], v[48:49], v[248:249] op_sel_hi:[1,0] neg_lo:[0,1] neg_hi:[0,1]
    v_pk_add_f32 v[50:51], v[50:51], v[248:249] op_sel_hi:[1,0] neg_lo:[0,1] neg_hi:[0,1]
    v_pk_add_f32 v[52:53], v[52:53], v[248:249] op_sel_hi:[1,0] neg_lo:[0,1] neg_hi:[0,1]
    v_pk_add_f32 v[54:55], v[54:55], v[248:249] op_sel_hi:[1,0] neg_lo:[0,1] neg_hi:[0,1]
    v_pk_add_f32 v[56:57], v[56:57], v[248:249] op_sel_hi:[1,0] neg_lo:[0,1] neg_hi:[0,1]
    v_pk_add_f32 v[58:59], v[58:59], v[248:249] op_sel_hi:[1,0] neg_lo:[0,1] neg_hi:[0,1]
    v_pk_add_f32 v[60:61], v[60:61], v[248:249] op_sel_hi:[1,0] neg_lo:[0,1] neg_hi:[0,1]
    v_pk_add_f32 v[62:63], v[62:63], v[248:249] op_sel_hi:[1,0] neg_lo:[0,1] neg_hi:[0,1]
    s_waitcnt lgkmcnt(6)
    v_mfma_f32_32x32x16_bf16 v[228:243], v[204:207], v[32:35], 0
    v_exp_f32 v48, v48
    v_exp_f32 v49, v49
    v_exp_f32 v50, v50
    v_exp_f32_e64 v51, v51
    s_add_u32 s98, s98, 4096
    buffer_load_dwordx4 a[16:19], v2, s[36:39], s98 offen offset:0 sc1
    v_cvt_pk_bf16_f32 v48, v48, v49
    v_exp_f32 v52, v52
    v_exp_f32 v53, v53
    v_cvt_pk_bf16_f32 v49, v50, v51
    v_exp_f32 v54, v54
    v_exp_f32 v55, v55
    v_cvt_pk_bf16_f32 v50, v52, v53
    s_waitcnt lgkmcnt(4)
    v_mfma_f32_32x32x16_bf16 v[228:243], v[208:211], v[36:39], v[228:243]
    ds_read_b64_tr_b16 v[204:205], v245 offset:1536
    v_exp_f32 v56, v56
    v_exp_f32 v57, v57
    v_exp_f32 v58, v58
    v_exp_f32_e64 v59, v59
    ds_read_b64_tr_b16 v[206:207], v245 offset:1664
    v_cvt_pk_bf16_f32 v51, v54, v55
    buffer_load_dwordx4 a[20:23], v2, s[36:39], s98 offen offset:1024 sc1
    v_exp_f32 v60, v60
    v_exp_f32 v61, v61
    v_cvt_pk_bf16_f32 v52, v56, v57
    ds_read_b64_tr_b16 v[208:209], v245 offset:1792
    buffer_load_dwordx4 a[24:27], v2, s[36:39], s98 offen offset:2048 sc1
    v_exp_f32 v62, v62
    v_exp_f32 v63, v63
    v_cvt_pk_bf16_f32 v53, v58, v59
    ds_read_b64_tr_b16 v[210:211], v245 offset:1920
    buffer_load_dwordx4 a[28:31], v2, s[36:39], s98 offen offset:3072 sc1
    v_cvt_pk_bf16_f32 v54, v60, v61
    s_add_u32 s98, s98, 4096
    buffer_load_dwordx4 a[32:35], v2, s[36:39], s98 offen offset:0 sc1
    v_cvt_pk_bf16_f32 v55, v62, v63
    v_pk_add_f32 v[64:65], v[64:65], v[248:249] op_sel_hi:[1,0] neg_lo:[0,1] neg_hi:[0,1]
    v_pk_add_f32 v[66:67], v[66:67], v[248:249] op_sel_hi:[1,0] neg_lo:[0,1] neg_hi:[0,1]
    v_pk_add_f32 v[68:69], v[68:69], v[248:249] op_sel_hi:[1,0] neg_lo:[0,1] neg_hi:[0,1]
    v_pk_add_f32 v[70:71], v[70:71], v[248:249] op_sel_hi:[1,0] neg_lo:[0,1] neg_hi:[0,1]
    v_pk_add_f32 v[72:73], v[72:73], v[248:249] op_sel_hi:[1,0] neg_lo:[0,1] neg_hi:[0,1]
    v_pk_add_f32 v[74:75], v[74:75], v[248:249] op_sel_hi:[1,0] neg_lo:[0,1] neg_hi:[0,1]
    v_pk_add_f32 v[76:77], v[76:77], v[248:249] op_sel_hi:[1,0] neg_lo:[0,1] neg_hi:[0,1]
    v_pk_add_f32 v[78:79], v[78:79], v[248:249] op_sel_hi:[1,0] neg_lo:[0,1] neg_hi:[0,1]
    s_waitcnt lgkmcnt(6)
    v_mfma_f32_32x32x16_bf16 v[228:243], v[212:215], v[48:51], v[228:243]
    v_exp_f32 v64, v64
    v_exp_f32 v65, v65
    v_exp_f32 v66, v66
    v_exp_f32_e64 v67, v67
    buffer_load_dwordx4 a[36:39], v2, s[36:39], s98 offen offset:1024 sc1
    v_cvt_pk_bf16_f32 v64, v64, v65
    v_exp_f32 v68, v68
    v_exp_f32 v69, v69
    v_cvt_pk_bf16_f32 v65, v66, v67
    v_exp_f32 v70, v70
    v_exp_f32 v71, v71
    v_cvt_pk_bf16_f32 v66, v68, v69
    s_waitcnt lgkmcnt(4)
    v_mfma_f32_32x32x16_bf16 v[228:243], v[216:219], v[52:55], v[228:243]
    ds_read_b64_tr_b16 v[212:213], v245 offset:2048
    v_exp_f32 v72, v72
    v_exp_f32 v73, v73
    v_exp_f32 v74, v74
    v_exp_f32_e64 v75, v75
    ds_read_b64_tr_b16 v[214:215], v245 offset:2176
    v_cvt_pk_bf16_f32 v67, v70, v71
    buffer_load_dwordx4 a[40:43], v2, s[36:39], s98 offen offset:2048 sc1
    v_exp_f32 v76, v76
    v_exp_f32 v77, v77
    v_cvt_pk_bf16_f32 v68, v72, v73
    ds_read_b64_tr_b16 v[216:217], v245 offset:2304
    buffer_load_dwordx4 a[44:47], v2, s[36:39], s98 offen offset:3072 sc1
    v_exp_f32 v78, v78
    v_exp_f32 v79, v79
    v_cvt_pk_bf16_f32 v69, v74, v75
    ds_read_b64_tr_b16 v[218:219], v245 offset:2432
    s_add_u32 s98, s98, 4096
    buffer_load_dwordx4 a[48:51], v2, s[36:39], s98 offen offset:0 sc1
    v_cvt_pk_bf16_f32 v70, v76, v77
    buffer_load_dwordx4 a[52:55], v2, s[36:39], s98 offen offset:1024 sc1
    v_cvt_pk_bf16_f32 v71, v78, v79
    v_pk_add_f32 v[80:81], v[80:81], v[248:249] op_sel_hi:[1,0] neg_lo:[0,1] neg_hi:[0,1]
    v_pk_add_f32 v[82:83], v[82:83], v[248:249] op_sel_hi:[1,0] neg_lo:[0,1] neg_hi:[0,1]
    v_pk_add_f32 v[84:85], v[84:85], v[248:249] op_sel_hi:[1,0] neg_lo:[0,1] neg_hi:[0,1]
    v_pk_add_f32 v[86:87], v[86:87], v[248:249] op_sel_hi:[1,0] neg_lo:[0,1] neg_hi:[0,1]
    v_pk_add_f32 v[88:89], v[88:89], v[248:249] op_sel_hi:[1,0] neg_lo:[0,1] neg_hi:[0,1]
    v_pk_add_f32 v[90:91], v[90:91], v[248:249] op_sel_hi:[1,0] neg_lo:[0,1] neg_hi:[0,1]
    v_pk_add_f32 v[92:93], v[92:93], v[248:249] op_sel_hi:[1,0] neg_lo:[0,1] neg_hi:[0,1]
    v_pk_add_f32 v[94:95], v[94:95], v[248:249] op_sel_hi:[1,0] neg_lo:[0,1] neg_hi:[0,1]
    s_waitcnt lgkmcnt(6)
    v_mfma_f32_32x32x16_bf16 v[228:243], v[204:207], v[64:67], v[228:243]
    v_exp_f32 v80, v80
    v_exp_f32 v81, v81
    v_exp_f32 v82, v82
    v_exp_f32_e64 v83, v83
    buffer_load_dwordx4 a[56:59], v2, s[36:39], s98 offen offset:2048 sc1
    v_cvt_pk_bf16_f32 v80, v80, v81
    v_exp_f32 v84, v84
    v_exp_f32 v85, v85
    v_cvt_pk_bf16_f32 v81, v82, v83
    v_exp_f32 v86, v86
    v_exp_f32 v87, v87
    v_cvt_pk_bf16_f32 v82, v84, v85
    s_waitcnt lgkmcnt(4)
    v_mfma_f32_32x32x16_bf16 v[228:243], v[208:211], v[68:71], v[228:243]
    ds_read_b64_tr_b16 v[204:205], v245 offset:2560
    v_exp_f32 v88, v88
    v_exp_f32 v89, v89
    v_exp_f32 v90, v90
    v_exp_f32_e64 v91, v91
    ds_read_b64_tr_b16 v[206:207], v245 offset:2688
    v_cvt_pk_bf16_f32 v83, v86, v87
    buffer_load_dwordx4 a[60:63], v2, s[36:39], s98 offen offset:3072 sc1
    v_exp_f32 v92, v92
    v_exp_f32 v93, v93
    v_cvt_pk_bf16_f32 v84, v88, v89
    ds_read_b64_tr_b16 v[208:209], v245 offset:2816
    s_add_u32 s98, s98, 4096
    buffer_load_dwordx4 a[64:67], v2, s[36:39], s98 offen offset:0 sc1
    v_exp_f32 v94, v94
    v_exp_f32 v95, v95
    v_cvt_pk_bf16_f32 v85, v90, v91
    ds_read_b64_tr_b16 v[210:211], v245 offset:2944
    buffer_load_dwordx4 a[68:71], v2, s[36:39], s98 offen offset:1024 sc1
    v_cvt_pk_bf16_f32 v86, v92, v93
    buffer_load_dwordx4 a[72:75], v2, s[36:39], s98 offen offset:2048 sc1
    v_cvt_pk_bf16_f32 v87, v94, v95
    v_pk_add_f32 v[96:97], v[96:97], v[248:249] op_sel_hi:[1,0] neg_lo:[0,1] neg_hi:[0,1]
    v_pk_add_f32 v[98:99], v[98:99], v[248:249] op_sel_hi:[1,0] neg_lo:[0,1] neg_hi:[0,1]
    v_pk_add_f32 v[100:101], v[100:101], v[248:249] op_sel_hi:[1,0] neg_lo:[0,1] neg_hi:[0,1]
    v_pk_add_f32 v[102:103], v[102:103], v[248:249] op_sel_hi:[1,0] neg_lo:[0,1] neg_hi:[0,1]
    v_pk_add_f32 v[104:105], v[104:105], v[248:249] op_sel_hi:[1,0] neg_lo:[0,1] neg_hi:[0,1]
    v_pk_add_f32 v[106:107], v[106:107], v[248:249] op_sel_hi:[1,0] neg_lo:[0,1] neg_hi:[0,1]
    v_pk_add_f32 v[108:109], v[108:109], v[248:249] op_sel_hi:[1,0] neg_lo:[0,1] neg_hi:[0,1]
    v_pk_add_f32 v[110:111], v[110:111], v[248:249] op_sel_hi:[1,0] neg_lo:[0,1] neg_hi:[0,1]
    s_waitcnt lgkmcnt(6)
    v_mfma_f32_32x32x16_bf16 v[228:243], v[212:215], v[80:83], v[228:243]
    v_exp_f32 v96, v96
    v_exp_f32 v97, v97
    v_exp_f32 v98, v98
    v_exp_f32_e64 v99, v99
    buffer_load_dwordx4 a[76:79], v2, s[36:39], s98 offen offset:3072 sc1
    v_cvt_pk_bf16_f32 v96, v96, v97
    v_exp_f32 v100, v100
    v_exp_f32 v101, v101
    v_cvt_pk_bf16_f32 v97, v98, v99
    v_exp_f32 v102, v102
    v_exp_f32 v103, v103
    v_cvt_pk_bf16_f32 v98, v100, v101
    s_waitcnt lgkmcnt(4)
    v_mfma_f32_32x32x16_bf16 v[228:243], v[216:219], v[84:87], v[228:243]
    ds_read_b64_tr_b16 v[212:213], v245 offset:3072
    v_exp_f32 v104, v104
    v_exp_f32 v105, v105
    v_exp_f32 v106, v106
    v_exp_f32_e64 v107, v107
    ds_read_b64_tr_b16 v[214:215], v245 offset:3200
    v_cvt_pk_bf16_f32 v99, v102, v103
    s_add_u32 s98, s98, 4096
    buffer_load_dwordx4 a[80:83], v2, s[36:39], s98 offen offset:0 sc1
    v_exp_f32 v108, v108
    v_exp_f32 v109, v109
    v_cvt_pk_bf16_f32 v100, v104, v105
    ds_read_b64_tr_b16 v[216:217], v245 offset:3328
    buffer_load_dwordx4 a[84:87], v2, s[36:39], s98 offen offset:1024 sc1
    v_exp_f32 v110, v110
    v_exp_f32 v111, v111
    v_cvt_pk_bf16_f32 v101, v106, v107
    ds_read_b64_tr_b16 v[218:219], v245 offset:3456
    buffer_load_dwordx4 a[88:91], v2, s[36:39], s98 offen offset:2048 sc1
    v_cvt_pk_bf16_f32 v102, v108, v109
    buffer_load_dwordx4 a[92:95], v2, s[36:39], s98 offen offset:3072 sc1
    v_cvt_pk_bf16_f32 v103, v110, v111
    v_pk_add_f32 v[112:113], v[112:113], v[248:249] op_sel_hi:[1,0] neg_lo:[0,1] neg_hi:[0,1]
    v_pk_add_f32 v[114:115], v[114:115], v[248:249] op_sel_hi:[1,0] neg_lo:[0,1] neg_hi:[0,1]
    v_pk_add_f32 v[116:117], v[116:117], v[248:249] op_sel_hi:[1,0] neg_lo:[0,1] neg_hi:[0,1]
    v_pk_add_f32 v[118:119], v[118:119], v[248:249] op_sel_hi:[1,0] neg_lo:[0,1] neg_hi:[0,1]
    v_pk_add_f32 v[120:121], v[120:121], v[248:249] op_sel_hi:[1,0] neg_lo:[0,1] neg_hi:[0,1]
    v_pk_add_f32 v[122:123], v[122:123], v[248:249] op_sel_hi:[1,0] neg_lo:[0,1] neg_hi:[0,1]
    v_pk_add_f32 v[124:125], v[124:125], v[248:249] op_sel_hi:[1,0] neg_lo:[0,1] neg_hi:[0,1]
    v_pk_add_f32 v[126:127], v[126:127], v[248:249] op_sel_hi:[1,0] neg_lo:[0,1] neg_hi:[0,1]
    s_waitcnt lgkmcnt(6)
    v_mfma_f32_32x32x16_bf16 v[228:243], v[204:207], v[96:99], v[228:243]
    v_exp_f32 v112, v112
    v_exp_f32 v113, v113
    v_exp_f32 v114, v114
    v_exp_f32_e64 v115, v115
    s_add_u32 s98, s98, 4096
    buffer_load_dwordx4 a[96:99], v2, s[36:39], s98 offen offset:0 sc1
    v_cvt_pk_bf16_f32 v112, v112, v113
    v_exp_f32 v116, v116
    v_exp_f32 v117, v117
    v_cvt_pk_bf16_f32 v113, v114, v115
    v_exp_f32 v118, v118
    v_exp_f32 v119, v119
    v_cvt_pk_bf16_f32 v114, v116, v117
    s_waitcnt lgkmcnt(4)
    v_mfma_f32_32x32x16_bf16 v[228:243], v[208:211], v[100:103], v[228:243]
    ds_read_b64_tr_b16 v[204:205], v245 offset:3584
    v_exp_f32 v120, v120
    v_exp_f32 v121, v121
    v_exp_f32 v122, v122
    v_exp_f32_e64 v123, v123
    ds_read_b64_tr_b16 v[206:207], v245 offset:3712
    v_cvt_pk_bf16_f32 v115, v118, v119
    buffer_load_dwordx4 a[100:103], v2, s[36:39], s98 offen offset:1024 sc1
    v_exp_f32 v124, v124
    v_exp_f32 v125, v125
    v_cvt_pk_bf16_f32 v116, v120, v121
    ds_read_b64_tr_b16 v[208:209], v245 offset:3840
    buffer_load_dwordx4 a[104:107], v2, s[36:39], s98 offen offset:2048 sc1
    v_exp_f32 v126, v126
    v_exp_f32 v127, v127
    v_cvt_pk_bf16_f32 v117, v122, v123
    ds_read_b64_tr_b16 v[210:211], v245 offset:3968
    buffer_load_dwordx4 a[108:111], v2, s[36:39], s98 offen offset:3072 sc1
    v_cvt_pk_bf16_f32 v118, v124, v125
    s_add_u32 s98, s98, 4096
    buffer_load_dwordx4 a[112:115], v2, s[36:39], s98 offen offset:0 sc1
    v_cvt_pk_bf16_f32 v119, v126, v127
    v_pk_add_f32 v[128:129], v[128:129], v[248:249] op_sel_hi:[1,0] neg_lo:[0,1] neg_hi:[0,1]
    v_pk_add_f32 v[130:131], v[130:131], v[248:249] op_sel_hi:[1,0] neg_lo:[0,1] neg_hi:[0,1]
    v_pk_add_f32 v[132:133], v[132:133], v[248:249] op_sel_hi:[1,0] neg_lo:[0,1] neg_hi:[0,1]
    v_pk_add_f32 v[134:135], v[134:135], v[248:249] op_sel_hi:[1,0] neg_lo:[0,1] neg_hi:[0,1]
    v_pk_add_f32 v[136:137], v[136:137], v[248:249] op_sel_hi:[1,0] neg_lo:[0,1] neg_hi:[0,1]
    v_pk_add_f32 v[138:139], v[138:139], v[248:249] op_sel_hi:[1,0] neg_lo:[0,1] neg_hi:[0,1]
    v_pk_add_f32 v[140:141], v[140:141], v[248:249] op_sel_hi:[1,0] neg_lo:[0,1] neg_hi:[0,1]
    v_pk_add_f32 v[142:143], v[142:143], v[248:249] op_sel_hi:[1,0] neg_lo:[0,1] neg_hi:[0,1]
    s_waitcnt lgkmcnt(6)
    v_mfma_f32_32x32x16_bf16 v[228:243], v[212:215], v[112:115], v[228:243]
    v_exp_f32 v128, v128
    v_exp_f32 v129, v129
    v_exp_f32 v130, v130
    v_exp_f32_e64 v131, v131
    buffer_load_dwordx4 a[116:119], v2, s[36:39], s98 offen offset:1024 sc1
    v_cvt_pk_bf16_f32 v128, v128, v129
    v_exp_f32 v132, v132
    v_exp_f32 v133, v133
    v_cvt_pk_bf16_f32 v129, v130, v131
    v_exp_f32 v134, v134
    v_exp_f32 v135, v135
    v_cvt_pk_bf16_f32 v130, v132, v133
    s_waitcnt lgkmcnt(4)
    v_mfma_f32_32x32x16_bf16 v[228:243], v[216:219], v[116:119], v[228:243]
    ds_read_b64_tr_b16 v[212:213], v245 offset:4096
    v_exp_f32 v136, v136
    v_exp_f32 v137, v137
    v_exp_f32 v138, v138
    v_exp_f32_e64 v139, v139
    ds_read_b64_tr_b16 v[214:215], v245 offset:4224
    v_cvt_pk_bf16_f32 v131, v134, v135
    buffer_load_dwordx4 a[120:123], v2, s[36:39], s98 offen offset:2048 sc1
    v_exp_f32 v140, v140
    v_exp_f32 v141, v141
    v_cvt_pk_bf16_f32 v132, v136, v137
    ds_read_b64_tr_b16 v[216:217], v245 offset:4352
    buffer_load_dwordx4 a[124:127], v2, s[36:39], s98 offen offset:3072 sc1
    v_exp_f32 v142, v142
    v_exp_f32 v143, v143
    v_cvt_pk_bf16_f32 v133, v138, v139
    ds_read_b64_tr_b16 v[218:219], v245 offset:4480
    s_add_u32 s98, s98, 4096
    buffer_load_dwordx4 a[128:131], v2, s[36:39], s98 offen offset:0 sc1
    v_cvt_pk_bf16_f32 v134, v140, v141
    buffer_load_dwordx4 a[132:135], v2, s[36:39], s98 offen offset:1024 sc1
    v_cvt_pk_bf16_f32 v135, v142, v143
    v_pk_add_f32 v[144:145], v[144:145], v[248:249] op_sel_hi:[1,0] neg_lo:[0,1] neg_hi:[0,1]
    v_pk_add_f32 v[146:147], v[146:147], v[248:249] op_sel_hi:[1,0] neg_lo:[0,1] neg_hi:[0,1]
    v_pk_add_f32 v[148:149], v[148:149], v[248:249] op_sel_hi:[1,0] neg_lo:[0,1] neg_hi:[0,1]
    v_pk_add_f32 v[150:151], v[150:151], v[248:249] op_sel_hi:[1,0] neg_lo:[0,1] neg_hi:[0,1]
    v_pk_add_f32 v[152:153], v[152:153], v[248:249] op_sel_hi:[1,0] neg_lo:[0,1] neg_hi:[0,1]
    v_pk_add_f32 v[154:155], v[154:155], v[248:249] op_sel_hi:[1,0] neg_lo:[0,1] neg_hi:[0,1]
    v_pk_add_f32 v[156:157], v[156:157], v[248:249] op_sel_hi:[1,0] neg_lo:[0,1] neg_hi:[0,1]
    v_pk_add_f32 v[158:159], v[158:159], v[248:249] op_sel_hi:[1,0] neg_lo:[0,1] neg_hi:[0,1]
    s_waitcnt lgkmcnt(6)
    v_mfma_f32_32x32x16_bf16 v[228:243], v[204:207], v[128:131], v[228:243]
    v_exp_f32 v144, v144
    v_exp_f32 v145, v145
    v_exp_f32 v146, v146
    v_exp_f32_e64 v147, v147
    buffer_load_dwordx4 a[136:139], v2, s[36:39], s98 offen offset:2048 sc1
    v_cvt_pk_bf16_f32 v144, v144, v145
    v_exp_f32 v148, v148
    v_exp_f32 v149, v149
    v_cvt_pk_bf16_f32 v145, v146, v147
    v_exp_f32 v150, v150
    v_exp_f32 v151, v151
    v_cvt_pk_bf16_f32 v146, v148, v149
    s_waitcnt lgkmcnt(4)
    v_mfma_f32_32x32x16_bf16 v[228:243], v[208:211], v[132:135], v[228:243]
    ds_read_b64_tr_b16 v[204:205], v245 offset:0
    v_exp_f32 v152, v152
    v_exp_f32 v153, v153
    v_exp_f32 v154, v154
    v_exp_f32_e64 v155, v155
    ds_read_b64_tr_b16 v[206:207], v245 offset:128
    v_cvt_pk_bf16_f32 v147, v150, v151
    buffer_load_dwordx4 a[140:143], v2, s[36:39], s98 offen offset:3072 sc1
    v_exp_f32 v156, v156
    v_exp_f32 v157, v157
    v_cvt_pk_bf16_f32 v148, v152, v153
    ds_read_b64_tr_b16 v[208:209], v245 offset:256
    s_add_u32 s98, s98, 4096
    buffer_load_dwordx4 a[144:147], v2, s[36:39], s98 offen offset:0 sc1
    v_exp_f32 v158, v158
    v_exp_f32 v159, v159
    v_cvt_pk_bf16_f32 v149, v154, v155
    ds_read_b64_tr_b16 v[210:211], v245 offset:384
    buffer_load_dwordx4 a[148:151], v2, s[36:39], s98 offen offset:1024 sc1
    v_cvt_pk_bf16_f32 v150, v156, v157
    buffer_load_dwordx4 a[152:155], v2, s[36:39], s98 offen offset:2048 sc1
    v_cvt_pk_bf16_f32 v151, v158, v159
    v_bfi_b32 v16, v220, 0, v144
    v_bfi_b32 v17, v221, 0, v145
    v_bfi_b32 v18, v222, 0, v146
    v_bfi_b32 v19, v223, 0, v147
    v_bfi_b32 v20, v224, 0, v148
    v_bfi_b32 v21, v225, 0, v149
    v_bfi_b32 v22, v226, 0, v150
    v_bfi_b32 v23, v227, 0, v151
    v_and_b32 v144, v220, v144
    v_and_b32 v145, v221, v145
    v_and_b32 v146, v222, v146
    v_and_b32 v147, v223, v147
    v_and_b32 v148, v224, v148
    v_and_b32 v149, v225, v149
    v_and_b32 v150, v226, v150
    v_and_b32 v151, v227, v151
    s_waitcnt lgkmcnt(6)
    v_mfma_f32_32x32x16_bf16 v[228:243], v[212:215], v[144:147], v[228:243]
    s_waitcnt lgkmcnt(4)
    v_mfma_f32_32x32x16_bf16 v[228:243], v[216:219], v[148:151], v[228:243]
    s_waitcnt lgkmcnt(2)
    v_mfma_f32_32x32x16_bf16 v[228:243], v[204:207], v[16:19], v[228:243]
    s_waitcnt lgkmcnt(0)
    v_mfma_f32_32x32x16_bf16 v[228:243], v[208:211], v[20:23], v[228:243]
    s_nop 11
    v_mov_b32 v249, v236
    v_mov_b32 v250, v236
    s_nop 1
    v_permlane32_swap_b32 v249, v250
    v_rcp_f32 v250, v250
    s_nop 0
    s_nop 0
    v_pk_mul_f32 v[228:229], v[228:229], v[250:251] op_sel_hi:[1,0]
    v_pk_mul_f32 v[230:231], v[230:231], v[250:251] op_sel_hi:[1,0]
    v_pk_mul_f32 v[232:233], v[232:233], v[250:251] op_sel_hi:[1,0]
    v_pk_mul_f32 v[234:235], v[234:235], v[250:251] op_sel_hi:[1,0]
    v_pk_mul_f32 v[236:237], v[236:237], v[250:251] op_sel_hi:[1,0]
    v_pk_mul_f32 v[238:239], v[238:239], v[250:251] op_sel_hi:[1,0]
    v_cvt_pk_bf16_f32 v8, v228, v229
    v_cvt_pk_bf16_f32 v9, v230, v231
    v_cvt_pk_bf16_f32 v10, v232, v233
    v_cvt_pk_bf16_f32 v11, v234, v235
    v_cvt_pk_bf16_f32 v12, v236, v237
    v_cvt_pk_bf16_f32 v13, v238, v239
    buffer_store_dwordx4 v[8:11], v252, s[36:39], s96 offen offset:0 sc1
    s_lshl_b32 s57, s53, 2
    s_add_u32 s57, s57, s55
    s_sub_i32 s58, 8, s57
    s_nop 0
    ds_read_b128 v[188:191], v244 offset:12288
    ds_read_b128 v[192:195], v244 offset:24576
    ds_read_b128 v[196:199], v244 offset:16384
    ds_read_b128 v[200:203], v244 offset:28672
    ds_read_b128 v[204:207], v244 offset:12800
    ds_read_b128 v[208:211], v244 offset:25088
    s_waitcnt lgkmcnt(5)
    v_mfma_f32_32x32x16_bf16 v[16:31], v[188:191], v[180:183], 0
    s_waitcnt lgkmcnt(4)
    v_mfma_f32_32x32x16_bf16 v[16:31], v[192:195], v[184:187], v[16:31]
    ds_read_b128 v[212:215], v244 offset:13312
    ds_read_b128 v[216:219], v244 offset:25600
    s_waitcnt lgkmcnt(5)
    v_mfma_f32_32x32x16_bf16 v[144:159], v[196:199], v[180:183], 0
    s_waitcnt lgkmcnt(4)
    v_mfma_f32_32x32x16_bf16 v[144:159], v[200:203], v[184:187], v[144:159]
    ds_read_b128 v[188:191], v244 offset:13824
    ds_read_b128 v[192:195], v244 offset:26112
    s_nop 3
    s_cmp_gt_i32 s58, 0
    s_cbranch_scc1 FX_68
FXB_69:
    s_waitcnt lgkmcnt(5)
    v_mfma_f32_32x32x16_bf16 v[32:47], v[204:207], v[180:183], 0
    s_waitcnt lgkmcnt(4)
    v_mfma_f32_32x32x16_bf16 v[32:47], v[208:211], v[184:187], v[32:47]
    ds_read_b128 v[196:199], v244 offset:14336
    ds_read_b128 v[200:203], v244 offset:26624
    s_waitcnt lgkmcnt(5)
    v_mfma_f32_32x32x16_bf16 v[48:63], v[212:215], v[180:183], 0
    v_cndmask_b32 v144, v16, v144, s[64:65]
    v_cndmask_b32 v145, v17, v145, s[66:67]
    v_cndmask_b32 v146, v18, v146, s[68:69]
    v_cndmask_b32 v147, v19, v147, s[70:71]
    v_cndmask_b32 v148, v20, v148, s[72:73]
    v_cndmask_b32 v149, v21, v149, s[74:75]
    v_cndmask_b32 v150, v22, v150, s[76:77]
    v_cndmask_b32 v151, v23, v151, s[78:79]
    v_cndmask_b32 v152, v24, v152, s[80:81]
    v_cndmask_b32 v153, v25, v153, s[82:83]
    v_cndmask_b32 v154, v26, v154, s[84:85]
    v_cndmask_b32 v155, v27, v155, s[86:87]
    s_waitcnt lgkmcnt(4)
    s_nop 0
    v_mfma_f32_32x32x16_bf16 v[48:63], v[216:219], v[184:187], v[48:63]
    ds_read_b128 v[204:207], v244 offset:14848
    ds_read_b128 v[208:211], v244 offset:27136
    v_cndmask_b32 v156, v28, v156, s[88:89]
    v_cndmask_b32 v157, v29, v157, s[90:91]
    v_cndmask_b32 v158, v30, v158, s[92:93]
    v_cndmask_b32 v159, v31, v159, s[94:95]
    v_max3_f32 v248, v144, v145, v146
    v_max3_f32 v249, v147, v148, v149
    v_max3_f32 v248, v150, v151, v248
    v_max3_f32 v249, v152, v153, v249
    v_max3_f32 v248, v154, v155, v248
    v_max3_f32 v249, v156, v157, v249
    v_max3_f32 v248, v158, v159, v248
    s_cmp_gt_i32 s58, 1
    s_cbranch_scc1 FX_70
FXB_71:
    s_waitcnt lgkmcnt(5)
    s_nop 0
    v_mfma_f32_32x32x16_bf16 v[64:79], v[188:191], v[180:183], 0
    v_max3_f32 v248, v32, v33, v248
    v_max3_f32 v249, v34, v35, v249
    v_max3_f32 v248, v36, v37, v248
    v_max3_f32 v249, v38, v39, v249
    s_waitcnt lgkmcnt(4)
    s_nop 0
    v_mfma_f32_32x32x16_bf16 v[64:79], v[192:195], v[184:187], v[64:79]
    ds_read_b128 v[212:215], v244 offset:15360
    ds_read_b128 v[216:219], v244 offset:27648
    v_max3_f32 v248, v40, v41, v248
    v_max3_f32 v249, v42, v43, v249
    v_max3_f32 v248, v44, v45, v248
    v_max3_f32 v249, v46, v47, v249
    s_cmp_gt_i32 s58, 2
    s_cbranch_scc1 FX_72
FXB_73:
    s_waitcnt lgkmcnt(5)
    s_nop 0
    v_mfma_f32_32x32x16_bf16 v[80:95], v[196:199], v[180:183], 0
    v_max3_f32 v248, v48, v49, v248
    v_max3_f32 v249, v50, v51, v249
    v_max3_f32 v248, v52, v53, v248
    v_max3_f32 v249, v54, v55, v249
    s_waitcnt lgkmcnt(4)
    s_nop 0
    v_mfma_f32_32x32x16_bf16 v[80:95], v[200:203], v[184:187], v[80:95]
    ds_read_b128 v[188:191], v244 offset:15872
    ds_read_b128 v[192:195], v244 offset:28160
    v_max3_f32 v248, v56, v57, v248
    v_max3_f32 v249, v58, v59, v249
    v_max3_f32 v248, v60, v61, v248
    v_max3_f32 v249, v62, v63, v249
    s_cmp_gt_i32 s58, 3
    s_cbranch_scc1 FX_74
FXB_75:
    s_waitcnt lgkmcnt(5)
    s_nop 0
    v_mfma_f32_32x32x16_bf16 v[96:111], v[204:207], v[180:183], 0
    v_max3_f32 v248, v64, v65, v248
    v_max3_f32 v249, v66, v67, v249
    v_max3_f32 v248, v68, v69, v248
    v_max3_f32 v249, v70, v71, v249
    s_waitcnt lgkmcnt(4)
    s_nop 0
    v_mfma_f32_32x32x16_bf16 v[96:111], v[208:211], v[184:187], v[96:111]
    v_max3_f32 v248, v72, v73, v248
    v_max3_f32 v249, v74, v75, v249
    v_max3_f32 v248, v76, v77, v248
    v_max3_f32 v249, v78, v79, v249
    s_cmp_gt_i32 s58, 4
    s_cbranch_scc1 FX_76
FXB_77:
    s_waitcnt lgkmcnt(3)
    s_nop 0
    v_mfma_f32_32x32x16_bf16 v[112:127], v[212:215], v[180:183], 0
    v_max3_f32 v248, v80, v81, v248
    v_max3_f32 v249, v82, v83, v249
    v_max3_f32 v248, v84, v85, v248
    v_max3_f32 v249, v86, v87, v249
    s_waitcnt lgkmcnt(2)
    s_nop 0
    v_mfma_f32_32x32x16_bf16 v[112:127], v[216:219], v[184:187], v[112:127]
    v_max3_f32 v248, v88, v89, v248
    v_max3_f32 v249, v90, v91, v249
    v_max3_f32 v248, v92, v93, v248
    v_max3_f32 v249, v94, v95, v249
    s_cmp_gt_i32 s58, 5
    s_cbranch_scc1 FX_78
FXB_79:
    s_waitcnt lgkmcnt(1)
    s_nop 0
    v_mfma_f32_32x32x16_bf16 v[128:143], v[188:191], v[180:183], 0
    v_max3_f32 v248, v96, v97, v248
    v_max3_f32 v249, v98, v99, v249
    v_max3_f32 v248, v100, v101, v248
    v_max3_f32 v249, v102, v103, v249
    s_waitcnt lgkmcnt(0)
    s_nop 0
    v_mfma_f32_32x32x16_bf16 v[128:143], v[192:195], v[184:187], v[128:143]
    v_max3_f32 v248, v104, v105, v248
    v_max3_f32 v249, v106, v107, v249
    v_max3_f32 v248, v108, v109, v248
    v_max3_f32 v249, v110, v111, v249
    s_cmp_gt_i32 s58, 6
    s_cbranch_scc1 FX_80
FXB_81:
    v_max3_f32 v248, v112, v113, v248
    v_max3_f32 v249, v114, v115, v249
    v_max3_f32 v248, v116, v117, v248
    v_max3_f32 v249, v118, v119, v249
    v_max3_f32 v248, v120, v121, v248
    v_max3_f32 v249, v122, v123, v249
    v_max3_f32 v248, v124, v125, v248
    v_max3_f32 v249, v126, v127, v249
    s_cmp_gt_i32 s58, 7
    s_cbranch_scc1 FX_82
FXB_83:
    v_max3_f32 v248, v128, v129, v248
    v_max3_f32 v249, v130, v131, v249
    v_max3_f32 v248, v132, v133, v248
    v_max3_f32 v249, v134, v135, v249
    v_max3_f32 v248, v136, v137, v248
    v_max3_f32 v249, v138, v139, v249
    v_max3_f32 v248, v140, v141, v248
    v_max3_f32 v249, v142, v143, v249
    v_max_f32 v248, v248, v249
    v_mov_b32 v249, v248
    s_nop 1
    v_permlane32_swap_b32 v248, v249
    v_max_f32 v248, v248, v249
    s_cmp_lg_u32 s55, 3
    s_cbranch_scc1 LP_84
    v_lshlrev_b32 v8, 2, v1
    v_add_u32 v8, 218112, v8
    v_add_u32 v9, 256, v8
    v_add_u32 v10, 128, v1
    v_min_u32 v10, 159, v10
    v_lshlrev_b32_e64 v10, 2, v10
    v_add_u32 v10, 218112, v10
    s_mov_b32 s57, 0
POLL_85:
    buffer_load_dword v249, v8, s[36:39], 0 offen sc1
    buffer_load_dword v250, v9, s[36:39], 0 offen sc1
    buffer_load_dword v251, v10, s[36:39], 0 offen sc1
    s_waitcnt vmcnt(0)
    v_cmp_ne_u32 vcc, s52, v249
    v_cmp_ne_u32 s[58:59], s52, v250
    s_nop 0
    s_or_b64 vcc, vcc, s[58:59]
    v_cmp_ne_u32 s[58:59], s52, v251
    s_nop 0
    s_or_b64 vcc, vcc, s[58:59]
    s_add_u32 s57, s57, 1
    s_cmp_gt_u32 s57, 400000
    s_cbranch_scc1 POLLD_86
    s_cbranch_vccnz POLL_85
POLLD_86:
LP_84:
    s_barrier
    s_nop 0
    ds_read_b64_tr_b16 v[204:205], v246 offset:512
    ds_read_b64_tr_b16 v[206:207], v246 offset:640
    ds_read_b64_tr_b16 v[208:209], v246 offset:768
    ds_read_b64_tr_b16 v[210:211], v246 offset:896
    v_pk_add_f32 v[32:33], v[32:33], v[248:249] op_sel_hi:[1,0] neg_lo:[0,1] neg_hi:[0,1]
    v_pk_add_f32 v[34:35], v[34:35], v[248:249] op_sel_hi:[1,0] neg_lo:[0,1] neg_hi:[0,1]
    v_pk_add_f32 v[36:37], v[36:37], v[248:249] op_sel_hi:[1,0] neg_lo:[0,1] neg_hi:[0,1]
    v_pk_add_f32 v[38:39], v[38:39], v[248:249] op_sel_hi:[1,0] neg_lo:[0,1] neg_hi:[0,1]
    v_pk_add_f32 v[40:41], v[40:41], v[248:249] op_sel_hi:[1,0] neg_lo:[0,1] neg_hi:[0,1]
    v_pk_add_f32 v[42:43], v[42:43], v[248:249] op_sel_hi:[1,0] neg_lo:[0,1] neg_hi:[0,1]
    v_pk_add_f32 v[44:45], v[44:45], v[248:249] op_sel_hi:[1,0] neg_lo:[0,1] neg_hi:[0,1]
    v_pk_add_f32 v[46:47], v[46:47], v[248:249] op_sel_hi:[1,0] neg_lo:[0,1] neg_hi:[0,1]
    v_exp_f32 v32, v32
    v_exp_f32 v33, v33
    v_exp_f32 v34, v34
    v_exp_f32 v35, v35
    buffer_load_dwordx4 a[156:159], v2, s[36:39], s98 offen offset:3072 sc1
    v_cvt_pk_bf16_f32 v32, v32, v33
    v_exp_f32 v36, v36
    v_exp_f32 v37, v37
    v_cvt_pk_bf16_f32 v33, v34, v35
    v_exp_f32 v38, v38
    v_exp_f32 v39, v39
    v_cvt_pk_bf16_f32 v34, v36, v37
    ds_read_b64_tr_b16 v[212:213], v246 offset:1024
    v_exp_f32 v40, v40
    v_exp_f32 v41, v41
    v_exp_f32 v42, v42
    v_exp_f32 v43, v43
    ds_read_b64_tr_b16 v[214:215], v246 offset:1152
    v_cvt_pk_bf16_f32 v35, v38, v39
    s_add_u32 s98, s98, 4096
    buffer_load_dwordx4 a[160:163], v2, s[36:39], s98 offen offset:0 sc1
    v_exp_f32 v44, v44
    v_exp_f32 v45, v45
    v_cvt_pk_bf16_f32 v36, v40, v41
    ds_read_b64_tr_b16 v[216:217], v246 offset:1280
    buffer_load_dwordx4 a[164:167], v2, s[36:39], s98 offen offset:1024 sc1
    v_exp_f32 v46, v46
    v_exp_f32 v47, v47
    v_cvt_pk_bf16_f32 v37, v42, v43
    ds_read_b64_tr_b16 v[218:219], v246 offset:1408
    buffer_load_dwordx4 a[168:171], v2, s[36:39], s98 offen offset:2048 sc1
    v_cvt_pk_bf16_f32 v38, v44, v45
    buffer_load_dwordx4 a[172:175], v2, s[36:39], s98 offen offset:3072 sc1
    v_cvt_pk_bf16_f32 v39, v46, v47
    v_pk_add_f32 v[48:49], v[48:49], v[248:249] op_sel_hi:[1,0] neg_lo:[0,1] neg_hi:[0,1]
    v_pk_add_f32 v[50:51], v[50:51], v[248:249] op_sel_hi:[1,0] neg_lo:[0,1] neg_hi:[0,1]
    v_pk_add_f32 v[52:53], v[52:53], v[248:249] op_sel_hi:[1,0] neg_lo:[0,1] neg_hi:[0,1]
    v_pk_add_f32 v[54:55], v[54:55], v[248:249] op_sel_hi:[1,0] neg_lo:[0,1] neg_hi:[0,1]
    v_pk_add_f32 v[56:57], v[56:57], v[248:249] op_sel_hi:[1,0] neg_lo:[0,1] neg_hi:[0,1]
    v_pk_add_f32 v[58:59], v[58:59], v[248:249] op_sel_hi:[1,0] neg_lo:[0,1] neg_hi:[0,1]
    v_pk_add_f32 v[60:61], v[60:61], v[248:249] op_sel_hi:[1,0] neg_lo:[0,1] neg_hi:[0,1]
    v_pk_add_f32 v[62:63], v[62:63], v[248:249] op_sel_hi:[1,0] neg_lo:[0,1] neg_hi:[0,1]
    s_waitcnt lgkmcnt(6)
    v_mfma_f32_32x32x16_bf16 v[228:243], v[204:207], v[32:35], 0
    v_exp_f32 v48, v48
    v_exp_f32 v49, v49
    v_exp_f32 v50, v50
    v_exp_f32_e64 v51, v51
    s_add_u32 s98, s98, 4096
    buffer_load_dwordx4 a[176:179], v2, s[36:39], s98 offen offset:0 sc1
    v_cvt_pk_bf16_f32 v48, v48, v49
    v_exp_f32 v52, v52
    v_exp_f32 v53, v53
    v_cvt_pk_bf16_f32 v49, v50, v51
    v_exp_f32 v54, v54
    v_exp_f32 v55, v55
    v_cvt_pk_bf16_f32 v50, v52, v53
    s_waitcnt lgkmcnt(4)
    v_mfma_f32_32x32x16_bf16 v[228:243], v[208:211], v[36:39], v[228:243]
    ds_read_b64_tr_b16 v[204:205], v246 offset:1536
    v_exp_f32 v56, v56
    v_exp_f32 v57, v57
    v_exp_f32 v58, v58
    v_exp_f32_e64 v59, v59
    ds_read_b64_tr_b16 v[206:207], v246 offset:1664
    v_cvt_pk_bf16_f32 v51, v54, v55
    buffer_load_dwordx4 a[180:183], v2, s[36:39], s98 offen offset:1024 sc1
    v_exp_f32 v60, v60
    v_exp_f32 v61, v61
    v_cvt_pk_bf16_f32 v52, v56, v57
    ds_read_b64_tr_b16 v[208:209], v246 offset:1792
    buffer_load_dwordx4 a[184:187], v2, s[36:39], s98 offen offset:2048 sc1
    v_exp_f32 v62, v62
    v_exp_f32 v63, v63
    v_cvt_pk_bf16_f32 v53, v58, v59
    ds_read_b64_tr_b16 v[210:211], v246 offset:1920
    buffer_load_dwordx4 a[188:191], v2, s[36:39], s98 offen offset:3072 sc1
    v_cvt_pk_bf16_f32 v54, v60, v61
    s_add_u32 s98, s98, 4096
    buffer_load_dwordx4 a[192:195], v2, s[36:39], s98 offen offset:0 sc1
    v_cvt_pk_bf16_f32 v55, v62, v63
    v_pk_add_f32 v[64:65], v[64:65], v[248:249] op_sel_hi:[1,0] neg_lo:[0,1] neg_hi:[0,1]
    v_pk_add_f32 v[66:67], v[66:67], v[248:249] op_sel_hi:[1,0] neg_lo:[0,1] neg_hi:[0,1]
    v_pk_add_f32 v[68:69], v[68:69], v[248:249] op_sel_hi:[1,0] neg_lo:[0,1] neg_hi:[0,1]
    v_pk_add_f32 v[70:71], v[70:71], v[248:249] op_sel_hi:[1,0] neg_lo:[0,1] neg_hi:[0,1]
    v_pk_add_f32 v[72:73], v[72:73], v[248:249] op_sel_hi:[1,0] neg_lo:[0,1] neg_hi:[0,1]
    v_pk_add_f32 v[74:75], v[74:75], v[248:249] op_sel_hi:[1,0] neg_lo:[0,1] neg_hi:[0,1]
    v_pk_add_f32 v[76:77], v[76:77], v[248:249] op_sel_hi:[1,0] neg_lo:[0,1] neg_hi:[0,1]
    v_pk_add_f32 v[78:79], v[78:79], v[248:249] op_sel_hi:[1,0] neg_lo:[0,1] neg_hi:[0,1]
    s_waitcnt lgkmcnt(6)
    v_mfma_f32_32x32x16_bf16 v[228:243], v[212:215], v[48:51], v[228:243]
    v_exp_f32 v64, v64
    v_exp_f32 v65, v65
    v_exp_f32 v66, v66
    v_exp_f32_e64 v67, v67
    buffer_load_dwordx4 a[196:199], v2, s[36:39], s98 offen offset:1024 sc1
    v_cvt_pk_bf16_f32 v64, v64, v65
    v_exp_f32 v68, v68
    v_exp_f32 v69, v69
    v_cvt_pk_bf16_f32 v65, v66, v67
    v_exp_f32 v70, v70
    v_exp_f32 v71, v71
    v_cvt_pk_bf16_f32 v66, v68, v69
    s_waitcnt lgkmcnt(4)
    v_mfma_f32_32x32x16_bf16 v[228:243], v[216:219], v[52:55], v[228:243]
    ds_read_b64_tr_b16 v[212:213], v246 offset:2048
    v_exp_f32 v72, v72
    v_exp_f32 v73, v73
    v_exp_f32 v74, v74
    v_exp_f32_e64 v75, v75
    ds_read_b64_tr_b16 v[214:215], v246 offset:2176
    v_cvt_pk_bf16_f32 v67, v70, v71
    buffer_load_dwordx2 a[200:201], v7, s[8:11], s63 offen offset:0
    v_exp_f32 v76, v76
    v_exp_f32 v77, v77
    v_cvt_pk_bf16_f32 v68, v72, v73
    ds_read_b64_tr_b16 v[216:217], v246 offset:2304
    buffer_load_dwordx2 a[202:203], v7, s[8:11], s63 offen offset:32
    v_exp_f32 v78, v78
    v_exp_f32 v79, v79
    v_cvt_pk_bf16_f32 v69, v74, v75
    ds_read_b64_tr_b16 v[218:219], v246 offset:2432
    buffer_load_dwordx2 a[204:205], v7, s[8:11], s63 offen offset:64
    v_cvt_pk_bf16_f32 v70, v76, v77
    buffer_load_dwordx2 a[206:207], v7, s[8:11], s63 offen offset:96
    v_cvt_pk_bf16_f32 v71, v78, v79
    v_pk_add_f32 v[80:81], v[80:81], v[248:249] op_sel_hi:[1,0] neg_lo:[0,1] neg_hi:[0,1]
    v_pk_add_f32 v[82:83], v[82:83], v[248:249] op_sel_hi:[1,0] neg_lo:[0,1] neg_hi:[0,1]
    v_pk_add_f32 v[84:85], v[84:85], v[248:249] op_sel_hi:[1,0] neg_lo:[0,1] neg_hi:[0,1]
    v_pk_add_f32 v[86:87], v[86:87], v[248:249] op_sel_hi:[1,0] neg_lo:[0,1] neg_hi:[0,1]
    v_pk_add_f32 v[88:89], v[88:89], v[248:249] op_sel_hi:[1,0] neg_lo:[0,1] neg_hi:[0,1]
    v_pk_add_f32 v[90:91], v[90:91], v[248:249] op_sel_hi:[1,0] neg_lo:[0,1] neg_hi:[0,1]
    v_pk_add_f32 v[92:93], v[92:93], v[248:249] op_sel_hi:[1,0] neg_lo:[0,1] neg_hi:[0,1]
    v_pk_add_f32 v[94:95], v[94:95], v[248:249] op_sel_hi:[1,0] neg_lo:[0,1] neg_hi:[0,1]
    s_waitcnt lgkmcnt(6)
    v_mfma_f32_32x32x16_bf16 v[228:243], v[204:207], v[64:67], v[228:243]
    v_exp_f32 v80, v80
    v_exp_f32 v81, v81
    v_exp_f32 v82, v82
    v_exp_f32_e64 v83, v83
    buffer_load_dwordx2 a[208:209], v7, s[8:11], s63 offen offset:128
    v_cvt_pk_bf16_f32 v80, v80, v81
    v_exp_f32 v84, v84
    v_exp_f32 v85, v85
    v_cvt_pk_bf16_f32 v81, v82, v83
    v_exp_f32 v86, v86
    v_exp_f32 v87, v87
    v_cvt_pk_bf16_f32 v82, v84, v85
    s_waitcnt lgkmcnt(4)
    v_mfma_f32_32x32x16_bf16 v[228:243], v[208:211], v[68:71], v[228:243]
    ds_read_b64_tr_b16 v[204:205], v246 offset:2560
    v_exp_f32 v88, v88
    v_exp_f32 v89, v89
    v_exp_f32 v90, v90
    v_exp_f32_e64 v91, v91
    ds_read_b64_tr_b16 v[206:207], v246 offset:2688
    v_cvt_pk_bf16_f32 v83, v86, v87
    s_add_u32 m0, s60, 0
    s_add_u32 s59, s99, 0
    buffer_load_dwordx4 v2, s[36:39], s59 offen sc1 lds
    v_exp_f32 v92, v92
    v_exp_f32 v93, v93
    v_cvt_pk_bf16_f32 v84, v88, v89
    ds_read_b64_tr_b16 v[208:209], v246 offset:2816
    s_add_u32 m0, s60, 1024
    s_add_u32 s59, s99, 1024
    buffer_load_dwordx4 v2, s[36:39], s59 offen sc1 lds
    v_exp_f32 v94, v94
    v_exp_f32 v95, v95
    v_cvt_pk_bf16_f32 v85, v90, v91
    ds_read_b64_tr_b16 v[210:211], v246 offset:2944
    s_add_u32 m0, s60, 2048
    s_add_u32 s59, s99, 2048
    buffer_load_dwordx4 v2, s[36:39], s59 offen sc1 lds
    v_cvt_pk_bf16_f32 v86, v92, v93
    s_add_u32 m0, s60, 3072
    s_add_u32 s59, s99, 3072
    buffer_load_dwordx4 v2, s[36:39], s59 offen sc1 lds
    v_cvt_pk_bf16_f32 v87, v94, v95
    v_pk_add_f32 v[96:97], v[96:97], v[248:249] op_sel_hi:[1,0] neg_lo:[0,1] neg_hi:[0,1]
    v_pk_add_f32 v[98:99], v[98:99], v[248:249] op_sel_hi:[1,0] neg_lo:[0,1] neg_hi:[0,1]
    v_pk_add_f32 v[100:101], v[100:101], v[248:249] op_sel_hi:[1,0] neg_lo:[0,1] neg_hi:[0,1]
    v_pk_add_f32 v[102:103], v[102:103], v[248:249] op_sel_hi:[1,0] neg_lo:[0,1] neg_hi:[0,1]
    v_pk_add_f32 v[104:105], v[104:105], v[248:249] op_sel_hi:[1,0] neg_lo:[0,1] neg_hi:[0,1]
    v_pk_add_f32 v[106:107], v[106:107], v[248:249] op_sel_hi:[1,0] neg_lo:[0,1] neg_hi:[0,1]
    v_pk_add_f32 v[108:109], v[108:109], v[248:249] op_sel_hi:[1,0] neg_lo:[0,1] neg_hi:[0,1]
    v_pk_add_f32 v[110:111], v[110:111], v[248:249] op_sel_hi:[1,0] neg_lo:[0,1] neg_hi:[0,1]
    s_waitcnt lgkmcnt(6)
    v_mfma_f32_32x32x16_bf16 v[228:243], v[212:215], v[80:83], v[228:243]
    v_exp_f32 v96, v96
    v_exp_f32 v97, v97
    v_exp_f32 v98, v98
    v_exp_f32_e64 v99, v99
    s_add_u32 m0, s60, 4096
    s_add_u32 s59, s99, 4096
    buffer_load_dwordx4 v2, s[36:39], s59 offen sc1 lds
    v_cvt_pk_bf16_f32 v96, v96, v97
    v_exp_f32 v100, v100
    v_exp_f32 v101, v101
    v_cvt_pk_bf16_f32 v97, v98, v99
    v_exp_f32 v102, v102
    v_exp_f32 v103, v103
    v_cvt_pk_bf16_f32 v98, v100, v101
    s_waitcnt lgkmcnt(4)
    v_mfma_f32_32x32x16_bf16 v[228:243], v[216:219], v[84:87], v[228:243]
    ds_read_b64_tr_b16 v[212:213], v246 offset:3072
    v_exp_f32 v104, v104
    v_exp_f32 v105, v105
    v_exp_f32 v106, v106
    v_exp_f32_e64 v107, v107
    ds_read_b64_tr_b16 v[214:215], v246 offset:3200
    v_cvt_pk_bf16_f32 v99, v102, v103
    s_add_u32 m0, s60, 5120
    s_add_u32 s59, s99, 5120
    buffer_load_dwordx4 v2, s[36:39], s59 offen sc1 lds
    v_exp_f32 v108, v108
    v_exp_f32 v109, v109
    v_cvt_pk_bf16_f32 v100, v104, v105
    ds_read_b64_tr_b16 v[216:217], v246 offset:3328
    s_add_u32 m0, s60, 6144
    s_add_u32 s59, s99, 6144
    s_waitcnt vmcnt(62)
    buffer_load_dwordx4 v2, s[36:39], s59 offen sc1 lds
    v_exp_f32 v110, v110
    v_exp_f32_e64 v111, v111
    v_cvt_pk_bf16_f32 v101, v106, v107
    ds_read_b64_tr_b16 v[218:219], v246 offset:3456
    s_add_u32 m0, s60, 7168
    s_add_u32 s59, s99, 7168
    s_waitcnt vmcnt(62)
    buffer_load_dwordx4 v2, s[36:39], s59 offen sc1 lds
    v_cvt_pk_bf16_f32 v102, v108, v109
    s_add_u32 m0, s60, 8192
    s_add_u32 s59, s99, 8192
    s_waitcnt vmcnt(62)
    buffer_load_dwordx4 v2, s[36:39], s59 offen sc1 lds
    v_cvt_pk_bf16_f32 v103, v110, v111
    v_pk_add_f32 v[112:113], v[112:113], v[248:249] op_sel_hi:[1,0] neg_lo:[0,1] neg_hi:[0,1]
    v_pk_add_f32 v[114:115], v[114:115], v[248:249] op_sel_hi:[1,0] neg_lo:[0,1] neg_hi:[0,1]
    v_pk_add_f32 v[116:117], v[116:117], v[248:249] op_sel_hi:[1,0] neg_lo:[0,1] neg_hi:[0,1]
    v_pk_add_f32 v[118:119], v[118:119], v[248:249] op_sel_hi:[1,0] neg_lo:[0,1] neg_hi:[0,1]
    v_pk_add_f32 v[120:121], v[120:121], v[248:249] op_sel_hi:[1,0] neg_lo:[0,1] neg_hi:[0,1]
    v_pk_add_f32 v[122:123], v[122:123], v[248:249] op_sel_hi:[1,0] neg_lo:[0,1] neg_hi:[0,1]
    v_pk_add_f32 v[124:125], v[124:125], v[248:249] op_sel_hi:[1,0] neg_lo:[0,1] neg_hi:[0,1]
    v_pk_add_f32 v[126:127], v[126:127], v[248:249] op_sel_hi:[1,0] neg_lo:[0,1] neg_hi:[0,1]
    s_waitcnt lgkmcnt(6)
    v_mfma_f32_32x32x16_bf16 v[228:243], v[204:207], v[96:99], v[228:243]
    v_exp_f32 v112, v112
    v_exp_f32 v113, v113
    v_exp_f32 v114, v114
    v_exp_f32_e64 v115, v115
    s_add_u32 m0, s60, 9216
    s_add_u32 s59, s99, 9216
    s_waitcnt vmcnt(62)
    buffer_load_dwordx4 v2, s[36:39], s59 offen sc1 lds
    v_cvt_pk_bf16_f32 v112, v112, v113
    v_exp_f32 v116, v116
    v_exp_f32_e64 v117, v117
    v_cvt_pk_bf16_f32 v113, v114, v115
    v_exp_f32 v118, v118
    v_exp_f32 v119, v119
    v_cvt_pk_bf16_f32 v114, v116, v117
    s_waitcnt lgkmcnt(4)
    v_mfma_f32_32x32x16_bf16 v[228:243], v[208:211], v[100:103], v[228:243]
    ds_read_b64_tr_b16 v[204:205], v246 offset:3584
    v_exp_f32 v120, v120
    v_exp_f32 v121, v121
    v_exp_f32 v122, v122
    v_exp_f32_e64 v123, v123
    ds_read_b64_tr_b16 v[206:207], v246 offset:3712
    v_cvt_pk_bf16_f32 v115, v118, v119
    s_mov_b32 s57, 262144
    s_waitcnt vmcnt(62)
    buffer_load_dwordx4 a[210:213], v4, s[36:39], s57 offen sc1
    v_exp_f32 v124, v124
    v_exp_f32_e64 v125, v125
    v_cvt_pk_bf16_f32 v116, v120, v121
    ds_read_b64_tr_b16 v[208:209], v246 offset:3840
    s_mov_b32 s57, 262144
    s_waitcnt vmcnt(62)
    buffer_load_dwordx4 a[226:229], v5, s[36:39], s57 offen sc1
    v_exp_f32 v126, v126
    v_exp_f32_e64 v127, v127
    v_cvt_pk_bf16_f32 v117, v122, v123
    ds_read_b64_tr_b16 v[210:211], v246 offset:3968
    s_mov_b32 s57, 277504
    s_waitcnt vmcnt(62)
    buffer_load_dwordx4 a[214:217], v4, s[36:39], s57 offen sc1
    v_cvt_pk_bf16_f32 v118, v124, v125
    s_mov_b32 s57, 277504
    s_waitcnt vmcnt(62)
    buffer_load_dwordx4 a[230:233], v5, s[36:39], s57 offen sc1
    v_cvt_pk_bf16_f32 v119, v126, v127
    v_pk_add_f32 v[128:129], v[128:129], v[248:249] op_sel_hi:[1,0] neg_lo:[0,1] neg_hi:[0,1]
    v_pk_add_f32 v[130:131], v[130:131], v[248:249] op_sel_hi:[1,0] neg_lo:[0,1] neg_hi:[0,1]
    v_pk_add_f32 v[132:133], v[132:133], v[248:249] op_sel_hi:[1,0] neg_lo:[0,1] neg_hi:[0,1]
    v_pk_add_f32 v[134:135], v[134:135], v[248:249] op_sel_hi:[1,0] neg_lo:[0,1] neg_hi:[0,1]
    v_pk_add_f32 v[136:137], v[136:137], v[248:249] op_sel_hi:[1,0] neg_lo:[0,1] neg_hi:[0,1]
    v_pk_add_f32 v[138:139], v[138:139], v[248:249] op_sel_hi:[1,0] neg_lo:[0,1] neg_hi:[0,1]
    v_pk_add_f32 v[140:141], v[140:141], v[248:249] op_sel_hi:[1,0] neg_lo:[0,1] neg_hi:[0,1]
    v_pk_add_f32 v[142:143], v[142:143], v[248:249] op_sel_hi:[1,0] neg_lo:[0,1] neg_hi:[0,1]
    s_waitcnt lgkmcnt(6)
    v_mfma_f32_32x32x16_bf16 v[228:243], v[212:215], v[112:115], v[228:243]
    v_exp_f32 v128, v128
    v_exp_f32 v129, v129
    v_exp_f32 v130, v130
    v_exp_f32_e64 v131, v131
    s_mov_b32 s57, 292864
    s_waitcnt vmcnt(62)
    buffer_load_dwordx4 a[218:221], v4, s[36:39], s57 offen sc1
    v_cvt_pk_bf16_f32 v128, v128, v129
    v_exp_f32 v132, v132
    v_exp_f32_e64 v133, v133
    v_cvt_pk_bf16_f32 v129, v130, v131
    v_exp_f32 v134, v134
    v_exp_f32 v135, v135
    v_cvt_pk_bf16_f32 v130, v132, v133
    s_waitcnt lgkmcnt(4)
    v_mfma_f32_32x32x16_bf16 v[228:243], v[216:219], v[116:119], v[228:243]
    ds_read_b64_tr_b16 v[212:213], v246 offset:4096
    v_exp_f32 v136, v136
    v_exp_f32 v137, v137
    v_exp_f32 v138, v138
    v_exp_f32_e64 v139, v139
    ds_read_b64_tr_b16 v[214:215], v246 offset:4224
    v_cvt_pk_bf16_f32 v131, v134, v135
    s_mov_b32 s57, 292864
    s_waitcnt vmcnt(62)
    buffer_load_dwordx4 a[234:237], v5, s[36:39], s57 offen sc1
    v_exp_f32 v140, v140
    v_exp_f32_e64 v141, v141
    v_cvt_pk_bf16_f32 v132, v136, v137
    ds_read_b64_tr_b16 v[216:217], v246 offset:4352
    s_mov_b32 s57, 308224
    s_waitcnt vmcnt(62)
    buffer_load_dwordx4 a[222:225], v4, s[36:39], s57 offen sc1
    v_exp_f32 v142, v142
    v_exp_f32_e64 v143, v143
    v_cvt_pk_bf16_f32 v133, v138, v139
    ds_read_b64_tr_b16 v[218:219], v246 offset:4480
    s_mov_b32 s57, 308224
    s_waitcnt vmcnt(62)
    s_nop 0
    buffer_load_dwordx4 a[238:241], v5, s[36:39], s57 offen sc1
    v_cvt_pk_bf16_f32 v134, v140, v141
    v_cvt_pk_bf16_f32 v135, v142, v143
    v_pk_add_f32 v[144:145], v[144:145], v[248:249] op_sel_hi:[1,0] neg_lo:[0,1] neg_hi:[0,1]
    v_pk_add_f32 v[146:147], v[146:147], v[248:249] op_sel_hi:[1,0] neg_lo:[0,1] neg_hi:[0,1]
    v_pk_add_f32 v[148:149], v[148:149], v[248:249] op_sel_hi:[1,0] neg_lo:[0,1] neg_hi:[0,1]
    v_pk_add_f32 v[150:151], v[150:151], v[248:249] op_sel_hi:[1,0] neg_lo:[0,1] neg_hi:[0,1]
    v_pk_add_f32 v[152:153], v[152:153], v[248:249] op_sel_hi:[1,0] neg_lo:[0,1] neg_hi:[0,1]
    v_pk_add_f32 v[154:155], v[154:155], v[248:249] op_sel_hi:[1,0] neg_lo:[0,1] neg_hi:[0,1]
    v_pk_add_f32 v[156:157], v[156:157], v[248:249] op_sel_hi:[1,0] neg_lo:[0,1] neg_hi:[0,1]
    v_pk_add_f32 v[158:159], v[158:159], v[248:249] op_sel_hi:[1,0] neg_lo:[0,1] neg_hi:[0,1]
    s_waitcnt lgkmcnt(6)
    v_mfma_f32_32x32x16_bf16 v[228:243], v[204:207], v[128:131], v[228:243]
    v_exp_f32 v144, v144
    v_exp_f32 v145, v145
    v_exp_f32 v146, v146
    v_exp_f32_e64 v147, v147
    v_cvt_pk_bf16_f32 v144, v144, v145
    v_exp_f32 v148, v148
    v_exp_f32 v149, v149
    v_cvt_pk_bf16_f32 v145, v146, v147
    v_exp_f32 v150, v150
    v_exp_f32 v151, v151
    v_cvt_pk_bf16_f32 v146, v148, v149
    s_waitcnt lgkmcnt(4)
    v_mfma_f32_32x32x16_bf16 v[228:243], v[208:211], v[132:135], v[228:243]
    ds_read_b64_tr_b16 v[204:205], v246 offset:0
    v_exp_f32 v152, v152
    v_exp_f32 v153, v153
    v_exp_f32 v154, v154
    v_exp_f32_e64 v155, v155
    ds_read_b64_tr_b16 v[206:207], v246 offset:128
    v_cvt_pk_bf16_f32 v147, v150, v151
    v_exp_f32 v156, v156
    v_exp_f32 v157, v157
    v_cvt_pk_bf16_f32 v148, v152, v153
    ds_read_b64_tr_b16 v[208:209], v246 offset:256
    v_exp_f32 v158, v158
    v_exp_f32 v159, v159
    v_cvt_pk_bf16_f32 v149, v154, v155
    ds_read_b64_tr_b16 v[210:211], v246 offset:384
    v_cvt_pk_bf16_f32 v150, v156, v157
    v_cvt_pk_bf16_f32 v151, v158, v159
    v_bfi_b32 v16, v220, 0, v144
    v_bfi_b32 v17, v221, 0, v145
    v_bfi_b32 v18, v222, 0, v146
    v_bfi_b32 v19, v223, 0, v147
    v_bfi_b32 v20, v224, 0, v148
    v_bfi_b32 v21, v225, 0, v149
    v_bfi_b32 v22, v226, 0, v150
    v_bfi_b32 v23, v227, 0, v151
    v_and_b32 v144, v220, v144
    v_and_b32 v145, v221, v145
    v_and_b32 v146, v222, v146
    v_and_b32 v147, v223, v147
    v_and_b32 v148, v224, v148
    v_and_b32 v149, v225, v149
    v_and_b32 v150, v226, v150
    v_and_b32 v151, v227, v151
    s_waitcnt lgkmcnt(6)
    v_mfma_f32_32x32x16_bf16 v[228:243], v[212:215], v[144:147], v[228:243]
    s_waitcnt lgkmcnt(4)
    v_mfma_f32_32x32x16_bf16 v[228:243], v[216:219], v[148:151], v[228:243]
    s_waitcnt lgkmcnt(2)
    v_mfma_f32_32x32x16_bf16 v[228:243], v[204:207], v[16:19], v[228:243]
    s_waitcnt lgkmcnt(0)
    v_mfma_f32_32x32x16_bf16 v[228:243], v[208:211], v[20:23], v[228:243]
    s_nop 11
    v_mov_b32 v249, v236
    v_mov_b32 v250, v236
    s_nop 1
    v_permlane32_swap_b32 v249, v250
    v_rcp_f32 v250, v250
    s_nop 0
    s_nop 0
    v_pk_mul_f32 v[228:229], v[228:229], v[250:251] op_sel_hi:[1,0]
    v_pk_mul_f32 v[230:231], v[230:231], v[250:251] op_sel_hi:[1,0]
    v_pk_mul_f32 v[232:233], v[232:233], v[250:251] op_sel_hi:[1,0]
    v_pk_mul_f32 v[234:235], v[234:235], v[250:251] op_sel_hi:[1,0]
    v_pk_mul_f32 v[236:237], v[236:237], v[250:251] op_sel_hi:[1,0]
    v_pk_mul_f32 v[238:239], v[238:239], v[250:251] op_sel_hi:[1,0]
    v_cvt_pk_bf16_f32 v8, v228, v229
    v_cvt_pk_bf16_f32 v9, v230, v231
    v_cvt_pk_bf16_f32 v10, v232, v233
    v_cvt_pk_bf16_f32 v11, v234, v235
    v_cvt_pk_bf16_f32 v14, v236, v237
    v_cvt_pk_bf16_f32 v15, v238, v239
    s_waitcnt vmcnt(62)
    buffer_store_dwordx4 v[8:11], v252, s[36:39], s96 offen offset:512 sc1
    s_waitcnt vmcnt(62)
    buffer_store_dwordx4 v[12:15], v253, s[36:39], s97 offen sc1
    s_waitcnt vmcnt(0)
    s_barrier
    s_lshl_b32 s58, s53, 4
    s_add_u32 s58, s58, s54
    s_cmp_lg_u32 s55, 0
    s_cbranch_scc1 PF_87
    s_lshl_b32 s57, s58, 7
    s_add_u32 s57, s57, 118784
    v_mov_b32 v3, s52
    v_mov_b32 v4, 0
    s_mov_b64 exec, 1
    buffer_store_dword v3, v4, s[36:39], s57 offen sc1
    s_nop 1
    s_mov_b64 exec, -1
PF_87:
    v_subrev_u32 v3, 160, v0
    v_cmp_gt_u32 vcc, 160, v0
    s_nop 1
    v_cndmask_b32 v3, v3, v0, vcc
    v_mov_b32 v4, 153216
    v_mov_b32 v5, 154496
    v_cndmask_b32_e64 v74, v4, v5, vcc
    v_mul_u32_u24 v6, 3277, v3
    v_lshrrev_b32 v6, 16, v6
    v_mul_u32_u24 v7, 20, v6
    v_sub_u32_e64 v7, v3, v7
    v_mul_u32_u24 v6, 80, v6
    v_lshrrev_b32 v8, 3, v7
    v_lshlrev_b32 v8, 5, v8
    v_bfe_u32 v9, v7, 1, 1
    v_lshl_add_u32 v8, v9, 4, v8
    v_and_b32_e64 v9, 1, v7
    v_lshl_add_u32 v8, v9, 3, v8
    v_bfe_u32 v9, v7, 2, 1
    v_lshl_add_u32 v8, v9, 2, v8
    v_bfe_u32 v9, v7, 1, 1
    v_lshlrev_b32 v72, 3, v9
    v_and_b32 v9, 1, v7
    v_lshl_add_u32 v72, v9, 2, v72
    v_add_u32 v72, 64, v72
    v_cmp_gt_u32 vcc, 16, v7
    s_nop 1
    v_cndmask_b32 v72, v72, v8, vcc
    v_add_u32 v72, v72, v6
    v_lshlrev_b32 v72, 1, v72
    v_add_u32_e64 v72, v72, v74
    v_add_u32 v3, 96, v0
    v_min_u32 v3, 159, v3
    v_mul_u32_u24 v6, 3277, v3
    v_lshrrev_b32 v6, 16, v6
    v_mul_u32_u24 v7, 20, v6
    v_sub_u32_e64 v7, v3, v7
    v_mul_u32_u24 v6, 80, v6
    v_lshrrev_b32 v8, 3, v7
    v_lshlrev_b32 v8, 5, v8
    v_bfe_u32 v9, v7, 1, 1
    v_lshl_add_u32 v8, v9, 4, v8
    v_and_b32_e64 v9, 1, v7
    v_lshl_add_u32 v8, v9, 3, v8
    v_bfe_u32 v9, v7, 2, 1
    v_lshl_add_u32 v8, v9, 2, v8
    v_bfe_u32 v9, v7, 1, 1
    v_lshlrev_b32 v73, 3, v9
    v_and_b32 v9, 1, v7
    v_lshl_add_u32 v73, v9, 2, v73
    v_add_u32 v73, 64, v73
    v_cmp_gt_u32 vcc, 16, v7
    s_nop 1
    v_cndmask_b32 v73, v73, v8, vcc
    v_add_u32 v73, v73, v6
    v_lshlrev_b32 v73, 1, v73
    v_add_u32 v73, 153216, v73
    v_accvgpr_read_b32 v16, a210
    v_accvgpr_read_b32 v17, a211
    v_accvgpr_read_b32 v18, a212
    v_accvgpr_read_b32 v19, a213
    v_accvgpr_read_b32 v20, a214
    v_accvgpr_read_b32 v21, a215
    v_accvgpr_read_b32 v22, a216
    v_accvgpr_read_b32 v23, a217
    v_accvgpr_read_b32 v24, a218
    v_accvgpr_read_b32 v25, a219
    v_accvgpr_read_b32 v26, a220
    v_accvgpr_read_b32 v27, a221
    v_accvgpr_read_b32 v28, a222
    v_accvgpr_read_b32 v29, a223
    v_accvgpr_read_b32 v30, a224
    v_accvgpr_read_b32 v31, a225
    v_accvgpr_read_b32 v32, a226
    v_accvgpr_read_b32 v33, a227
    v_accvgpr_read_b32 v34, a228
    v_accvgpr_read_b32 v35, a229
    v_accvgpr_read_b32 v36, a230
    v_accvgpr_read_b32 v37, a231
    v_accvgpr_read_b32 v38, a232
    v_accvgpr_read_b32 v39, a233
    v_accvgpr_read_b32 v40, a234
    v_accvgpr_read_b32 v41, a235
    v_accvgpr_read_b32 v42, a236
    v_accvgpr_read_b32 v43, a237
    v_accvgpr_read_b32 v44, a238
    v_accvgpr_read_b32 v45, a239
    v_accvgpr_read_b32 v46, a240
    v_accvgpr_read_b32 v47, a241
    v_accvgpr_read_b32 v70, a242
    v_cmp_le_u32 vcc, 160, v0
    s_nop 1
    v_cndmask_b32 v5, 0, 1.0, vcc
    v_cmp_gt_u32 vcc, 64, v0
    s_nop 1
    s_nop 0
    v_cndmask_b32 v6, 0, 1.0, vcc
    v_pk_add_f32 v[16:17], v[16:17], v[20:21]
    v_pk_add_f32 v[24:25], v[24:25], v[28:29]
    v_pk_add_f32 v[18:19], v[18:19], v[22:23]
    v_pk_add_f32 v[26:27], v[26:27], v[30:31]
    v_pk_add_f32 v[16:17], v[16:17], v[24:25]
    v_pk_add_f32 v[18:19], v[18:19], v[26:27]
    v_cvt_pk_bf16_f32 v20, v16, v17
    v_cvt_pk_bf16_f32 v21, v18, v19
    v_lshlrev_b32_e64 v16, 16, v20
    v_and_b32 v17, 0xffff0000, v20
    v_lshlrev_b32_e64 v18, 16, v21
    v_and_b32 v19, 0xffff0000, v21
    v_add_f32 v16, v5, v16
    v_add_f32 v17, v5, v17
    v_add_f32 v18, v5, v18
    v_add_f32 v19, v5, v19
    v_cvt_pk_bf16_f32 v20, v16, v17
    v_cvt_pk_bf16_f32 v21, v18, v19
    v_lshlrev_b32_e64 v16, 16, v20
    v_and_b32 v17, 0xffff0000, v20
    v_lshlrev_b32_e64 v18, 16, v21
    v_and_b32 v19, 0xffff0000, v21
    v_pk_add_f32 v[32:33], v[32:33], v[36:37]
    v_pk_add_f32 v[40:41], v[40:41], v[44:45]
    v_pk_add_f32 v[34:35], v[34:35], v[38:39]
    v_pk_add_f32 v[42:43], v[42:43], v[46:47]
    v_pk_add_f32 v[32:33], v[32:33], v[40:41]
    v_pk_add_f32 v[34:35], v[34:35], v[42:43]
    v_cvt_pk_bf16_f32 v36, v32, v33
    v_cvt_pk_bf16_f32 v37, v34, v35
    v_lshlrev_b32_e64 v32, 16, v36
    v_and_b32 v33, 0xffff0000, v36
    v_lshlrev_b32_e64 v34, 16, v37
    v_and_b32 v35, 0xffff0000, v37
    v_add_f32 v32, v6, v32
    v_add_f32 v33, v6, v33
    v_add_f32 v34, v6, v34
    v_add_f32 v35, v6, v35
    v_cvt_pk_bf16_f32 v36, v32, v33
    v_cvt_pk_bf16_f32 v37, v34, v35
    v_lshlrev_b32_e64 v32, 16, v36
    v_and_b32 v33, 0xffff0000, v36
    v_lshlrev_b32_e64 v34, 16, v37
    v_and_b32 v35, 0xffff0000, v37
    v_lshlrev_b32_e64 v3, 4, v0
    v_add_u32 v3, 147456, v3
    v_add_u32 v4, 4096, v3
    ds_write_b128 v3, v[16:19]
    ds_write_b64 v72, v[20:21]
    v_mov_b32 v8, 0x3f803f80
    v_mov_b32 v9, 0x3f803f80
    v_min_u32 v10, 159, v0
    v_lshlrev_b32_e64 v10, 3, v10
    v_add_u32 v10, 155776, v10
    ds_write_b64 v10, v[8:9]
    v_lshlrev_b32_e64 v70, 16, v70
    v_min_u32 v10, 95, v0
    v_lshlrev_b32_e64 v10, 2, v10
    v_add_u32 v10, 158208, v10
    ds_write_b32 v10, v70
    v_cmp_gt_u32 vcc, 104, v0
    s_nop 0
    s_and_saveexec_b64 s[58:59], vcc
    s_cbranch_execz M2S_88
    ds_write_b128 v4, v[32:35]
    v_cmp_gt_u32 vcc, 64, v0
    s_nop 1
    s_and_b64 exec, exec, vcc
    s_cbranch_execz M2S_88
    ds_write_b64 v73, v[36:37]
M2S_88:
    s_mov_b64 exec, s[58:59]
    s_waitcnt lgkmcnt(0)
    s_barrier
    s_and_b32 s60, s54, 1
    s_lshr_b32 s61, s54, 1
    s_lshl_b32 s62, s53, 3
    s_lshl_b32 s63, s60, 2
    s_add_u32 s62, s62, s63
    s_and_b32 s57, s55, 1
    s_mul_i32 s58, s57, 10
    s_add_u32 s59, s62, s55
    s_xor_b32 s63, s55, 1
    s_add_u32 s63, s63, s62
    s_mul_i32 s59, s59, 20
    s_add_u32 s59, s59, s58
    s_lshl_b32 s59, s59, 10
    s_add_u32 s96, s59, 12582912
    s_mul_i32 s63, s63, 20
    s_add_u32 s63, s63, s58
    s_lshl_b32 s63, s63, 10
    s_add_u32 s97, s63, 12582912
    v_lshrrev_b32 v4, 4, v1
    v_lshlrev_b32 v6, 4, v4
    v_add_u32 v7, 147456, v6
    s_mul_i32 s57, s61, 320
    v_add_u32 v6, s57, v7
    s_xor_b32 s57, s55, 1
    s_mul_i32 s57, s57, 5120
    s_add_u32 s57, s57, 122880
    v_add_u32_e64 v12, s57, v2
    s_mul_i32 s57, s55, 5120
    s_add_u32 s57, s57, 122880
    v_add_u32_e64 v13, s57, v2
    ds_read_b128 v[16:19], v7 offset:5120
    ds_read_b128 v[20:23], v7 offset:5184
    ds_read_b128 v[24:27], v7 offset:5248
    ds_read_b128 v[28:31], v7 offset:5312
    ds_read_b128 v[32:35], v7 offset:5376
    ds_read_b128 v[36:39], v6 offset:2560
    ds_read_b128 v[40:43], v6 offset:2624
    ds_read_b128 v[44:47], v6 offset:2688
    ds_read_b128 v[48:51], v6 offset:2752
    ds_read_b128 v[52:55], v6 offset:2816
    ds_read_b128 v[56:59], v6 offset:0
    ds_read_b128 v[60:63], v6 offset:64
    ds_read_b128 v[64:67], v6 offset:128
    ds_read_b128 v[68:71], v6 offset:192
    ds_read_b128 v[72:75], v6 offset:256
    v_accvgpr_read_b32 v224, a200
    v_lshlrev_b32_e64 v204, 16, v224
    v_and_b32 v205, 0xffff0000, v224
    v_accvgpr_read_b32 v225, a201
    v_lshlrev_b32_e64 v206, 16, v225
    v_and_b32 v207, 0xffff0000, v225
    v_accvgpr_read_b32 v224, a202
    v_lshlrev_b32_e64 v208, 16, v224
    v_and_b32 v209, 0xffff0000, v224
    v_accvgpr_read_b32 v225, a203
    v_lshlrev_b32_e64 v210, 16, v225
    v_and_b32 v211, 0xffff0000, v225
    v_accvgpr_read_b32 v224, a204
    v_lshlrev_b32_e64 v212, 16, v224
    v_and_b32 v213, 0xffff0000, v224
    v_accvgpr_read_b32 v225, a205
    v_lshlrev_b32_e64 v214, 16, v225
    v_and_b32 v215, 0xffff0000, v225
    v_accvgpr_read_b32 v224, a206
    v_lshlrev_b32_e64 v216, 16, v224
    v_and_b32 v217, 0xffff0000, v224
    v_accvgpr_read_b32 v225, a207
    v_lshlrev_b32_e64 v218, 16, v225
    v_and_b32 v219, 0xffff0000, v225
    v_accvgpr_read_b32 v224, a208
    v_lshlrev_b32_e64 v220, 16, v224
    v_and_b32 v221, 0xffff0000, v224
    v_accvgpr_read_b32 v225, a209
    v_lshlrev_b32_e64 v222, 16, v225
    v_and_b32 v223, 0xffff0000, v225
    v_and_b32 v8, 15, v1
    s_lshl_b32 s57, s53, 4
    v_add_u32 v8, s57, v8
    v_lshlrev_b32 v8, 7, v8
    v_add_u32 v8, 118784, v8
    s_cmp_lg_u32 s55, 0
    s_cbranch_scc1 POLLS_90
    s_mov_b32 s57, 0
POLL_91:
    buffer_load_dword v9, v8, s[36:39], 0 offen sc1
    s_waitcnt vmcnt(0)
    v_cmp_ne_u32 vcc, s52, v9
    s_add_u32 s57, s57, 1
    s_cmp_gt_u32 s57, 400000
    s_cbranch_scc1 POLLD_92
    s_cbranch_vccnz POLL_91
POLLD_92:
POLLS_90:
    s_barrier
    s_nop 0
    buffer_load_dwordx4 v[120:123], v2, s[36:39], s97 offen offset:0 sc1
    buffer_load_dwordx4 v[124:127], v2, s[36:39], s97 offen offset:1024 sc1
    buffer_load_dwordx4 v[128:131], v2, s[36:39], s97 offen offset:2048 sc1
    buffer_load_dwordx4 v[132:135], v2, s[36:39], s97 offen offset:3072 sc1
    s_add_u32 s97, s97, 4096
    buffer_load_dwordx4 v[136:139], v2, s[36:39], s97 offen offset:0 sc1
    buffer_load_dwordx4 v[140:143], v2, s[36:39], s97 offen offset:1024 sc1
    buffer_load_dwordx4 v[144:147], v2, s[36:39], s97 offen offset:2048 sc1
    buffer_load_dwordx4 v[148:151], v2, s[36:39], s97 offen offset:3072 sc1
    s_add_u32 s97, s97, 4096
    buffer_load_dwordx4 v[152:155], v2, s[36:39], s97 offen offset:0 sc1
    buffer_load_dwordx4 v[156:159], v2, s[36:39], s97 offen offset:1024 sc1
    s_mul_i32 s98, s54, 122880
    s_mul_i32 s99, s55, 20480
    s_add_u32 s98, s98, s99
    s_add_u32 s98, s98, 26214400
    v_lshlrev_b32 v14, 7, v1
    s_waitcnt vmcnt(9)
    s_nop 0
    v_mfma_f32_16x16x32_bf16 v[180:183], a[0:3], v[120:123], 0
    v_mfma_f32_16x16x32_bf16 v[184:187], a[4:7], v[120:123], 0
    v_mfma_f32_16x16x32_bf16 v[188:191], a[8:11], v[120:123], 0
    v_mfma_f32_16x16x32_bf16 v[192:195], a[12:15], v[120:123], 0
    v_mfma_f32_16x16x32_bf16 v[196:199], a[16:19], v[120:123], 0
    buffer_load_dwordx4 v[80:83], v2, s[36:39], s96 offen offset:0 sc1
    s_add_u32 m0, s99, 0
    s_add_u32 s59, s98, 0
    buffer_load_dwordx4 v2, s[36:39], s59 offen sc1 lds
    s_waitcnt vmcnt(10)
    s_nop 0
    v_mfma_f32_16x16x32_bf16 v[180:183], a[20:23], v[124:127], v[180:183]
    v_mfma_f32_16x16x32_bf16 v[184:187], a[24:27], v[124:127], v[184:187]
    v_mfma_f32_16x16x32_bf16 v[188:191], a[28:31], v[124:127], v[188:191]
    v_mfma_f32_16x16x32_bf16 v[192:195], a[32:35], v[124:127], v[192:195]
    v_mfma_f32_16x16x32_bf16 v[196:199], a[36:39], v[124:127], v[196:199]
    buffer_load_dwordx4 v[84:87], v2, s[36:39], s96 offen offset:1024 sc1
    s_add_u32 m0, s99, 1024
    s_add_u32 s59, s98, 1024
    buffer_load_dwordx4 v2, s[36:39], s59 offen sc1 lds
    s_waitcnt vmcnt(11)
    s_nop 0
    v_mfma_f32_16x16x32_bf16 v[180:183], a[40:43], v[128:131], v[180:183]
    v_mfma_f32_16x16x32_bf16 v[184:187], a[44:47], v[128:131], v[184:187]
    v_mfma_f32_16x16x32_bf16 v[188:191], a[48:51], v[128:131], v[188:191]
    v_mfma_f32_16x16x32_bf16 v[192:195], a[52:55], v[128:131], v[192:195]
    v_mfma_f32_16x16x32_bf16 v[196:199], a[56:59], v[128:131], v[196:199]
    buffer_load_dwordx4 v[88:91], v2, s[36:39], s96 offen offset:2048 sc1
    s_add_u32 m0, s99, 2048
    s_add_u32 s59, s98, 2048
    buffer_load_dwordx4 v2, s[36:39], s59 offen sc1 lds
    s_waitcnt vmcnt(12)
    s_nop 0
    v_mfma_f32_16x16x32_bf16 v[180:183], a[60:63], v[132:135], v[180:183]
    v_mfma_f32_16x16x32_bf16 v[184:187], a[64:67], v[132:135], v[184:187]
    v_mfma_f32_16x16x32_bf16 v[188:191], a[68:71], v[132:135], v[188:191]
    v_mfma_f32_16x16x32_bf16 v[192:195], a[72:75], v[132:135], v[192:195]
    v_mfma_f32_16x16x32_bf16 v[196:199], a[76:79], v[132:135], v[196:199]
    buffer_load_dwordx4 v[92:95], v2, s[36:39], s96 offen offset:3072 sc1
    s_add_u32 m0, s99, 3072
    s_add_u32 s59, s98, 3072
    buffer_load_dwordx4 v2, s[36:39], s59 offen sc1 lds
    s_waitcnt vmcnt(13)
    s_nop 0
    v_mfma_f32_16x16x32_bf16 v[180:183], a[80:83], v[136:139], v[180:183]
    v_mfma_f32_16x16x32_bf16 v[184:187], a[84:87], v[136:139], v[184:187]
    v_mfma_f32_16x16x32_bf16 v[188:191], a[88:91], v[136:139], v[188:191]
    v_mfma_f32_16x16x32_bf16 v[192:195], a[92:95], v[136:139], v[192:195]
    v_mfma_f32_16x16x32_bf16 v[196:199], a[96:99], v[136:139], v[196:199]
    s_add_u32 s96, s96, 4096
    buffer_load_dwordx4 v[96:99], v2, s[36:39], s96 offen offset:0 sc1
    s_add_u32 m0, s99, 4096
    s_add_u32 s59, s98, 4096
    buffer_load_dwordx4 v2, s[36:39], s59 offen sc1 lds
    s_waitcnt vmcnt(14)
    s_nop 0
    v_mfma_f32_16x16x32_bf16 v[180:183], a[100:103], v[140:143], v[180:183]
    v_mfma_f32_16x16x32_bf16 v[184:187], a[104:107], v[140:143], v[184:187]
    v_mfma_f32_16x16x32_bf16 v[188:191], a[108:111], v[140:143], v[188:191]
    v_mfma_f32_16x16x32_bf16 v[192:195], a[112:115], v[140:143], v[192:195]
    v_mfma_f32_16x16x32_bf16 v[196:199], a[116:119], v[140:143], v[196:199]
    buffer_load_dwordx4 v[100:103], v2, s[36:39], s96 offen offset:1024 sc1
    s_add_u32 m0, s99, 5120
    s_add_u32 s59, s98, 5120
    buffer_load_dwordx4 v2, s[36:39], s59 offen sc1 lds
    s_waitcnt vmcnt(15)
    s_nop 0
    v_mfma_f32_16x16x32_bf16 v[180:183], a[120:123], v[144:147], v[180:183]
    v_mfma_f32_16x16x32_bf16 v[184:187], a[124:127], v[144:147], v[184:187]
    v_mfma_f32_16x16x32_bf16 v[188:191], a[128:131], v[144:147], v[188:191]
    v_mfma_f32_16x16x32_bf16 v[192:195], a[132:135], v[144:147], v[192:195]
    v_mfma_f32_16x16x32_bf16 v[196:199], a[136:139], v[144:147], v[196:199]
    buffer_load_dwordx4 v[104:107], v2, s[36:39], s96 offen offset:2048 sc1
    s_add_u32 m0, s99, 6144
    s_add_u32 s59, s98, 6144
    buffer_load_dwordx4 v2, s[36:39], s59 offen sc1 lds
    s_waitcnt vmcnt(16)
    s_nop 0
    v_mfma_f32_16x16x32_bf16 v[180:183], a[140:143], v[148:151], v[180:183]
    v_mfma_f32_16x16x32_bf16 v[184:187], a[144:147], v[148:151], v[184:187]
    v_mfma_f32_16x16x32_bf16 v[188:191], a[148:151], v[148:151], v[188:191]
    v_mfma_f32_16x16x32_bf16 v[192:195], a[152:155], v[148:151], v[192:195]
    v_mfma_f32_16x16x32_bf16 v[196:199], a[156:159], v[148:151], v[196:199]
    buffer_load_dwordx4 v[108:111], v2, s[36:39], s96 offen offset:3072 sc1
    s_add_u32 m0, s99, 7168
    s_add_u32 s59, s98, 7168
    buffer_load_dwordx4 v2, s[36:39], s59 offen sc1 lds
    s_waitcnt vmcnt(17)
    s_nop 0
    v_mfma_f32_16x16x32_bf16 v[180:183], a[160:163], v[152:155], v[180:183]
    v_mfma_f32_16x16x32_bf16 v[184:187], a[164:167], v[152:155], v[184:187]
    v_mfma_f32_16x16x32_bf16 v[188:191], a[168:171], v[152:155], v[188:191]
    v_mfma_f32_16x16x32_bf16 v[192:195], a[172:175], v[152:155], v[192:195]
    v_mfma_f32_16x16x32_bf16 v[196:199], a[176:179], v[152:155], v[196:199]
    s_add_u32 s96, s96, 4096
    buffer_load_dwordx4 v[112:115], v2, s[36:39], s96 offen offset:0 sc1
    s_add_u32 m0, s99, 8192
    s_add_u32 s59, s98, 8192
    buffer_load_dwordx4 v2, s[36:39], s59 offen sc1 lds
    s_waitcnt vmcnt(18)
    s_nop 0
    v_mfma_f32_16x16x32_bf16 v[180:183], a[180:183], v[156:159], v[180:183]
    v_mfma_f32_16x16x32_bf16 v[184:187], a[184:187], v[156:159], v[184:187]
    v_mfma_f32_16x16x32_bf16 v[188:191], a[188:191], v[156:159], v[188:191]
    v_mfma_f32_16x16x32_bf16 v[192:195], a[192:195], v[156:159], v[192:195]
    v_mfma_f32_16x16x32_bf16 v[196:199], a[196:199], v[156:159], v[196:199]
    buffer_load_dwordx4 v[116:119], v2, s[36:39], s96 offen offset:1024 sc1
    s_add_u32 m0, s99, 9216
    s_add_u32 s59, s98, 9216
    buffer_load_dwordx4 v2, s[36:39], s59 offen sc1 lds
    s_waitcnt vmcnt(19)
    s_nop 0
    v_mfma_f32_16x16x32_bf16 v[160:163], a[0:3], v[80:83], 0
    v_mfma_f32_16x16x32_bf16 v[164:167], a[4:7], v[80:83], 0
    v_mfma_f32_16x16x32_bf16 v[168:171], a[8:11], v[80:83], 0
    v_mfma_f32_16x16x32_bf16 v[172:175], a[12:15], v[80:83], 0
    v_mfma_f32_16x16x32_bf16 v[176:179], a[16:19], v[80:83], 0
    s_add_u32 m0, s99, 10240
    s_add_u32 s59, s98, 10240
    buffer_load_dwordx4 v2, s[36:39], s59 offen sc1 lds
    s_waitcnt vmcnt(18)
    s_nop 0
    v_mfma_f32_16x16x32_bf16 v[160:163], a[20:23], v[84:87], v[160:163]
    v_mfma_f32_16x16x32_bf16 v[164:167], a[24:27], v[84:87], v[164:167]
    v_mfma_f32_16x16x32_bf16 v[168:171], a[28:31], v[84:87], v[168:171]
    v_mfma_f32_16x16x32_bf16 v[172:175], a[32:35], v[84:87], v[172:175]
    v_mfma_f32_16x16x32_bf16 v[176:179], a[36:39], v[84:87], v[176:179]
    s_add_u32 m0, s99, 11264
    s_add_u32 s59, s98, 11264
    buffer_load_dwordx4 v2, s[36:39], s59 offen sc1 lds
    s_waitcnt lgkmcnt(14)
    ds_write_b128 v12, v[180:183] offset:0
    s_waitcnt lgkmcnt(14)
    ds_write_b128 v12, v[184:187] offset:1024
    s_waitcnt lgkmcnt(14)
    ds_write_b128 v12, v[188:191] offset:2048
    s_waitcnt lgkmcnt(14)
    ds_write_b128 v12, v[192:195] offset:3072
    s_waitcnt lgkmcnt(14)
    ds_write_b128 v12, v[196:199] offset:4096
    s_waitcnt vmcnt(17)
    v_mfma_f32_16x16x32_bf16 v[160:163], a[40:43], v[88:91], v[160:163]
    v_mfma_f32_16x16x32_bf16 v[164:167], a[44:47], v[88:91], v[164:167]
    v_mfma_f32_16x16x32_bf16 v[168:171], a[48:51], v[88:91], v[168:171]
    v_mfma_f32_16x16x32_bf16 v[172:175], a[52:55], v[88:91], v[172:175]
    v_mfma_f32_16x16x32_bf16 v[176:179], a[56:59], v[88:91], v[176:179]
    s_add_u32 m0, s99, 12288
    s_add_u32 s59, s98, 12288
    buffer_load_dwordx4 v2, s[36:39], s59 offen sc1 lds
    s_waitcnt vmcnt(16)
    s_nop 0
    v_mfma_f32_16x16x32_bf16 v[160:163], a[60:63], v[92:95], v[160:163]
    v_mfma_f32_16x16x32_bf16 v[164:167], a[64:67], v[92:95], v[164:167]
    v_mfma_f32_16x16x32_bf16 v[168:171], a[68:71], v[92:95], v[168:171]
    v_mfma_f32_16x16x32_bf16 v[172:175], a[72:75], v[92:95], v[172:175]
    v_mfma_f32_16x16x32_bf16 v[176:179], a[76:79], v[92:95], v[176:179]
    s_add_u32 m0, s99, 13312
    s_add_u32 s59, s98, 13312
    buffer_load_dwordx4 v2, s[36:39], s59 offen sc1 lds
    s_waitcnt vmcnt(15)
    s_nop 0
    v_mfma_f32_16x16x32_bf16 v[160:163], a[80:83], v[96:99], v[160:163]
    v_mfma_f32_16x16x32_bf16 v[164:167], a[84:87], v[96:99], v[164:167]
    v_mfma_f32_16x16x32_bf16 v[168:171], a[88:91], v[96:99], v[168:171]
    v_mfma_f32_16x16x32_bf16 v[172:175], a[92:95], v[96:99], v[172:175]
    v_mfma_f32_16x16x32_bf16 v[176:179], a[96:99], v[96:99], v[176:179]
    s_add_u32 m0, s99, 14336
    s_add_u32 s59, s98, 14336
    buffer_load_dwordx4 v2, s[36:39], s59 offen sc1 lds
    s_waitcnt vmcnt(14)
    s_nop 0
    v_mfma_f32_16x16x32_bf16 v[160:163], a[100:103], v[100:103], v[160:163]
    v_mfma_f32_16x16x32_bf16 v[164:167], a[104:107], v[100:103], v[164:167]
    v_mfma_f32_16x16x32_bf16 v[168:171], a[108:111], v[100:103], v[168:171]
    v_mfma_f32_16x16x32_bf16 v[172:175], a[112:115], v[100:103], v[172:175]
    v_mfma_f32_16x16x32_bf16 v[176:179], a[116:119], v[100:103], v[176:179]
    s_add_u32 m0, s99, 15360
    s_add_u32 s59, s98, 15360
    buffer_load_dwordx4 v2, s[36:39], s59 offen sc1 lds
    s_waitcnt vmcnt(13)
    s_nop 0
    v_mfma_f32_16x16x32_bf16 v[160:163], a[120:123], v[104:107], v[160:163]
    v_mfma_f32_16x16x32_bf16 v[164:167], a[124:127], v[104:107], v[164:167]
    v_mfma_f32_16x16x32_bf16 v[168:171], a[128:131], v[104:107], v[168:171]
    v_mfma_f32_16x16x32_bf16 v[172:175], a[132:135], v[104:107], v[172:175]
    v_mfma_f32_16x16x32_bf16 v[176:179], a[136:139], v[104:107], v[176:179]
    s_add_u32 m0, s99, 16384
    s_add_u32 s59, s98, 16384
    buffer_load_dwordx4 v2, s[36:39], s59 offen sc1 lds
    s_waitcnt vmcnt(12)
    s_nop 0
    v_mfma_f32_16x16x32_bf16 v[160:163], a[140:143], v[108:111], v[160:163]
    v_mfma_f32_16x16x32_bf16 v[164:167], a[144:147], v[108:111], v[164:167]
    v_mfma_f32_16x16x32_bf16 v[168:171], a[148:151], v[108:111], v[168:171]
    v_mfma_f32_16x16x32_bf16 v[172:175], a[152:155], v[108:111], v[172:175]
    v_mfma_f32_16x16x32_bf16 v[176:179], a[156:159], v[108:111], v[176:179]
    s_add_u32 m0, s99, 17408
    s_add_u32 s59, s98, 17408
    buffer_load_dwordx4 v2, s[36:39], s59 offen sc1 lds
    s_waitcnt vmcnt(11)
    s_nop 0
    v_mfma_f32_16x16x32_bf16 v[160:163], a[160:163], v[112:115], v[160:163]
    v_mfma_f32_16x16x32_bf16 v[164:167], a[164:167], v[112:115], v[164:167]
    v_mfma_f32_16x16x32_bf16 v[168:171], a[168:171], v[112:115], v[168:171]
    v_mfma_f32_16x16x32_bf16 v[172:175], a[172:175], v[112:115], v[172:175]
    v_mfma_f32_16x16x32_bf16 v[176:179], a[176:179], v[112:115], v[176:179]
    s_add_u32 m0, s99, 18432
    s_add_u32 s59, s98, 18432
    buffer_load_dwordx4 v2, s[36:39], s59 offen sc1 lds
    s_waitcnt vmcnt(10)
    s_nop 0
    v_mfma_f32_16x16x32_bf16 v[160:163], a[180:183], v[116:119], v[160:163]
    v_mfma_f32_16x16x32_bf16 v[164:167], a[184:187], v[116:119], v[164:167]
    v_mfma_f32_16x16x32_bf16 v[168:171], a[188:191], v[116:119], v[168:171]
    v_mfma_f32_16x16x32_bf16 v[172:175], a[192:195], v[116:119], v[172:175]
    v_mfma_f32_16x16x32_bf16 v[176:179], a[196:199], v[116:119], v[176:179]
    s_add_u32 m0, s99, 19456
    s_add_u32 s59, s98, 19456
    buffer_load_dwordx4 v2, s[36:39], s59 offen sc1 lds
    s_waitcnt lgkmcnt(0)
    s_barrier
    ds_read_b128 v[180:183], v13 offset:0
    ds_read_b128 v[184:187], v13 offset:1024
    ds_read_b128 v[188:191], v13 offset:2048
    ds_read_b128 v[192:195], v13 offset:3072
    ds_read_b128 v[196:199], v13 offset:4096
    s_waitcnt lgkmcnt(4)
    v_pk_add_f32 v[160:161], v[160:161], v[180:181]
    v_pk_add_f32 v[162:163], v[162:163], v[182:183]
    s_waitcnt lgkmcnt(3)
    v_pk_add_f32 v[164:165], v[164:165], v[184:185]
    v_pk_add_f32 v[166:167], v[166:167], v[186:187]
    s_waitcnt lgkmcnt(2)
    v_pk_add_f32 v[168:169], v[168:169], v[188:189]
    v_pk_add_f32 v[170:171], v[170:171], v[190:191]
    s_waitcnt lgkmcnt(1)
    v_pk_add_f32 v[172:173], v[172:173], v[192:193]
    v_pk_add_f32 v[174:175], v[174:175], v[194:195]
    s_waitcnt lgkmcnt(0)
    s_nop 0
    v_pk_add_f32 v[176:177], v[176:177], v[196:197]
    v_pk_add_f32 v[178:179], v[178:179], v[198:199]
    v_pk_fma_f32 v[204:205], v[16:17], v[160:161], v[204:205]
    v_pk_fma_f32 v[206:207], v[18:19], v[162:163], v[206:207]
    v_pk_fma_f32 v[208:209], v[20:21], v[164:165], v[208:209]
    v_pk_fma_f32 v[210:211], v[22:23], v[166:167], v[210:211]
    v_pk_fma_f32 v[212:213], v[24:25], v[168:169], v[212:213]
    v_pk_fma_f32 v[214:215], v[26:27], v[170:171], v[214:215]
    v_pk_fma_f32 v[216:217], v[28:29], v[172:173], v[216:217]
    v_pk_fma_f32 v[218:219], v[30:31], v[174:175], v[218:219]
    v_pk_fma_f32 v[220:221], v[32:33], v[176:177], v[220:221]
    v_pk_fma_f32 v[222:223], v[34:35], v[178:179], v[222:223]
    v_pk_mul_f32 v[80:81], v[204:205], v[36:37]
    v_pk_mul_f32 v[82:83], v[206:207], v[38:39]
    v_pk_mul_f32 v[84:85], v[208:209], v[40:41]
    v_pk_mul_f32 v[86:87], v[210:211], v[42:43]
    v_pk_mul_f32 v[88:89], v[212:213], v[44:45]
    v_pk_mul_f32 v[90:91], v[214:215], v[46:47]
    v_pk_mul_f32 v[92:93], v[216:217], v[48:49]
    v_pk_mul_f32 v[94:95], v[218:219], v[50:51]
    v_pk_mul_f32 v[96:97], v[220:221], v[52:53]
    v_pk_mul_f32 v[98:99], v[222:223], v[54:55]
    v_cvt_pk_bf16_f32 v100, v80, v81
    v_cvt_pk_bf16_f32 v101, v82, v83
    v_cvt_pk_bf16_f32 v102, v84, v85
    v_cvt_pk_bf16_f32 v103, v86, v87
    v_cvt_pk_bf16_f32 v104, v88, v89
    v_cvt_pk_bf16_f32 v105, v90, v91
    v_cvt_pk_bf16_f32 v106, v92, v93
    v_cvt_pk_bf16_f32 v107, v94, v95
    v_cvt_pk_bf16_f32 v108, v96, v97
    v_cvt_pk_bf16_f32 v109, v98, v99
    s_lshr_b32 s57, s62, 1
    s_lshr_b32 s58, s55, 1
    s_add_u32 s57, s57, s58
    s_mul_i32 s96, s57, 40
    s_mul_i32 s58, s61, 5
    s_add_u32 s96, s96, s58
    s_lshl_b32 s96, s96, 10
    s_and_b32 s58, s55, 1
    s_lshl_b32 s58, s58, 8
    s_add_u32 s96, s96, s58
    s_add_u32 s96, s96, 15728640
    s_lshl_b32 s97, s57, 3
    s_add_u32 s97, s97, s61
    s_lshl_b32 s97, s97, 10
    s_lshl_b32 s58, s58, 1
    s_add_u32 s97, s97, s58
    s_add_u32 s97, s97, 393216
    v_and_b32 v3, 15, v1
    v_lshrrev_b32 v5, 1, v4
    v_and_b32 v7, 1, v4
    v_lshlrev_b32_e64 v8, 10, v5
    v_lshl_add_u32 v8, v7, 9, v8
    v_lshl_add_u32 v8, v3, 4, v8
    v_lshlrev_b32_e64 v9, 9, v5
    v_lshl_add_u32 v9, v3, 4, v9
    v_lshl_add_u32 v9, v7, 3, v9
    buffer_store_dwordx4 v[100:103], v8, s[36:39], s96 offen sc1
    buffer_store_dwordx4 v[104:107], v8, s[36:39], s96 offen offset:2048 sc1
    s_add_u32 s96, s96, 4096
    buffer_store_dwordx2 v[108:109], v9, s[36:39], s96 offen sc1
    v_pk_add_f32 v[112:113], v[204:205], v[206:207]
    v_pk_mul_f32 v[114:115], v[204:205], v[204:205]
    v_pk_add_f32 v[116:117], v[80:81], v[82:83]
    v_pk_mul_f32 v[118:119], v[80:81], v[80:81]
    v_pk_mul_f32 v[120:121], v[80:81], v[36:37]
    v_pk_mul_f32 v[122:123], v[80:81], v[56:57]
    v_pk_fma_f32 v[114:115], v[206:207], v[206:207], v[114:115]
    v_pk_fma_f32 v[118:119], v[82:83], v[82:83], v[118:119]
    v_pk_fma_f32 v[120:121], v[82:83], v[38:39], v[120:121]
    v_pk_fma_f32 v[122:123], v[82:83], v[58:59], v[122:123]
    v_pk_add_f32 v[112:113], v[112:113], v[208:209]
    v_pk_fma_f32 v[114:115], v[208:209], v[208:209], v[114:115]
    v_pk_add_f32 v[116:117], v[116:117], v[84:85]
    v_pk_fma_f32 v[118:119], v[84:85], v[84:85], v[118:119]
    v_pk_fma_f32 v[120:121], v[84:85], v[40:41], v[120:121]
    v_pk_fma_f32 v[122:123], v[84:85], v[60:61], v[122:123]
    v_pk_add_f32 v[112:113], v[112:113], v[210:211]
    v_pk_fma_f32 v[114:115], v[210:211], v[210:211], v[114:115]
    v_pk_add_f32 v[116:117], v[116:117], v[86:87]
    v_pk_fma_f32 v[118:119], v[86:87], v[86:87], v[118:119]
    v_pk_fma_f32 v[120:121], v[86:87], v[42:43], v[120:121]
    v_pk_fma_f32 v[122:123], v[86:87], v[62:63], v[122:123]
    v_pk_add_f32 v[112:113], v[112:113], v[212:213]
    v_pk_fma_f32 v[114:115], v[212:213], v[212:213], v[114:115]
    v_pk_add_f32 v[116:117], v[116:117], v[88:89]
    v_pk_fma_f32 v[118:119], v[88:89], v[88:89], v[118:119]
    v_pk_fma_f32 v[120:121], v[88:89], v[44:45], v[120:121]
    v_pk_fma_f32 v[122:123], v[88:89], v[64:65], v[122:123]
    v_pk_add_f32 v[112:113], v[112:113], v[214:215]
    v_pk_fma_f32 v[114:115], v[214:215], v[214:215], v[114:115]
    v_pk_add_f32 v[116:117], v[116:117], v[90:91]
    v_pk_fma_f32 v[118:119], v[90:91], v[90:91], v[118:119]
    v_pk_fma_f32 v[120:121], v[90:91], v[46:47], v[120:121]
    v_pk_fma_f32 v[122:123], v[90:91], v[66:67], v[122:123]
    v_pk_add_f32 v[112:113], v[112:113], v[216:217]
    v_pk_fma_f32 v[114:115], v[216:217], v[216:217], v[114:115]
    v_pk_add_f32 v[116:117], v[116:117], v[92:93]
    v_pk_fma_f32 v[118:119], v[92:93], v[92:93], v[118:119]
    v_pk_fma_f32 v[120:121], v[92:93], v[48:49], v[120:121]
    v_pk_fma_f32 v[122:123], v[92:93], v[68:69], v[122:123]
    v_pk_add_f32 v[112:113], v[112:113], v[218:219]
    v_pk_fma_f32 v[114:115], v[218:219], v[218:219], v[114:115]
    v_pk_add_f32 v[116:117], v[116:117], v[94:95]
    v_pk_fma_f32 v[118:119], v[94:95], v[94:95], v[118:119]
    v_pk_fma_f32 v[120:121], v[94:95], v[50:51], v[120:121]
    v_pk_fma_f32 v[122:123], v[94:95], v[70:71], v[122:123]
    v_pk_add_f32 v[112:113], v[112:113], v[220:221]
    v_pk_fma_f32 v[114:115], v[220:221], v[220:221], v[114:115]
    v_pk_add_f32 v[116:117], v[116:117], v[96:97]
    v_pk_fma_f32 v[118:119], v[96:97], v[96:97], v[118:119]
    v_pk_fma_f32 v[120:121], v[96:97], v[52:53], v[120:121]
    v_pk_fma_f32 v[122:123], v[96:97], v[72:73], v[122:123]
    v_pk_add_f32 v[112:113], v[112:113], v[222:223]
    v_pk_fma_f32 v[114:115], v[222:223], v[222:223], v[114:115]
    v_pk_add_f32 v[116:117], v[116:117], v[98:99]
    v_pk_fma_f32 v[118:119], v[98:99], v[98:99], v[118:119]
    v_pk_fma_f32 v[120:121], v[98:99], v[54:55], v[120:121]
    v_pk_fma_f32 v[122:123], v[98:99], v[74:75], v[122:123]
    v_add_f32 v112, v112, v113
    v_add_f32 v114, v114, v115
    v_add_f32 v116, v116, v117
    v_add_f32 v118, v118, v119
    v_add_f32 v120, v120, v121
    v_add_f32 v122, v122, v123
    v_mov_b32 v113, v112
    v_mov_b32 v115, v114
    v_mov_b32 v117, v116
    v_mov_b32 v119, v118
    v_mov_b32 v121, v120
    v_mov_b32 v123, v122
    v_permlane16_swap_b32 v112, v113
    v_permlane16_swap_b32 v114, v115
    v_permlane16_swap_b32 v116, v117
    v_permlane16_swap_b32 v118, v119
    v_permlane16_swap_b32 v120, v121
    v_permlane16_swap_b32 v122, v123
    v_add_f32 v112, v112, v113
    v_add_f32 v114, v114, v115
    v_add_f32 v116, v116, v117
    v_add_f32 v118, v118, v119
    v_add_f32 v120, v120, v121
    v_add_f32 v122, v122, v123
    v_mov_b32 v113, v112
    v_mov_b32 v115, v114
    v_mov_b32 v117, v116
    v_mov_b32 v119, v118
    v_mov_b32 v121, v120
    v_mov_b32 v123, v122
    v_permlane32_swap_b32 v112, v113
    v_permlane32_swap_b32 v114, v115
    v_permlane32_swap_b32 v116, v117
    v_permlane32_swap_b32 v118, v119
    v_permlane32_swap_b32 v120, v121
    v_permlane32_swap_b32 v122, v123
    v_add_f32 v112, v112, v113
    v_add_f32 v114, v114, v115
    v_add_f32 v116, v116, v117
    v_add_f32 v118, v118, v119
    v_add_f32 v120, v120, v121
    v_add_f32 v122, v122, v123
    v_cmp_eq_u32 vcc, 0, v4
    v_lshlrev_b32 v10, 5, v3
    v_lshl_add_u32 v10, v4, 4, v10
    v_cndmask_b32 v12, v120, v112, vcc
    v_cndmask_b32 v13, v122, v114, vcc
    v_cndmask_b32 v14, 0, v116, vcc
    v_cndmask_b32 v15, 0, v118, vcc
    v_mov_b32 v11, 0xf0000000
    v_cmp_gt_u32 vcc, 2, v4
    s_nop 1
    v_cndmask_b32_e64 v10, v11, v10, vcc
    buffer_store_dwordx4 v[12:15], v10, s[36:39], s97 offen sc1
    v_cvt_pk_bf16_f32 v230, v204, v205
    v_cvt_pk_bf16_f32 v231, v206, v207
    v_cvt_pk_bf16_f32 v232, v208, v209
    v_cvt_pk_bf16_f32 v233, v210, v211
    v_cvt_pk_bf16_f32 v234, v212, v213
    v_cvt_pk_bf16_f32 v235, v214, v215
    v_cvt_pk_bf16_f32 v236, v216, v217
    v_cvt_pk_bf16_f32 v237, v218, v219
    v_cvt_pk_bf16_f32 v238, v220, v221
    v_cvt_pk_bf16_f32 v239, v222, v223
    s_waitcnt vmcnt(0)
    s_barrier
    s_lshl_b32 s62, s53, 4
    s_add_u32 s62, s62, s54
    s_cmp_lg_u32 s55, 0
    s_cbranch_scc1 PF_93
    s_lshl_b32 s57, s62, 7
    s_add_u32 s57, s57, 151552
    v_mov_b32 v3, s52
    v_mov_b32 v4, 0
    s_mov_b64 exec, 1
    buffer_store_dword v3, v4, s[36:39], s57 offen sc1
    s_nop 1
    s_mov_b64 exec, -1
PF_93:
    s_lshr_b32 s61, s54, 1
    s_mul_i32 s57, s61, 48
    s_mul_i32 s58, s55, 12
    s_add_u32 s57, s57, s58
    s_mul_i32 s57, s57, 5120
    s_add_u32 s95, s57, 28311552
    s_min_u32 s57, s55, 2
    s_mul_i32 s58, s57, 40960
    v_add_u32 v3, s58, v2
    v_and_b32 v4, 31, v1
    v_min_u32 v4, 2, v4
    v_mul_u32_u24 v4, 1280, v4
    v_lshrrev_b32_e64 v5, 5, v1
    v_lshl_add_u32 v4, v5, 4, v4
    v_add_u32 v4, 153216, v4
    v_mul_u32_u24_e64 v6, 40, v1
    v_add_u32 v6, 147456, v6
    ds_read_b128 v[16:19], v3 offset:0
    ds_read_b128 v[20:23], v4 offset:0
    ds_read_b128 v[24:27], v3 offset:1024
    ds_read_b128 v[28:31], v4 offset:32
    ds_read_b128 v[32:35], v3 offset:2048
    ds_read_b128 v[36:39], v4 offset:64
    ds_read_b128 v[40:43], v3 offset:3072
    ds_read_b128 v[44:47], v4 offset:96
    s_waitcnt lgkmcnt(6)
    s_nop 0
    v_mfma_f32_32x32x16_bf16 v[64:79], v[16:19], v[20:23], 0
    ds_read_b64 v[84:85], v6 offset:2560
    ds_read_b64 v[94:95], v6 offset:0
    ds_read_b64 v[86:87], v6 offset:2568
    ds_read_b128 v[16:19], v3 offset:4096
    ds_read_b128 v[20:23], v4 offset:128
    s_waitcnt lgkmcnt(9)
    s_nop 0
    v_mfma_f32_32x32x16_bf16 v[64:79], v[24:27], v[28:31], v[64:79]
    ds_read_b64 v[96:97], v6 offset:8
    ds_read_b64 v[88:89], v6 offset:2576
    ds_read_b64 v[98:99], v6 offset:16
    buffer_load_dwordx4 a[0:3], v2, s[36:39], s95 offen offset:0 sc1
    ds_read_b128 v[24:27], v3 offset:5120
    ds_read_b128 v[28:31], v4 offset:160
    s_waitcnt lgkmcnt(12)
    v_mfma_f32_32x32x16_bf16 v[64:79], v[32:35], v[36:39], v[64:79]
    ds_read_b64 v[90:91], v6 offset:2584
    ds_read_b64 v[100:101], v6 offset:24
    ds_read_b64 v[92:93], v6 offset:2592
    s_waitcnt lgkmcnt(14)
    ds_read_b128 v[32:35], v3 offset:6144
    s_waitcnt lgkmcnt(14)
    ds_read_b128 v[36:39], v4 offset:192
    v_mfma_f32_32x32x16_bf16 v[64:79], v[40:43], v[44:47], v[64:79]
    s_waitcnt lgkmcnt(14)
    ds_read_b64 v[102:103], v6 offset:32
    s_waitcnt lgkmcnt(13)
    v_pk_add_f32 v[104:105], v[84:85], v[86:87]
    s_waitcnt lgkmcnt(9)
    v_pk_add_f32 v[104:105], v[104:105], v[88:89]
    buffer_load_dwordx4 a[4:7], v2, s[36:39], s95 offen offset:1024 sc1
    ds_read_b128 v[40:43], v3 offset:7168
    ds_read_b128 v[44:47], v4 offset:224
    v_mfma_f32_32x32x16_bf16 v[64:79], v[16:19], v[20:23], v[64:79]
    s_waitcnt lgkmcnt(7)
    v_pk_add_f32 v[104:105], v[104:105], v[90:91]
    s_waitcnt lgkmcnt(5)
    v_pk_add_f32 v[104:105], v[104:105], v[92:93]
    v_add_f32_e64 v156, v104, v105
    ds_read_b128 v[16:19], v3 offset:8192
    ds_read_b128 v[20:23], v4 offset:256
    v_mfma_f32_32x32x16_bf16 v[64:79], v[24:27], v[28:31], v[64:79]
    v_pk_add_f32 v[106:107], v[94:95], v[96:97]
    v_pk_add_f32 v[106:107], v[106:107], v[98:99]
    v_pk_add_f32 v[106:107], v[106:107], v[100:101]
    buffer_load_dwordx4 a[8:11], v2, s[36:39], s95 offen offset:2048 sc1
    ds_read_b128 v[24:27], v3 offset:9216
    ds_read_b128 v[28:31], v4 offset:288
    s_waitcnt lgkmcnt(7)
    v_mfma_f32_32x32x16_bf16 v[64:79], v[32:35], v[36:39], v[64:79]
    s_waitcnt lgkmcnt(6)
    v_pk_add_f32 v[106:107], v[106:107], v[102:103]
    v_add_f32_e64 v157, v106, v107
    v_pk_mul_f32 v[108:109], v[84:85], v[84:85]
    ds_read_b128 v[32:35], v3 offset:10240
    ds_read_b128 v[36:39], v4 offset:320
    s_waitcnt lgkmcnt(6)
    s_nop 0
    v_mfma_f32_32x32x16_bf16 v[64:79], v[40:43], v[44:47], v[64:79]
    v_pk_fma_f32 v[108:109], v[86:87], v[86:87], v[108:109]
    v_pk_fma_f32 v[108:109], v[88:89], v[88:89], v[108:109]
    v_pk_fma_f32 v[108:109], v[90:91], v[90:91], v[108:109]
    buffer_load_dwordx4 a[12:15], v2, s[36:39], s95 offen offset:3072 sc1
    ds_read_b128 v[40:43], v3 offset:11264
    ds_read_b128 v[44:47], v4 offset:352
    s_waitcnt lgkmcnt(6)
    v_mfma_f32_32x32x16_bf16 v[64:79], v[16:19], v[20:23], v[64:79]
    v_pk_fma_f32 v[108:109], v[92:93], v[92:93], v[108:109]
    v_add_f32 v158, v108, v109
    v_pk_mul_f32 v[110:111], v[84:85], v[94:95]
    ds_read_b128 v[16:19], v3 offset:12288
    ds_read_b128 v[20:23], v4 offset:384
    s_waitcnt lgkmcnt(6)
    s_nop 0
    v_mfma_f32_32x32x16_bf16 v[64:79], v[24:27], v[28:31], v[64:79]
    v_pk_fma_f32 v[110:111], v[86:87], v[96:97], v[110:111]
    v_pk_fma_f32 v[110:111], v[88:89], v[98:99], v[110:111]
    v_pk_fma_f32 v[110:111], v[90:91], v[100:101], v[110:111]
    s_add_u32 s95, s95, 4096
    buffer_load_dwordx4 a[16:19], v2, s[36:39], s95 offen offset:0 sc1
    ds_read_b128 v[24:27], v3 offset:13312
    ds_read_b128 v[28:31], v4 offset:416
    s_waitcnt lgkmcnt(6)
    v_mfma_f32_32x32x16_bf16 v[64:79], v[32:35], v[36:39], v[64:79]
    v_pk_fma_f32 v[110:111], v[92:93], v[102:103], v[110:111]
    v_add_f32 v159, v110, v111
    v_pk_mul_f32 v[112:113], v[94:95], v[94:95]
    ds_read_b128 v[32:35], v3 offset:14336
    ds_read_b128 v[36:39], v4 offset:448
    s_waitcnt lgkmcnt(6)
    s_nop 0
    v_mfma_f32_32x32x16_bf16 v[64:79], v[40:43], v[44:47], v[64:79]
    v_pk_fma_f32 v[112:113], v[96:97], v[96:97], v[112:113]
    v_pk_fma_f32 v[112:113], v[98:99], v[98:99], v[112:113]
    v_pk_fma_f32 v[112:113], v[100:101], v[100:101], v[112:113]
    buffer_load_dwordx4 a[20:23], v2, s[36:39], s95 offen offset:1024 sc1
    ds_read_b128 v[40:43], v3 offset:15360
    ds_read_b128 v[44:47], v4 offset:480
    s_waitcnt lgkmcnt(6)
    v_mfma_f32_32x32x16_bf16 v[64:79], v[16:19], v[20:23], v[64:79]
    v_pk_fma_f32 v[112:113], v[102:103], v[102:103], v[112:113]
    v_add_f32 v160, v112, v113
    v_add_f32_dpp v156, v156, v156 row_ror:8 row_mask:0xf bank_mask:0xf
    ds_read_b128 v[16:19], v3 offset:16384
    ds_read_b128 v[20:23], v4 offset:512
    s_waitcnt lgkmcnt(6)
    s_nop 0
    v_mfma_f32_32x32x16_bf16 v[64:79], v[24:27], v[28:31], v[64:79]
    v_add_f32_dpp v157, v157, v157 row_ror:8 row_mask:0xf bank_mask:0xf
    v_add_f32_dpp v158, v158, v158 row_ror:8 row_mask:0xf bank_mask:0xf
    v_add_f32_dpp v159, v159, v159 row_ror:8 row_mask:0xf bank_mask:0xf
    buffer_load_dwordx4 a[24:27], v2, s[36:39], s95 offen offset:2048 sc1
    ds_read_b128 v[24:27], v3 offset:17408
    ds_read_b128 v[28:31], v4 offset:544
    s_waitcnt lgkmcnt(6)
    s_nop 0
    v_mfma_f32_32x32x16_bf16 v[64:79], v[32:35], v[36:39], v[64:79]
    v_add_f32_dpp v160, v160, v160 row_ror:8 row_mask:0xf bank_mask:0xf
    v_add_f32_dpp v156, v156, v156 row_ror:4 row_mask:0xf bank_mask:0xf
    v_add_f32_dpp v157, v157, v157 row_ror:4 row_mask:0xf bank_mask:0xf
    ds_read_b128 v[32:35], v3 offset:18432
    ds_read_b128 v[36:39], v4 offset:576
    s_waitcnt lgkmcnt(6)
    s_nop 0
    v_mfma_f32_32x32x16_bf16 v[64:79], v[40:43], v[44:47], v[64:79]
    v_add_f32_dpp v158, v158, v158 row_ror:4 row_mask:0xf bank_mask:0xf
    v_add_f32_dpp v159, v159, v159 row_ror:4 row_mask:0xf bank_mask:0xf
    v_add_f32_dpp v160, v160, v160 row_ror:4 row_mask:0xf bank_mask:0xf
    buffer_load_dwordx4 a[28:31], v2, s[36:39], s95 offen offset:3072 sc1
    ds_read_b128 v[40:43], v3 offset:19456
    ds_read_b128 v[44:47], v4 offset:608
    s_waitcnt lgkmcnt(6)
    s_nop 0
    v_mfma_f32_32x32x16_bf16 v[64:79], v[16:19], v[20:23], v[64:79]
    v_add_f32_dpp v156, v156, v156 row_ror:2 row_mask:0xf bank_mask:0xf
    v_add_f32_dpp v157, v157, v157 row_ror:2 row_mask:0xf bank_mask:0xf
    v_add_f32_dpp v158, v158, v158 row_ror:2 row_mask:0xf bank_mask:0xf
    ds_read_b128 v[16:19], v3 offset:20480
    ds_read_b128 v[20:23], v4 offset:640
    s_waitcnt lgkmcnt(6)
    s_nop 0
    v_mfma_f32_32x32x16_bf16 v[64:79], v[24:27], v[28:31], v[64:79]
    v_add_f32_dpp v159, v159, v159 row_ror:2 row_mask:0xf bank_mask:0xf
    v_add_f32_dpp v160, v160, v160 row_ror:2 row_mask:0xf bank_mask:0xf
    v_add_f32_dpp v156, v156, v156 row_ror:1 row_mask:0xf bank_mask:0xf
    s_add_u32 s95, s95, 4096
    buffer_load_dwordx4 a[32:35], v2, s[36:39], s95 offen offset:0 sc1
    ds_read_b128 v[24:27], v3 offset:21504
    ds_read_b128 v[28:31], v4 offset:672
    s_waitcnt lgkmcnt(6)
    s_nop 0
    v_mfma_f32_32x32x16_bf16 v[64:79], v[32:35], v[36:39], v[64:79]
    v_add_f32_dpp v157, v157, v157 row_ror:1 row_mask:0xf bank_mask:0xf
    v_add_f32_dpp v158, v158, v158 row_ror:1 row_mask:0xf bank_mask:0xf
    v_add_f32_dpp v159, v159, v159 row_ror:1 row_mask:0xf bank_mask:0xf
    ds_read_b128 v[32:35], v3 offset:22528
    ds_read_b128 v[36:39], v4 offset:704
    s_waitcnt lgkmcnt(6)
    v_mfma_f32_32x32x16_bf16 v[64:79], v[40:43], v[44:47], v[64:79]
    v_add_f32_dpp v160, v160, v160 row_ror:1 row_mask:0xf bank_mask:0xf
    v_mov_b32 v104, v156
    v_mov_b32_e64 v105, v157
    buffer_load_dwordx4 a[36:39], v2, s[36:39], s95 offen offset:1024 sc1
    ds_read_b128 v[40:43], v3 offset:23552
    ds_read_b128 v[44:47], v4 offset:736
    s_waitcnt lgkmcnt(6)
    v_mfma_f32_32x32x16_bf16 v[64:79], v[16:19], v[20:23], v[64:79]
    v_mov_b32 v106, v158
    v_mov_b32 v107, v159
    v_mov_b32 v108, v160
    ds_read_b128 v[16:19], v3 offset:24576
    ds_read_b128 v[20:23], v4 offset:768
    s_waitcnt lgkmcnt(6)
    v_mfma_f32_32x32x16_bf16 v[64:79], v[24:27], v[28:31], v[64:79]
    v_permlane16_swap_b32 v156, v104
    v_permlane16_swap_b32 v157, v105
    v_permlane16_swap_b32 v158, v106
    buffer_load_dwordx4 a[40:43], v2, s[36:39], s95 offen offset:2048 sc1
    ds_read_b128 v[24:27], v3 offset:25600
    ds_read_b128 v[28:31], v4 offset:800
    s_waitcnt lgkmcnt(6)
    v_mfma_f32_32x32x16_bf16 v[64:79], v[32:35], v[36:39], v[64:79]
    v_permlane16_swap_b32 v159, v107
    v_permlane16_swap_b32 v160, v108
    v_add_f32 v156, v156, v104
    ds_read_b128 v[32:35], v3 offset:26624
    ds_read_b128 v[36:39], v4 offset:832
    s_waitcnt lgkmcnt(6)
    v_mfma_f32_32x32x16_bf16 v[64:79], v[40:43], v[44:47], v[64:79]
    v_add_f32 v157, v157, v105
    v_add_f32 v158, v158, v106
    v_add_f32 v159, v159, v107
    buffer_load_dwordx4 a[44:47], v2, s[36:39], s95 offen offset:3072 sc1
    ds_read_b128 v[40:43], v3 offset:27648
    ds_read_b128 v[44:47], v4 offset:864
    s_waitcnt lgkmcnt(6)
    v_mfma_f32_32x32x16_bf16 v[64:79], v[16:19], v[20:23], v[64:79]
    v_add_f32 v160, v160, v108
    v_mov_b32 v104, v156
    v_mov_b32 v105, v157
    ds_read_b128 v[16:19], v3 offset:28672
    ds_read_b128 v[20:23], v4 offset:896
    s_waitcnt lgkmcnt(6)
    v_mfma_f32_32x32x16_bf16 v[64:79], v[24:27], v[28:31], v[64:79]
    v_mov_b32 v106, v158
    v_mov_b32 v107, v159
    v_mov_b32 v108, v160
    s_add_u32 s95, s95, 4096
    buffer_load_dwordx4 a[48:51], v2, s[36:39], s95 offen offset:0 sc1
    ds_read_b128 v[24:27], v3 offset:29696
    ds_read_b128 v[28:31], v4 offset:928
    s_waitcnt lgkmcnt(6)
    v_mfma_f32_32x32x16_bf16 v[64:79], v[32:35], v[36:39], v[64:79]
    v_permlane32_swap_b32 v156, v104
    v_permlane32_swap_b32 v157, v105
    v_permlane32_swap_b32 v158, v106
    ds_read_b128 v[32:35], v3 offset:30720
    ds_read_b128 v[36:39], v4 offset:960
    s_waitcnt lgkmcnt(6)
    v_mfma_f32_32x32x16_bf16 v[64:79], v[40:43], v[44:47], v[64:79]
    v_permlane32_swap_b32 v159, v107
    v_permlane32_swap_b32 v160, v108
    v_add_f32 v156, v156, v104
    buffer_load_dwordx4 a[52:55], v2, s[36:39], s95 offen offset:1024 sc1
    ds_read_b128 v[40:43], v3 offset:31744
    ds_read_b128 v[44:47], v4 offset:992
    s_waitcnt lgkmcnt(6)
    v_mfma_f32_32x32x16_bf16 v[64:79], v[16:19], v[20:23], v[64:79]
    v_add_f32 v157, v157, v105
    v_add_f32 v158, v158, v106
    v_add_f32 v159, v159, v107
    ds_read_b128 v[16:19], v3 offset:32768
    ds_read_b128 v[20:23], v4 offset:1024
    s_waitcnt lgkmcnt(6)
    v_mfma_f32_32x32x16_bf16 v[64:79], v[24:27], v[28:31], v[64:79]
    v_add_f32 v160, v160, v108
    v_mul_f32 v156, 0x3acccccd, v156
    v_mul_f32 v157, 0x3acccccd, v157
    buffer_load_dwordx4 a[56:59], v2, s[36:39], s95 offen offset:2048 sc1
    ds_read_b128 v[24:27], v3 offset:33792
    ds_read_b128 v[28:31], v4 offset:1056
    s_waitcnt lgkmcnt(6)
    s_nop 0
    v_mfma_f32_32x32x16_bf16 v[64:79], v[32:35], v[36:39], v[64:79]
    v_mul_f32 v158, 0x3acccccd, v158
    v_mul_f32 v159, 0x3acccccd, v159
    v_mul_f32 v160, 0x3acccccd, v160
    ds_read_b128 v[32:35], v3 offset:34816
    ds_read_b128 v[36:39], v4 offset:1088
    s_waitcnt lgkmcnt(6)
    v_mfma_f32_32x32x16_bf16 v[64:79], v[40:43], v[44:47], v[64:79]
    buffer_load_dwordx4 a[60:63], v2, s[36:39], s95 offen offset:3072 sc1
    ds_read_b128 v[40:43], v3 offset:35840
    ds_read_b128 v[44:47], v4 offset:1120
    s_waitcnt lgkmcnt(6)
    v_mfma_f32_32x32x16_bf16 v[64:79], v[16:19], v[20:23], v[64:79]
    ds_read_b128 v[16:19], v3 offset:36864
    ds_read_b128 v[20:23], v4 offset:1152
    s_waitcnt lgkmcnt(6)
    s_nop 0
    v_mfma_f32_32x32x16_bf16 v[64:79], v[24:27], v[28:31], v[64:79]
    s_add_u32 s95, s95, 4096
    buffer_load_dwordx4 a[64:67], v2, s[36:39], s95 offen offset:0 sc1
    ds_read_b128 v[24:27], v3 offset:37888
    ds_read_b128 v[28:31], v4 offset:1184
    s_waitcnt lgkmcnt(6)
    v_mfma_f32_32x32x16_bf16 v[64:79], v[32:35], v[36:39], v[64:79]
    ds_read_b128 v[32:35], v3 offset:38912
    ds_read_b128 v[36:39], v4 offset:1216
    s_waitcnt lgkmcnt(6)
    v_mfma_f32_32x32x16_bf16 v[64:79], v[40:43], v[44:47], v[64:79]
    buffer_load_dwordx4 a[68:71], v2, s[36:39], s95 offen offset:1024 sc1
    ds_read_b128 v[40:43], v3 offset:39936
    ds_read_b128 v[44:47], v4 offset:1248
    s_waitcnt lgkmcnt(6)
    v_mfma_f32_32x32x16_bf16 v[64:79], v[16:19], v[20:23], v[64:79]
    s_waitcnt lgkmcnt(4)
    v_mfma_f32_32x32x16_bf16 v[64:79], v[24:27], v[28:31], v[64:79]
    buffer_load_dwordx4 a[72:75], v2, s[36:39], s95 offen offset:2048 sc1
    s_waitcnt lgkmcnt(2)
    v_mfma_f32_32x32x16_bf16 v[64:79], v[32:35], v[36:39], v[64:79]
    s_waitcnt lgkmcnt(0)
    v_mfma_f32_32x32x16_bf16 v[64:79], v[40:43], v[44:47], v[64:79]
    buffer_load_dwordx4 a[76:79], v2, s[36:39], s95 offen offset:3072 sc1
    v_and_b32_e64 v4, 31, v1
    v_mul_u32_u24 v4, 384, v4
    v_lshl_add_u32 v4, v5, 4, v4
    s_lshl_b32 s57, s57, 7
    s_add_u32 s57, s57, 157056
    v_add_u32 v4, s57, v4
    s_mov_b32 exec_lo, 7
    s_mov_b32 exec_hi, 7
    s_nop 2
    ds_write_b128 v4, v[64:67] offset:0
    ds_write_b128 v4, v[68:71] offset:32
    ds_write_b128 v4, v[72:75] offset:64
    ds_write_b128 v4, v[76:79] offset:96
    s_mov_b64 exec, -1
    s_waitcnt lgkmcnt(0)
    s_lshl_b32 s57, s53, 2
    s_add_u32 s57, s57, s55
    s_mul_i32 s98, s57, 40960
    s_add_u32 s98, s98, 15728640
    s_lshl_b32 s99, s57, 13
    s_add_u32 s99, s99, 393216
    s_lshl_b32 s57, s53, 3
    s_lshl_b32 s58, s55, 1
    s_add_u32 s57, s57, s58
    s_mul_i32 s57, s57, 48
    s_mul_i32 s58, s54, 3
    s_add_u32 s57, s57, s58
    s_lshl_b32 s57, s57, 10
    s_add_u32 s96, s57, 18874368
    v_bfe_u32 v3, v1, 4, 1
    v_mul_u32_u24 v3, 49152, v3
    v_and_b32 v4, 15, v1
    v_lshl_add_u32 v3, v4, 4, v3
    v_lshrrev_b32_e64 v4, 5, v1
    v_lshl_add_u32 v244, v4, 8, v3
    v_lshlrev_b32_e64 v4, 4, v4
    v_add_u32 v243, 157056, v4
    s_mov_b32 s60, 0xc0135761
    s_mov_b32 s61, 0xc0135761
    s_mov_b32 s62, 0xbdd2d3e8
    s_mov_b32 s63, 0xbdd2d3e8
    v_mov_b32_e64 v240, v2
    v_add_u32 v241, 40960, v2
    v_add_u32 v242, 81920, v2
    v_and_b32 v8, 15, v1
    s_lshl_b32 s57, s53, 4
    v_add_u32 v8, s57, v8
    v_lshlrev_b32 v8, 7, v8
    v_add_u32 v8, 151552, v8
    s_cmp_lg_u32 s55, 0
    s_cbranch_scc1 POLLS_94
    s_mov_b32 s57, 0
POLL_95:
    buffer_load_dword v9, v8, s[36:39], 0 offen sc1
    s_waitcnt vmcnt(0)
    v_cmp_ne_u32 vcc, s52, v9
    s_add_u32 s57, s57, 1
    s_cmp_gt_u32 s57, 400000
    s_cbranch_scc1 POLLD_96
    s_cbranch_vccnz POLL_95
POLLD_96:
POLLS_94:
    s_barrier
    s_nop 0
    buffer_load_dwordx4 v[16:19], v2, s[36:39], s98 offen offset:0 sc1
    buffer_load_dwordx4 v[20:23], v2, s[36:39], s98 offen offset:1024 sc1
    buffer_load_dwordx4 v[24:27], v2, s[36:39], s98 offen offset:2048 sc1
    buffer_load_dwordx4 v[28:31], v2, s[36:39], s98 offen offset:3072 sc1
    s_add_u32 s98, s98, 4096
    buffer_load_dwordx4 v[32:35], v2, s[36:39], s98 offen offset:0 sc1
    buffer_load_dwordx4 v[36:39], v2, s[36:39], s98 offen offset:1024 sc1
    buffer_load_dwordx4 v[40:43], v2, s[36:39], s98 offen offset:2048 sc1
    buffer_load_dwordx4 v[44:47], v2, s[36:39], s98 offen offset:3072 sc1
    s_add_u32 s98, s98, 4096
    buffer_load_dwordx4 v[48:51], v2, s[36:39], s98 offen offset:0 sc1
    buffer_load_dwordx4 v[52:55], v2, s[36:39], s98 offen offset:1024 sc1
    buffer_load_dwordx4 v[56:59], v2, s[36:39], s98 offen offset:2048 sc1
    buffer_load_dwordx4 v[60:63], v2, s[36:39], s98 offen offset:3072 sc1
    ds_read_b128 v[80:83], v240 offset:0
    ds_read_b128 v[84:87], v241 offset:0
    ds_read_b128 v[88:91], v240 offset:1024
    ds_read_b128 v[92:95], v241 offset:1024
    s_waitcnt vmcnt(11) lgkmcnt(3)
    s_nop 0
    v_mfma_f32_32x32x16_bf16 v[176:191], v[80:83], v[16:19], 0
    s_add_u32 s98, s98, 4096
    buffer_load_dwordx4 v[64:67], v2, s[36:39], s98 offen offset:0 sc1
    ds_read_b128 v[246:249], v240 offset:2048
    ds_read_b128 v[250:253], v241 offset:2048
    s_waitcnt lgkmcnt(4)
    v_mfma_f32_32x32x16_bf16 v[192:207], v[84:87], v[16:19], 0
    buffer_load_dwordx4 v[68:71], v2, s[36:39], s98 offen offset:1024 sc1
    s_waitcnt vmcnt(12) lgkmcnt(3)
    v_mfma_f32_32x32x16_bf16 v[176:191], v[88:91], v[20:23], v[176:191]
    buffer_load_dwordx4 v[72:75], v2, s[36:39], s98 offen offset:2048 sc1
    ds_read_b128 v[80:83], v240 offset:3072
    ds_read_b128 v[84:87], v241 offset:3072
    s_waitcnt lgkmcnt(4)
    v_mfma_f32_32x32x16_bf16 v[192:207], v[92:95], v[20:23], v[192:207]
    buffer_load_dwordx4 v[76:79], v2, s[36:39], s98 offen offset:3072 sc1
    s_waitcnt vmcnt(13) lgkmcnt(3)
    v_mfma_f32_32x32x16_bf16 v[176:191], v[246:249], v[24:27], v[176:191]
    s_add_u32 s98, s98, 4096
    buffer_load_dwordx4 a[160:163], v2, s[36:39], s98 offen offset:0 sc1
    ds_read_b128 v[88:91], v240 offset:4096
    ds_read_b128 v[92:95], v241 offset:4096
    s_waitcnt lgkmcnt(4)
    v_mfma_f32_32x32x16_bf16 v[192:207], v[250:253], v[24:27], v[192:207]
    buffer_load_dwordx4 a[164:167], v2, s[36:39], s98 offen offset:1024 sc1
    s_waitcnt vmcnt(14) lgkmcnt(3)
    v_mfma_f32_32x32x16_bf16 v[176:191], v[80:83], v[28:31], v[176:191]
    buffer_load_dwordx4 a[168:171], v2, s[36:39], s98 offen offset:2048 sc1
    ds_read_b128 v[246:249], v240 offset:5120
    ds_read_b128 v[250:253], v241 offset:5120
    s_waitcnt lgkmcnt(4)
    v_mfma_f32_32x32x16_bf16 v[192:207], v[84:87], v[28:31], v[192:207]
    buffer_load_dwordx4 a[172:175], v2, s[36:39], s98 offen offset:3072 sc1
    s_waitcnt vmcnt(15) lgkmcnt(3)
    v_mfma_f32_32x32x16_bf16 v[176:191], v[88:91], v[32:35], v[176:191]
    buffer_load_dwordx4 v[96:99], v2, s[36:39], s99 offen offset:0 sc1
    ds_read_b128 v[80:83], v240 offset:6144
    ds_read_b128 v[84:87], v241 offset:6144
    s_waitcnt lgkmcnt(4)
    v_mfma_f32_32x32x16_bf16 v[192:207], v[92:95], v[32:35], v[192:207]
    s_add_u32 s98, s98, 4096
    buffer_load_dwordx4 a[176:179], v2, s[36:39], s98 offen offset:0 sc1
    s_waitcnt vmcnt(16) lgkmcnt(3)
    v_mfma_f32_32x32x16_bf16 v[176:191], v[246:249], v[36:39], v[176:191]
    buffer_load_dwordx4 v[100:103], v2, s[36:39], s99 offen offset:1024 sc1
    ds_read_b128 v[88:91], v240 offset:7168
    ds_read_b128 v[92:95], v241 offset:7168
    s_waitcnt lgkmcnt(4)
    v_mfma_f32_32x32x16_bf16 v[192:207], v[250:253], v[36:39], v[192:207]
    buffer_load_dwordx4 a[180:183], v2, s[36:39], s98 offen offset:1024 sc1
    s_waitcnt vmcnt(17) lgkmcnt(3)
    v_mfma_f32_32x32x16_bf16 v[176:191], v[80:83], v[40:43], v[176:191]
    buffer_load_dwordx4 v[104:107], v2, s[36:39], s99 offen offset:2048 sc1
    ds_read_b128 v[246:249], v240 offset:8192
    ds_read_b128 v[250:253], v241 offset:8192
    s_waitcnt lgkmcnt(4)
    v_mfma_f32_32x32x16_bf16 v[192:207], v[84:87], v[40:43], v[192:207]
    buffer_load_dwordx4 a[184:187], v2, s[36:39], s98 offen offset:2048 sc1
    s_waitcnt vmcnt(18) lgkmcnt(3)
    v_mfma_f32_32x32x16_bf16 v[176:191], v[88:91], v[44:47], v[176:191]
    buffer_load_dwordx4 v[108:111], v2, s[36:39], s99 offen offset:3072 sc1
    ds_read_b128 v[80:83], v240 offset:9216
    ds_read_b128 v[84:87], v241 offset:9216
    s_waitcnt lgkmcnt(4)
    v_mfma_f32_32x32x16_bf16 v[192:207], v[92:95], v[44:47], v[192:207]
    buffer_load_dwordx4 a[188:191], v2, s[36:39], s98 offen offset:3072 sc1
    s_waitcnt vmcnt(19) lgkmcnt(3)
    v_mfma_f32_32x32x16_bf16 v[176:191], v[246:249], v[48:51], v[176:191]
    s_add_u32 s99, s99, 4096
    buffer_load_dwordx4 v[112:115], v2, s[36:39], s99 offen offset:0 sc1
    ds_read_b128 v[88:91], v240 offset:10240
    ds_read_b128 v[92:95], v241 offset:10240
    s_waitcnt lgkmcnt(4)
    v_mfma_f32_32x32x16_bf16 v[192:207], v[250:253], v[48:51], v[192:207]
    s_waitcnt vmcnt(19) lgkmcnt(3)
    v_mfma_f32_32x32x16_bf16 v[176:191], v[80:83], v[52:55], v[176:191]
    s_add_u32 s98, s98, 4096
    buffer_load_dwordx4 a[192:195], v2, s[36:39], s98 offen offset:0 sc1
    ds_read_b128 v[246:249], v240 offset:11264
    ds_read_b128 v[250:253], v241 offset:11264
    s_waitcnt lgkmcnt(4)
    v_mfma_f32_32x32x16_bf16 v[192:207], v[84:87], v[52:55], v[192:207]
    s_waitcnt vmcnt(19) lgkmcnt(3)
    v_mfma_f32_32x32x16_bf16 v[176:191], v[88:91], v[56:59], v[176:191]
    buffer_load_dwordx4 v[116:119], v2, s[36:39], s99 offen offset:1024 sc1
    ds_read_b128 v[80:83], v240 offset:12288
    ds_read_b128 v[84:87], v241 offset:12288
    s_waitcnt lgkmcnt(4)
    v_mfma_f32_32x32x16_bf16 v[192:207], v[92:95], v[56:59], v[192:207]
    s_waitcnt vmcnt(19) lgkmcnt(3)
    v_mfma_f32_32x32x16_bf16 v[176:191], v[246:249], v[60:63], v[176:191]
    buffer_load_dwordx4 a[196:199], v2, s[36:39], s98 offen offset:1024 sc1
    ds_read_b128 v[88:91], v240 offset:13312
    ds_read_b128 v[92:95], v241 offset:13312
    s_waitcnt lgkmcnt(4)
    v_mfma_f32_32x32x16_bf16 v[192:207], v[250:253], v[60:63], v[192:207]
    s_waitcnt vmcnt(19) lgkmcnt(3)
    v_mfma_f32_32x32x16_bf16 v[176:191], v[80:83], v[64:67], v[176:191]
    buffer_load_dwordx4 v[120:123], v2, s[36:39], s99 offen offset:2048 sc1
    ds_read_b128 v[246:249], v240 offset:14336
    ds_read_b128 v[250:253], v241 offset:14336
    s_waitcnt lgkmcnt(4)
    v_mfma_f32_32x32x16_bf16 v[192:207], v[84:87], v[64:67], v[192:207]
    s_waitcnt vmcnt(19) lgkmcnt(3)
    v_mfma_f32_32x32x16_bf16 v[176:191], v[88:91], v[68:71], v[176:191]
    buffer_load_dwordx4 a[200:203], v2, s[36:39], s98 offen offset:2048 sc1
    ds_read_b128 v[80:83], v240 offset:15360
    ds_read_b128 v[84:87], v241 offset:15360
    s_waitcnt lgkmcnt(4)
    v_mfma_f32_32x32x16_bf16 v[192:207], v[92:95], v[68:71], v[192:207]
    s_waitcnt vmcnt(19) lgkmcnt(3)
    v_mfma_f32_32x32x16_bf16 v[176:191], v[246:249], v[72:75], v[176:191]
    buffer_load_dwordx4 v[124:127], v2, s[36:39], s99 offen offset:3072 sc1
    ds_read_b128 v[88:91], v240 offset:16384
    ds_read_b128 v[92:95], v241 offset:16384
    s_waitcnt lgkmcnt(4)
    v_mfma_f32_32x32x16_bf16 v[192:207], v[250:253], v[72:75], v[192:207]
    s_waitcnt vmcnt(19) lgkmcnt(3)
    v_mfma_f32_32x32x16_bf16 v[176:191], v[80:83], v[76:79], v[176:191]
    buffer_load_dwordx4 a[204:207], v2, s[36:39], s98 offen offset:3072 sc1
    ds_read_b128 v[246:249], v240 offset:17408
    ds_read_b128 v[250:253], v241 offset:17408
    s_waitcnt lgkmcnt(4)
    v_mfma_f32_32x32x16_bf16 v[192:207], v[84:87], v[76:79], v[192:207]
    s_waitcnt vmcnt(19) lgkmcnt(3)
    v_mfma_f32_32x32x16_bf16 v[176:191], v[88:91], a[160:163], v[176:191]
    s_add_u32 s98, s98, 4096
    buffer_load_dwordx4 a[208:211], v2, s[36:39], s98 offen offset:0 sc1
    ds_read_b128 v[80:83], v240 offset:18432
    ds_read_b128 v[84:87], v241 offset:18432
    s_waitcnt lgkmcnt(4)
    v_mfma_f32_32x32x16_bf16 v[192:207], v[92:95], a[160:163], v[192:207]
    s_waitcnt vmcnt(19) lgkmcnt(3)
    v_mfma_f32_32x32x16_bf16 v[176:191], v[246:249], a[164:167], v[176:191]
    buffer_load_dwordx4 a[212:215], v2, s[36:39], s98 offen offset:1024 sc1
    ds_read_b128 v[88:91], v240 offset:19456
    ds_read_b128 v[92:95], v241 offset:19456
    s_waitcnt lgkmcnt(4)
    v_mfma_f32_32x32x16_bf16 v[192:207], v[250:253], a[164:167], v[192:207]
    s_waitcnt vmcnt(19) lgkmcnt(3)
    v_mfma_f32_32x32x16_bf16 v[176:191], v[80:83], a[168:171], v[176:191]
    buffer_load_dwordx4 a[216:219], v2, s[36:39], s98 offen offset:2048 sc1
    ds_read_b128 v[246:249], v240 offset:20480
    ds_read_b128 v[250:253], v241 offset:20480
    s_waitcnt lgkmcnt(4)
    v_mfma_f32_32x32x16_bf16 v[192:207], v[84:87], a[168:171], v[192:207]
    s_waitcnt vmcnt(19) lgkmcnt(3)
    v_mfma_f32_32x32x16_bf16 v[176:191], v[88:91], a[172:175], v[176:191]
    buffer_load_dwordx4 a[220:223], v2, s[36:39], s98 offen offset:3072 sc1
    ds_read_b128 v[80:83], v240 offset:21504
    ds_read_b128 v[84:87], v241 offset:21504
    s_waitcnt lgkmcnt(4)
    v_mfma_f32_32x32x16_bf16 v[192:207], v[92:95], a[172:175], v[192:207]
    s_waitcnt vmcnt(18) lgkmcnt(3)
    v_mfma_f32_32x32x16_bf16 v[176:191], v[246:249], a[176:179], v[176:191]
    s_add_u32 s98, s98, 4096
    buffer_load_dwordx4 a[224:227], v2, s[36:39], s98 offen offset:0 sc1
    ds_read_b128 v[88:91], v240 offset:22528
    ds_read_b128 v[92:95], v241 offset:22528
    s_waitcnt lgkmcnt(4)
    v_mfma_f32_32x32x16_bf16 v[192:207], v[250:253], a[176:179], v[192:207]
    s_waitcnt vmcnt(17) lgkmcnt(3)
    v_mfma_f32_32x32x16_bf16 v[176:191], v[80:83], a[180:183], v[176:191]
    buffer_load_dwordx4 a[228:231], v2, s[36:39], s98 offen offset:1024 sc1
    ds_read_b128 v[246:249], v240 offset:23552
    ds_read_b128 v[250:253], v241 offset:23552
    s_waitcnt lgkmcnt(4)
    v_mfma_f32_32x32x16_bf16 v[192:207], v[84:87], a[180:183], v[192:207]
    s_waitcnt vmcnt(16) lgkmcnt(3)
    v_mfma_f32_32x32x16_bf16 v[176:191], v[88:91], a[184:187], v[176:191]
    buffer_load_dwordx4 a[232:235], v2, s[36:39], s98 offen offset:2048 sc1
    ds_read_b128 v[80:83], v240 offset:24576
    ds_read_b128 v[84:87], v241 offset:24576
    s_waitcnt lgkmcnt(4)
    v_mfma_f32_32x32x16_bf16 v[192:207], v[92:95], a[184:187], v[192:207]
    s_waitcnt vmcnt(15) lgkmcnt(3)
    v_mfma_f32_32x32x16_bf16 v[176:191], v[246:249], a[188:191], v[176:191]
    buffer_load_dwordx4 a[236:239], v2, s[36:39], s98 offen offset:3072 sc1
    ds_read_b128 v[88:91], v240 offset:25600
    ds_read_b128 v[92:95], v241 offset:25600
    s_waitcnt lgkmcnt(4)
    v_mfma_f32_32x32x16_bf16 v[192:207], v[250:253], a[188:191], v[192:207]
    s_waitcnt vmcnt(14) lgkmcnt(3)
    v_mfma_f32_32x32x16_bf16 v[176:191], v[80:83], a[192:195], v[176:191]
    s_add_u32 s98, s98, 4096
    buffer_load_dwordx4 a[240:243], v2, s[36:39], s98 offen offset:0 sc1
    ds_read_b128 v[246:249], v240 offset:26624
    ds_read_b128 v[250:253], v241 offset:26624
    s_waitcnt lgkmcnt(4)
    v_mfma_f32_32x32x16_bf16 v[192:207], v[84:87], a[192:195], v[192:207]
    s_waitcnt vmcnt(13) lgkmcnt(3)
    v_mfma_f32_32x32x16_bf16 v[176:191], v[88:91], a[196:199], v[176:191]
    buffer_load_dwordx4 a[244:247], v2, s[36:39], s98 offen offset:1024 sc1
    ds_read_b128 v[80:83], v240 offset:27648
    ds_read_b128 v[84:87], v241 offset:27648
    s_waitcnt lgkmcnt(4)
    v_mfma_f32_32x32x16_bf16 v[192:207], v[92:95], a[196:199], v[192:207]
    s_waitcnt vmcnt(12) lgkmcnt(3)
    v_mfma_f32_32x32x16_bf16 v[176:191], v[246:249], a[200:203], v[176:191]
    buffer_load_dwordx4 a[248:251], v2, s[36:39], s98 offen offset:2048 sc1
    ds_read_b128 v[88:91], v240 offset:28672
    ds_read_b128 v[92:95], v241 offset:28672
    s_waitcnt lgkmcnt(4)
    v_mfma_f32_32x32x16_bf16 v[192:207], v[250:253], a[200:203], v[192:207]
    s_waitcnt vmcnt(11) lgkmcnt(3)
    v_mfma_f32_32x32x16_bf16 v[176:191], v[80:83], a[204:207], v[176:191]
    buffer_load_dwordx4 a[252:255], v2, s[36:39], s98 offen offset:3072 sc1
    ds_read_b128 v[246:249], v240 offset:29696
    ds_read_b128 v[250:253], v241 offset:29696
    s_waitcnt lgkmcnt(4)
    v_mfma_f32_32x32x16_bf16 v[192:207], v[84:87], a[204:207], v[192:207]
    s_waitcnt vmcnt(11) lgkmcnt(3)
    v_mfma_f32_32x32x16_bf16 v[176:191], v[88:91], a[208:211], v[176:191]
    ds_read_b128 v[80:83], v240 offset:30720
    ds_read_b128 v[84:87], v241 offset:30720
    s_waitcnt lgkmcnt(4)
    s_nop 0
    v_mfma_f32_32x32x16_bf16 v[192:207], v[92:95], a[208:211], v[192:207]
    v_pk_add_f32 v[96:97], v[96:97], v[100:101]
    v_pk_add_f32 v[98:99], v[98:99], v[102:103]
    v_pk_add_f32 v[96:97], v[96:97], v[104:105]
    v_pk_add_f32 v[98:99], v[98:99], v[106:107]
    v_pk_add_f32 v[96:97], v[96:97], v[108:109]
    v_pk_add_f32 v[98:99], v[98:99], v[110:111]
    s_waitcnt vmcnt(10) lgkmcnt(3)
    v_mfma_f32_32x32x16_bf16 v[176:191], v[246:249], a[212:215], v[176:191]
    ds_read_b128 v[88:91], v240 offset:31744
    ds_read_b128 v[92:95], v241 offset:31744
    s_waitcnt lgkmcnt(4)
    v_mfma_f32_32x32x16_bf16 v[192:207], v[250:253], a[212:215], v[192:207]
    v_pk_add_f32 v[96:97], v[96:97], v[112:113]
    v_pk_add_f32 v[98:99], v[98:99], v[114:115]
    v_pk_add_f32 v[96:97], v[96:97], v[116:117]
    v_pk_add_f32 v[98:99], v[98:99], v[118:119]
    v_pk_add_f32 v[96:97], v[96:97], v[120:121]
    v_pk_add_f32 v[98:99], v[98:99], v[122:123]
    s_waitcnt vmcnt(9) lgkmcnt(3)
    v_mfma_f32_32x32x16_bf16 v[176:191], v[80:83], a[216:219], v[176:191]
    ds_read_b128 v[246:249], v240 offset:32768
    ds_read_b128 v[250:253], v241 offset:32768
    s_waitcnt lgkmcnt(4)
    v_mfma_f32_32x32x16_bf16 v[192:207], v[84:87], a[216:219], v[192:207]
    v_pk_add_f32 v[96:97], v[96:97], v[124:125]
    v_pk_add_f32 v[98:99], v[98:99], v[126:127]
    s_nop 0
    v_mov_b32_dpp v104, v96 quad_perm:[1,0,3,2] row_mask:0xf bank_mask:0xf
    v_mov_b32_dpp v105, v97 quad_perm:[1,0,3,2] row_mask:0xf bank_mask:0xf
    v_mov_b32_dpp v106, v98 quad_perm:[1,0,3,2] row_mask:0xf bank_mask:0xf
    v_mov_b32_dpp v107, v99 quad_perm:[1,0,3,2] row_mask:0xf bank_mask:0xf
    s_waitcnt vmcnt(8) lgkmcnt(3)
    v_mfma_f32_32x32x16_bf16 v[176:191], v[88:91], a[220:223], v[176:191]
    ds_read_b128 v[80:83], v240 offset:33792
    ds_read_b128 v[84:87], v241 offset:33792
    s_waitcnt lgkmcnt(4)
    v_mfma_f32_32x32x16_bf16 v[192:207], v[92:95], a[220:223], v[192:207]
    v_and_b32 v3, 1, v1
    v_cmp_eq_u32 vcc, 0, v3
    s_nop 1
    v_cndmask_b32 v112, v104, v96, vcc
    v_cndmask_b32 v113, v105, v97, vcc
    v_cndmask_b32 v114, v106, v98, vcc
    v_cndmask_b32 v115, v107, v99, vcc
    s_waitcnt vmcnt(7) lgkmcnt(3)
    v_mfma_f32_32x32x16_bf16 v[176:191], v[246:249], a[224:227], v[176:191]
    ds_read_b128 v[88:91], v240 offset:34816
    ds_read_b128 v[92:95], v241 offset:34816
    s_waitcnt lgkmcnt(4)
    v_mfma_f32_32x32x16_bf16 v[192:207], v[250:253], a[224:227], v[192:207]
    v_cndmask_b32 v116, v96, v104, vcc
    v_cndmask_b32 v117, v97, v105, vcc
    v_mul_f32 v112, 0x3acccccd, v112
    v_mul_f32 v113, 0x3acccccd, v113
    v_mul_f32 v114, 0x3acccccd, v114
    v_mul_f32 v115, 0x3acccccd, v115
    s_waitcnt vmcnt(6) lgkmcnt(3)
    v_mfma_f32_32x32x16_bf16 v[176:191], v[80:83], a[228:231], v[176:191]
    ds_read_b128 v[246:249], v240 offset:35840
    ds_read_b128 v[250:253], v241 offset:35840
    s_waitcnt lgkmcnt(4)
    v_mfma_f32_32x32x16_bf16 v[192:207], v[84:87], a[228:231], v[192:207]
    v_mul_f32 v116, 0x3acccccd, v116
    v_mul_f32 v117, 0x3acccccd, v117
    v_fma_f32 v96, -v112, v112, v113
    v_add_f32 v96, 0x3727c5ac, v96
    v_rsq_f32_e64 v96, v96
    v_fma_f32 v97, -v112, v156, v114
    s_waitcnt vmcnt(5) lgkmcnt(3)
    v_mfma_f32_32x32x16_bf16 v[176:191], v[88:91], a[232:235], v[176:191]
    ds_read_b128 v[80:83], v240 offset:36864
    ds_read_b128 v[84:87], v241 offset:36864
    s_waitcnt lgkmcnt(4)
    v_mfma_f32_32x32x16_bf16 v[192:207], v[92:95], a[232:235], v[192:207]
    v_mul_f32_e64 v99, v112, v158
    v_fma_f32 v98, v96, v97, v157
    v_fma_f32 v99, -2.0, v116, v99
    v_fma_f32 v99, v112, v99, v115
    v_fma_f32 v100, -v112, v159, v117
    v_mul_f32 v101, v96, v99
    s_waitcnt vmcnt(4) lgkmcnt(3)
    v_mfma_f32_32x32x16_bf16 v[176:191], v[246:249], a[236:239], v[176:191]
    ds_read_b128 v[88:91], v240 offset:37888
    ds_read_b128 v[92:95], v241 offset:37888
    s_waitcnt lgkmcnt(4)
    s_nop 0
    v_mfma_f32_32x32x16_bf16 v[192:207], v[250:253], a[236:239], v[192:207]
    v_fma_f32 v101, 2.0, v100, v101
    v_fma_f32 v101, v96, v101, v160
    v_fma_f32 v101, -v98, v98, v101
    v_add_f32 v101, 0x3727c5ac, v101
    v_rsq_f32 v101, v101
    s_lshl_b32 s57, s55, 9
    s_waitcnt vmcnt(3) lgkmcnt(3)
    v_mfma_f32_32x32x16_bf16 v[176:191], v[80:83], a[240:243], v[176:191]
    ds_read_b128 v[246:249], v240 offset:38912
    ds_read_b128 v[250:253], v241 offset:38912
    s_waitcnt lgkmcnt(4)
    v_mfma_f32_32x32x16_bf16 v[192:207], v[84:87], a[240:243], v[192:207]
    s_add_u32 s57, s57, 158592
    v_mul_f32_e64 v104, v101, v96
    v_mul_f32 v105, -v104, v112
    v_mov_b32_e64 v106, v101
    v_mul_f32 v107, -v101, v98
    v_lshrrev_b32 v3, 1, v1
    s_waitcnt vmcnt(2) lgkmcnt(3)
    v_mfma_f32_32x32x16_bf16 v[176:191], v[88:91], a[244:247], v[176:191]
    ds_read_b128 v[80:83], v240 offset:39936
    ds_read_b128 v[84:87], v241 offset:39936
    s_waitcnt lgkmcnt(4)
    v_mfma_f32_32x32x16_bf16 v[192:207], v[92:95], a[244:247], v[192:207]
    v_lshlrev_b32 v3, 4, v3
    v_add_u32_e64 v3, s57, v3
    ds_write_b128 v3, v[104:107]
    v_and_b32 v3, 31, v1
    v_lshlrev_b32 v3, 4, v3
    v_add_u32 v3, s57, v3
    s_waitcnt vmcnt(1) lgkmcnt(4)
    v_mfma_f32_32x32x16_bf16 v[176:191], v[246:249], a[248:251], v[176:191]
    s_waitcnt lgkmcnt(3)
    v_mfma_f32_32x32x16_bf16 v[192:207], v[250:253], a[248:251], v[192:207]
    ds_read_b128 v[152:155], v3
    s_waitcnt vmcnt(0) lgkmcnt(3)
    v_mfma_f32_32x32x16_bf16 v[176:191], v[80:83], a[252:255], v[176:191]
    s_waitcnt lgkmcnt(2)
    s_nop 0
    v_mfma_f32_32x32x16_bf16 v[192:207], v[84:87], a[252:255], v[192:207]
    ds_read_b128 v[80:83], v242 offset:0
    ds_read_b128 v[84:87], v242 offset:1024
    ds_read_b128 v[88:91], v242 offset:2048
    ds_read_b128 v[128:131], v243 offset:0
    ds_read_b128 v[132:135], v243 offset:384
    ds_read_b128 v[136:139], v243 offset:768
    ds_read_b128 v[140:143], v243 offset:1152
    s_waitcnt lgkmcnt(6)
    v_mfma_f32_32x32x16_bf16 v[208:223], v[80:83], v[16:19], 0
    ds_read_b128 v[92:95], v242 offset:3072
    s_waitcnt lgkmcnt(1)
    v_fma_f32 v176, v176, v152, v140
    v_fma_f32 v177, v177, v152, v141
    v_fma_f32 v178, v178, v152, v142
    v_fma_f32 v179, v179, v152, v143
    v_fmac_f32 v176, v128, v153
    v_fmac_f32 v177, v129, v153
    v_fmac_f32 v178, v130, v153
    v_fmac_f32 v179, v131, v153
    v_mfma_f32_32x32x16_bf16 v[208:223], v[84:87], v[20:23], v[208:223]
    ds_read_b128 v[80:83], v242 offset:4096
    v_fmac_f32 v176, v132, v154
    v_fmac_f32 v177, v133, v154
    v_fmac_f32 v178, v134, v154
    v_fmac_f32 v179, v135, v154
    v_fmac_f32 v176, v136, v155
    v_fmac_f32 v177, v137, v155
    v_fmac_f32 v178, v138, v155
    v_fmac_f32 v179, v139, v155
    ds_read_b128 v[128:131], v243 offset:32
    ds_read_b128 v[132:135], v243 offset:416
    ds_read_b128 v[136:139], v243 offset:800
    ds_read_b128 v[140:143], v243 offset:1184
    v_pk_mul_f32 v[144:145], v[176:177], v[176:177]
    v_pk_mul_f32 v[146:147], v[178:179], v[178:179]
    v_pk_mul_f32 v[144:145], v[144:145], s[62:63]
    v_pk_mul_f32 v[146:147], v[146:147], s[62:63]
    v_pk_add_f32 v[144:145], v[144:145], s[60:61]
    v_pk_add_f32 v[146:147], v[146:147], s[60:61]
    v_pk_mul_f32 v[144:145], v[144:145], v[176:177]
    v_pk_mul_f32 v[146:147], v[146:147], v[178:179]
    v_mfma_f32_32x32x16_bf16 v[208:223], v[88:91], v[24:27], v[208:223]
    ds_read_b128 v[84:87], v242 offset:5120
    v_exp_f32 v144, v144
    v_exp_f32 v145, v145
    v_exp_f32 v146, v146
    v_exp_f32 v147, v147
    v_pk_add_f32 v[144:145], v[144:145], 1.0 op_sel_hi:[1,0]
    v_pk_add_f32 v[146:147], v[146:147], 1.0 op_sel_hi:[1,0]
    s_waitcnt lgkmcnt(6)
    v_mfma_f32_32x32x16_bf16 v[208:223], v[92:95], v[28:31], v[208:223]
    ds_read_b128 v[88:91], v242 offset:6144
    v_rcp_f32 v144, v144
    v_rcp_f32 v145, v145
    v_rcp_f32 v146, v146
    v_rcp_f32 v147, v147
    s_waitcnt lgkmcnt(6)
    v_mfma_f32_32x32x16_bf16 v[208:223], v[80:83], v[32:35], v[208:223]
    ds_read_b128 v[92:95], v242 offset:7168
    v_mul_f32 v176, v176, v144
    v_mul_f32 v177, v177, v145
    v_mul_f32 v178, v178, v146
    v_mul_f32 v179, v179, v147
    v_cvt_pk_bf16_f32 v176, v176, v177
    v_cvt_pk_bf16_f32 v177, v178, v179
    s_add_u32 s95, s95, 4096
    buffer_load_dwordx4 a[80:83], v2, s[36:39], s95 offen offset:0 sc1
    buffer_load_dwordx4 a[84:87], v2, s[36:39], s95 offen offset:1024 sc1
    buffer_load_dwordx4 a[88:91], v2, s[36:39], s95 offen offset:2048 sc1
    s_waitcnt lgkmcnt(2)
    s_nop 0
    v_mfma_f32_32x32x16_bf16 v[208:223], v[84:87], v[36:39], v[208:223]
    ds_read_b128 v[80:83], v242 offset:8192
    v_fma_f32 v180, v180, v152, v140
    v_fma_f32 v181, v181, v152, v141
    v_fma_f32 v182, v182, v152, v142
    v_fma_f32 v183, v183, v152, v143
    v_fmac_f32 v180, v128, v153
    v_fmac_f32 v181, v129, v153
    v_fmac_f32 v182, v130, v153
    v_fmac_f32 v183, v131, v153
    s_waitcnt lgkmcnt(2)
    v_mfma_f32_32x32x16_bf16 v[208:223], v[88:91], v[40:43], v[208:223]
    ds_read_b128 v[84:87], v242 offset:9216
    v_fmac_f32 v180, v132, v154
    v_fmac_f32 v181, v133, v154
    v_fmac_f32 v182, v134, v154
    v_fmac_f32 v183, v135, v154
    v_fmac_f32 v180, v136, v155
    v_fmac_f32 v181, v137, v155
    v_fmac_f32 v182, v138, v155
    v_fmac_f32_e64 v183, v139, v155
    ds_read_b128 v[128:131], v243 offset:64
    ds_read_b128 v[132:135], v243 offset:448
    ds_read_b128 v[136:139], v243 offset:832
    ds_read_b128 v[140:143], v243 offset:1216
    v_pk_mul_f32 v[148:149], v[180:181], v[180:181]
    v_pk_mul_f32 v[150:151], v[182:183], v[182:183]
    v_pk_mul_f32 v[148:149], v[148:149], s[62:63]
    v_pk_mul_f32 v[150:151], v[150:151], s[62:63]
    v_pk_add_f32 v[148:149], v[148:149], s[60:61]
    v_pk_add_f32 v[150:151], v[150:151], s[60:61]
    v_pk_mul_f32 v[148:149], v[148:149], v[180:181]
    v_pk_mul_f32 v[150:151], v[150:151], v[182:183]
    s_waitcnt lgkmcnt(6)
    v_mfma_f32_32x32x16_bf16 v[208:223], v[92:95], v[44:47], v[208:223]
    ds_read_b128 v[88:91], v242 offset:10240
    v_exp_f32 v148, v148
    v_exp_f32 v149, v149
    v_exp_f32 v150, v150
    v_exp_f32_e64 v151, v151
    v_pk_add_f32 v[148:149], v[148:149], 1.0 op_sel_hi:[1,0]
    v_pk_add_f32 v[150:151], v[150:151], 1.0 op_sel_hi:[1,0]
    s_waitcnt lgkmcnt(6)
    v_mfma_f32_32x32x16_bf16 v[208:223], v[80:83], v[48:51], v[208:223]
    ds_read_b128 v[92:95], v242 offset:11264
    v_rcp_f32 v148, v148
    v_rcp_f32 v149, v149
    v_rcp_f32 v150, v150
    v_rcp_f32 v151, v151
    s_waitcnt lgkmcnt(6)
    v_mfma_f32_32x32x16_bf16 v[208:223], v[84:87], v[52:55], v[208:223]
    ds_read_b128 v[80:83], v242 offset:12288
    v_mul_f32 v180, v180, v148
    v_mul_f32 v181, v181, v149
    v_mul_f32 v182, v182, v150
    v_mul_f32 v183, v183, v151
    v_cvt_pk_bf16_f32 v178, v180, v181
    v_cvt_pk_bf16_f32 v179, v182, v183
    buffer_load_dwordx4 a[92:95], v2, s[36:39], s95 offen offset:3072 sc1
    s_add_u32 s95, s95, 4096
    buffer_load_dwordx4 a[96:99], v2, s[36:39], s95 offen offset:0 sc1
    buffer_load_dwordx4 a[100:103], v2, s[36:39], s95 offen offset:1024 sc1
    s_add_u32 s57, s96, 0
    buffer_store_dwordx4 v[176:179], v244, s[36:39], s57 offen sc1
    s_waitcnt lgkmcnt(2)
    v_mfma_f32_32x32x16_bf16 v[208:223], v[88:91], v[56:59], v[208:223]
    ds_read_b128 v[84:87], v242 offset:13312
    v_fma_f32 v184, v184, v152, v140
    v_fma_f32 v185, v185, v152, v141
    v_fma_f32 v186, v186, v152, v142
    v_fma_f32 v187, v187, v152, v143
    v_fmac_f32 v184, v128, v153
    v_fmac_f32 v185, v129, v153
    v_fmac_f32 v186, v130, v153
    v_fmac_f32 v187, v131, v153
    s_waitcnt lgkmcnt(2)
    v_mfma_f32_32x32x16_bf16 v[208:223], v[92:95], v[60:63], v[208:223]
    ds_read_b128 v[88:91], v242 offset:14336
    v_fmac_f32 v184, v132, v154
    v_fmac_f32 v185, v133, v154
    v_fmac_f32 v186, v134, v154
    v_fmac_f32 v187, v135, v154
    v_fmac_f32 v184, v136, v155
    v_fmac_f32 v185, v137, v155
    v_fmac_f32 v186, v138, v155
    v_fmac_f32_e64 v187, v139, v155
    ds_read_b128 v[128:131], v243 offset:96
    ds_read_b128 v[132:135], v243 offset:480
    ds_read_b128 v[136:139], v243 offset:864
    ds_read_b128 v[140:143], v243 offset:1248
    v_pk_mul_f32 v[144:145], v[184:185], v[184:185]
    v_pk_mul_f32 v[146:147], v[186:187], v[186:187]
    v_pk_mul_f32 v[144:145], v[144:145], s[62:63]
    v_pk_mul_f32 v[146:147], v[146:147], s[62:63]
    v_pk_add_f32 v[144:145], v[144:145], s[60:61]
    v_pk_add_f32 v[146:147], v[146:147], s[60:61]
    v_pk_mul_f32 v[144:145], v[144:145], v[184:185]
    v_pk_mul_f32 v[146:147], v[146:147], v[186:187]
    s_waitcnt lgkmcnt(6)
    v_mfma_f32_32x32x16_bf16 v[208:223], v[80:83], v[64:67], v[208:223]
    ds_read_b128 v[92:95], v242 offset:15360
    v_exp_f32 v144, v144
    v_exp_f32 v145, v145
    v_exp_f32 v146, v146
    v_exp_f32_e64 v147, v147
    v_pk_add_f32 v[144:145], v[144:145], 1.0 op_sel_hi:[1,0]
    v_pk_add_f32 v[146:147], v[146:147], 1.0 op_sel_hi:[1,0]
    s_waitcnt lgkmcnt(6)
    v_mfma_f32_32x32x16_bf16 v[208:223], v[84:87], v[68:71], v[208:223]
    ds_read_b128 v[80:83], v242 offset:16384
    v_rcp_f32 v144, v144
    v_rcp_f32 v145, v145
    v_rcp_f32 v146, v146
    v_rcp_f32 v147, v147
    s_waitcnt lgkmcnt(6)
    v_mfma_f32_32x32x16_bf16 v[208:223], v[88:91], v[72:75], v[208:223]
    ds_read_b128 v[84:87], v242 offset:17408
    v_mul_f32 v184, v184, v144
    v_mul_f32 v185, v185, v145
    v_mul_f32 v186, v186, v146
    v_mul_f32 v187, v187, v147
    v_cvt_pk_bf16_f32 v180, v184, v185
    v_cvt_pk_bf16_f32 v181, v186, v187
    buffer_load_dwordx4 a[104:107], v2, s[36:39], s95 offen offset:2048 sc1
    buffer_load_dwordx4 a[108:111], v2, s[36:39], s95 offen offset:3072 sc1
    s_add_u32 s95, s95, 4096
    buffer_load_dwordx4 a[112:115], v2, s[36:39], s95 offen offset:0 sc1
    s_waitcnt lgkmcnt(2)
    s_nop 0
    v_mfma_f32_32x32x16_bf16 v[208:223], v[92:95], v[76:79], v[208:223]
    ds_read_b128 v[88:91], v242 offset:18432
    v_fma_f32 v188, v188, v152, v140
    v_fma_f32 v189, v189, v152, v141
    v_fma_f32 v190, v190, v152, v142
    v_fma_f32 v191, v191, v152, v143
    v_fmac_f32 v188, v128, v153
    v_fmac_f32 v189, v129, v153
    v_fmac_f32 v190, v130, v153
    v_fmac_f32 v191, v131, v153
    s_waitcnt lgkmcnt(2)
    v_mfma_f32_32x32x16_bf16 v[208:223], v[80:83], a[160:163], v[208:223]
    ds_read_b128 v[92:95], v242 offset:19456
    v_fmac_f32 v188, v132, v154
    v_fmac_f32 v189, v133, v154
    v_fmac_f32 v190, v134, v154
    v_fmac_f32 v191, v135, v154
    v_fmac_f32 v188, v136, v155
    v_fmac_f32 v189, v137, v155
    v_fmac_f32 v190, v138, v155
    v_fmac_f32_e64 v191, v139, v155
    v_pk_mul_f32 v[148:149], v[188:189], v[188:189]
    v_pk_mul_f32 v[150:151], v[190:191], v[190:191]
    v_pk_mul_f32 v[148:149], v[148:149], s[62:63]
    v_pk_mul_f32 v[150:151], v[150:151], s[62:63]
    v_pk_add_f32 v[148:149], v[148:149], s[60:61]
    v_pk_add_f32 v[150:151], v[150:151], s[60:61]
    v_pk_mul_f32 v[148:149], v[148:149], v[188:189]
    v_pk_mul_f32 v[150:151], v[150:151], v[190:191]
    s_waitcnt lgkmcnt(2)
    v_mfma_f32_32x32x16_bf16 v[208:223], v[84:87], a[164:167], v[208:223]
    ds_read_b128 v[80:83], v242 offset:20480
    v_exp_f32 v148, v148
    v_exp_f32 v149, v149
    v_exp_f32 v150, v150
    v_exp_f32_e64 v151, v151
    v_pk_add_f32 v[148:149], v[148:149], 1.0 op_sel_hi:[1,0]
    v_pk_add_f32 v[150:151], v[150:151], 1.0 op_sel_hi:[1,0]
    s_waitcnt lgkmcnt(2)
    v_mfma_f32_32x32x16_bf16 v[208:223], v[88:91], a[168:171], v[208:223]
    ds_read_b128 v[84:87], v242 offset:21504
    v_rcp_f32 v148, v148
    v_rcp_f32 v149, v149
    v_rcp_f32 v150, v150
    v_rcp_f32 v151, v151
    s_waitcnt lgkmcnt(2)
    v_mfma_f32_32x32x16_bf16 v[208:223], v[92:95], a[172:175], v[208:223]
    ds_read_b128 v[88:91], v242 offset:22528
    v_mul_f32 v188, v188, v148
    v_mul_f32 v189, v189, v149
    v_mul_f32 v190, v190, v150
    v_mul_f32 v191, v191, v151
    v_cvt_pk_bf16_f32 v182, v188, v189
    v_cvt_pk_bf16_f32 v183, v190, v191
    buffer_load_dwordx4 a[116:119], v2, s[36:39], s95 offen offset:1024 sc1
    buffer_load_dwordx4 a[120:123], v2, s[36:39], s95 offen offset:2048 sc1
    buffer_load_dwordx4 a[124:127], v2, s[36:39], s95 offen offset:3072 sc1
    s_add_u32 s57, s96, 0
    s_nop 0
    buffer_store_dwordx4 v[180:183], v244, s[36:39], s57 offen offset:512 sc1
    ds_read_b128 v[128:131], v243 offset:128
    ds_read_b128 v[132:135], v243 offset:512
    ds_read_b128 v[136:139], v243 offset:896
    ds_read_b128 v[140:143], v243 offset:1280
    s_waitcnt lgkmcnt(6)
    v_mfma_f32_32x32x16_bf16 v[208:223], v[80:83], a[176:179], v[208:223]
    ds_read_b128 v[92:95], v242 offset:23552
    s_waitcnt lgkmcnt(1)
    v_fma_f32 v192, v192, v152, v140
    v_fma_f32 v193, v193, v152, v141
    v_fma_f32 v194, v194, v152, v142
    v_fma_f32 v195, v195, v152, v143
    v_fmac_f32 v192, v128, v153
    v_fmac_f32 v193, v129, v153
    v_fmac_f32 v194, v130, v153
    v_fmac_f32 v195, v131, v153
    v_mfma_f32_32x32x16_bf16 v[208:223], v[84:87], a[180:183], v[208:223]
    ds_read_b128 v[80:83], v242 offset:24576
    v_fmac_f32 v192, v132, v154
    v_fmac_f32 v193, v133, v154
    v_fmac_f32 v194, v134, v154
    v_fmac_f32 v195, v135, v154
    v_fmac_f32 v192, v136, v155
    v_fmac_f32 v193, v137, v155
    v_fmac_f32 v194, v138, v155
    v_fmac_f32 v195, v139, v155
    ds_read_b128 v[128:131], v243 offset:160
    ds_read_b128 v[132:135], v243 offset:544
    ds_read_b128 v[136:139], v243 offset:928
    ds_read_b128 v[140:143], v243 offset:1312
    v_pk_mul_f32 v[144:145], v[192:193], v[192:193]
    v_pk_mul_f32 v[146:147], v[194:195], v[194:195]
    v_pk_mul_f32 v[144:145], v[144:145], s[62:63]
    v_pk_mul_f32 v[146:147], v[146:147], s[62:63]
    v_pk_add_f32 v[144:145], v[144:145], s[60:61]
    v_pk_add_f32 v[146:147], v[146:147], s[60:61]
    v_pk_mul_f32 v[144:145], v[144:145], v[192:193]
    v_pk_mul_f32 v[146:147], v[146:147], v[194:195]
    v_mfma_f32_32x32x16_bf16 v[208:223], v[88:91], a[184:187], v[208:223]
    ds_read_b128 v[84:87], v242 offset:25600
    v_exp_f32 v144, v144
    v_exp_f32 v145, v145
    v_exp_f32 v146, v146
    v_exp_f32 v147, v147
    v_pk_add_f32 v[144:145], v[144:145], 1.0 op_sel_hi:[1,0]
    v_pk_add_f32 v[146:147], v[146:147], 1.0 op_sel_hi:[1,0]
    s_waitcnt lgkmcnt(6)
    v_mfma_f32_32x32x16_bf16 v[208:223], v[92:95], a[188:191], v[208:223]
    ds_read_b128 v[88:91], v242 offset:26624
    v_rcp_f32 v144, v144
    v_rcp_f32 v145, v145
    v_rcp_f32 v146, v146
    v_rcp_f32 v147, v147
    s_waitcnt lgkmcnt(6)
    v_mfma_f32_32x32x16_bf16 v[208:223], v[80:83], a[192:195], v[208:223]
    ds_read_b128 v[92:95], v242 offset:27648
    v_mul_f32 v192, v192, v144
    v_mul_f32 v193, v193, v145
    v_mul_f32 v194, v194, v146
    v_mul_f32 v195, v195, v147
    v_cvt_pk_bf16_f32 v192, v192, v193
    v_cvt_pk_bf16_f32 v193, v194, v195
    s_add_u32 s95, s95, 4096
    buffer_load_dwordx4 a[128:131], v2, s[36:39], s95 offen offset:0 sc1
    buffer_load_dwordx4 a[132:135], v2, s[36:39], s95 offen offset:1024 sc1
    buffer_load_dwordx4 a[136:139], v2, s[36:39], s95 offen offset:2048 sc1
    s_waitcnt lgkmcnt(2)
    s_nop 0
    v_mfma_f32_32x32x16_bf16 v[208:223], v[84:87], a[196:199], v[208:223]
    ds_read_b128 v[80:83], v242 offset:28672
    v_fma_f32 v196, v196, v152, v140
    v_fma_f32 v197, v197, v152, v141
    v_fma_f32 v198, v198, v152, v142
    v_fma_f32 v199, v199, v152, v143
    v_fmac_f32 v196, v128, v153
    v_fmac_f32 v197, v129, v153
    v_fmac_f32 v198, v130, v153
    v_fmac_f32 v199, v131, v153
    s_waitcnt lgkmcnt(2)
    v_mfma_f32_32x32x16_bf16 v[208:223], v[88:91], a[200:203], v[208:223]
    ds_read_b128 v[84:87], v242 offset:29696
    v_fmac_f32 v196, v132, v154
    v_fmac_f32 v197, v133, v154
    v_fmac_f32 v198, v134, v154
    v_fmac_f32 v199, v135, v154
    v_fmac_f32 v196, v136, v155
    v_fmac_f32 v197, v137, v155
    v_fmac_f32 v198, v138, v155
    v_fmac_f32_e64 v199, v139, v155
    ds_read_b128 v[128:131], v243 offset:192
    ds_read_b128 v[132:135], v243 offset:576
    ds_read_b128 v[136:139], v243 offset:960
    ds_read_b128 v[140:143], v243 offset:1344
    v_pk_mul_f32 v[148:149], v[196:197], v[196:197]
    v_pk_mul_f32 v[150:151], v[198:199], v[198:199]
    v_pk_mul_f32 v[148:149], v[148:149], s[62:63]
    v_pk_mul_f32 v[150:151], v[150:151], s[62:63]
    v_pk_add_f32 v[148:149], v[148:149], s[60:61]
    v_pk_add_f32 v[150:151], v[150:151], s[60:61]
    v_pk_mul_f32 v[148:149], v[148:149], v[196:197]
    v_pk_mul_f32 v[150:151], v[150:151], v[198:199]
    s_waitcnt lgkmcnt(6)
    v_mfma_f32_32x32x16_bf16 v[208:223], v[92:95], a[204:207], v[208:223]
    ds_read_b128 v[88:91], v242 offset:30720
    v_exp_f32 v148, v148
    v_exp_f32 v149, v149
    v_exp_f32 v150, v150
    v_exp_f32_e64 v151, v151
    v_pk_add_f32 v[148:149], v[148:149], 1.0 op_sel_hi:[1,0]
    v_pk_add_f32 v[150:151], v[150:151], 1.0 op_sel_hi:[1,0]
    s_waitcnt lgkmcnt(6)
    v_mfma_f32_32x32x16_bf16 v[208:223], v[80:83], a[208:211], v[208:223]
    ds_read_b128 v[92:95], v242 offset:31744
    v_rcp_f32 v148, v148
    v_rcp_f32 v149, v149
    v_rcp_f32 v150, v150
    v_rcp_f32 v151, v151
    s_waitcnt lgkmcnt(6)
    v_mfma_f32_32x32x16_bf16 v[208:223], v[84:87], a[212:215], v[208:223]
    ds_read_b128 v[80:83], v242 offset:32768
    v_mul_f32 v196, v196, v148
    v_mul_f32 v197, v197, v149
    v_mul_f32 v198, v198, v150
    v_mul_f32 v199, v199, v151
    v_cvt_pk_bf16_f32 v194, v196, v197
    v_cvt_pk_bf16_f32 v195, v198, v199
    buffer_load_dwordx4 a[140:143], v2, s[36:39], s95 offen offset:3072 sc1
    s_add_u32 s95, s95, 4096
    buffer_load_dwordx4 a[144:147], v2, s[36:39], s95 offen offset:0 sc1
    buffer_load_dwordx4 a[148:151], v2, s[36:39], s95 offen offset:1024 sc1
    s_add_u32 s57, s96, 1024
    buffer_store_dwordx4 v[192:195], v244, s[36:39], s57 offen sc1
    s_waitcnt lgkmcnt(2)
    s_nop 0
    v_mfma_f32_32x32x16_bf16 v[208:223], v[88:91], a[216:219], v[208:223]
    ds_read_b128 v[84:87], v242 offset:33792
    v_fma_f32 v200, v200, v152, v140
    v_fma_f32 v201, v201, v152, v141
    v_fma_f32 v202, v202, v152, v142
    v_fma_f32 v203, v203, v152, v143
    v_fmac_f32 v200, v128, v153
    v_fmac_f32 v201, v129, v153
    v_fmac_f32 v202, v130, v153
    v_fmac_f32 v203, v131, v153
    s_waitcnt lgkmcnt(2)
    v_mfma_f32_32x32x16_bf16 v[208:223], v[92:95], a[220:223], v[208:223]
    ds_read_b128 v[88:91], v242 offset:34816
    v_fmac_f32 v200, v132, v154
    v_fmac_f32 v201, v133, v154
    v_fmac_f32 v202, v134, v154
    v_fmac_f32 v203, v135, v154
    v_fmac_f32 v200, v136, v155
    v_fmac_f32 v201, v137, v155
    v_fmac_f32 v202, v138, v155
    v_fmac_f32_e64 v203, v139, v155
    ds_read_b128 v[128:131], v243 offset:224
    ds_read_b128 v[132:135], v243 offset:608
    ds_read_b128 v[136:139], v243 offset:992
    ds_read_b128 v[140:143], v243 offset:1376
    v_pk_mul_f32 v[144:145], v[200:201], v[200:201]
    v_pk_mul_f32 v[146:147], v[202:203], v[202:203]
    v_pk_mul_f32 v[144:145], v[144:145], s[62:63]
    v_pk_mul_f32 v[146:147], v[146:147], s[62:63]
    v_pk_add_f32 v[144:145], v[144:145], s[60:61]
    v_pk_add_f32 v[146:147], v[146:147], s[60:61]
    v_pk_mul_f32 v[144:145], v[144:145], v[200:201]
    v_pk_mul_f32 v[146:147], v[146:147], v[202:203]
    s_waitcnt lgkmcnt(6)
    v_mfma_f32_32x32x16_bf16 v[208:223], v[80:83], a[224:227], v[208:223]
    ds_read_b128 v[92:95], v242 offset:35840
    v_exp_f32 v144, v144
    v_exp_f32 v145, v145
    v_exp_f32 v146, v146
    v_exp_f32_e64 v147, v147
    v_pk_add_f32 v[144:145], v[144:145], 1.0 op_sel_hi:[1,0]
    v_pk_add_f32 v[146:147], v[146:147], 1.0 op_sel_hi:[1,0]
    s_waitcnt lgkmcnt(6)
    v_mfma_f32_32x32x16_bf16 v[208:223], v[84:87], a[228:231], v[208:223]
    ds_read_b128 v[80:83], v242 offset:36864
    v_rcp_f32 v144, v144
    v_rcp_f32 v145, v145
    v_rcp_f32 v146, v146
    v_rcp_f32 v147, v147
    s_waitcnt lgkmcnt(6)
    v_mfma_f32_32x32x16_bf16 v[208:223], v[88:91], a[232:235], v[208:223]
    ds_read_b128 v[84:87], v242 offset:37888
    v_mul_f32 v200, v200, v144
    v_mul_f32 v201, v201, v145
    v_mul_f32 v202, v202, v146
    v_mul_f32 v203, v203, v147
    v_cvt_pk_bf16_f32 v196, v200, v201
    v_cvt_pk_bf16_f32 v197, v202, v203
    buffer_load_dwordx4 a[152:155], v2, s[36:39], s95 offen offset:2048 sc1
    buffer_load_dwordx4 a[156:159], v2, s[36:39], s95 offen offset:3072 sc1
    s_waitcnt lgkmcnt(2)
    s_nop 0
    v_mfma_f32_32x32x16_bf16 v[208:223], v[92:95], a[236:239], v[208:223]
    ds_read_b128 v[88:91], v242 offset:38912
    v_fma_f32 v204, v204, v152, v140
    v_fma_f32 v205, v205, v152, v141
    v_fma_f32 v206, v206, v152, v142
    v_fma_f32 v207, v207, v152, v143
    v_fmac_f32 v204, v128, v153
    v_fmac_f32 v205, v129, v153
    v_fmac_f32 v206, v130, v153
    v_fmac_f32 v207, v131, v153
    s_waitcnt lgkmcnt(2)
    v_mfma_f32_32x32x16_bf16 v[208:223], v[80:83], a[240:243], v[208:223]
    ds_read_b128 v[92:95], v242 offset:39936
    v_fmac_f32 v204, v132, v154
    v_fmac_f32 v205, v133, v154
    v_fmac_f32 v206, v134, v154
    v_fmac_f32 v207, v135, v154
    v_fmac_f32 v204, v136, v155
    v_fmac_f32 v205, v137, v155
    v_fmac_f32 v206, v138, v155
    v_fmac_f32_e64 v207, v139, v155
    v_pk_mul_f32 v[148:149], v[204:205], v[204:205]
    v_pk_mul_f32 v[150:151], v[206:207], v[206:207]
    v_pk_mul_f32 v[148:149], v[148:149], s[62:63]
    v_pk_mul_f32 v[150:151], v[150:151], s[62:63]
    v_pk_add_f32 v[148:149], v[148:149], s[60:61]
    v_pk_add_f32 v[150:151], v[150:151], s[60:61]
    v_pk_mul_f32 v[148:149], v[148:149], v[204:205]
    v_pk_mul_f32 v[150:151], v[150:151], v[206:207]
    s_waitcnt lgkmcnt(2)
    v_mfma_f32_32x32x16_bf16 v[208:223], v[84:87], a[244:247], v[208:223]
    v_exp_f32 v148, v148
    v_exp_f32 v149, v149
    v_exp_f32 v150, v150
    v_exp_f32_e64 v151, v151
    v_pk_add_f32 v[148:149], v[148:149], 1.0 op_sel_hi:[1,0]
    v_pk_add_f32 v[150:151], v[150:151], 1.0 op_sel_hi:[1,0]
    s_waitcnt lgkmcnt(1)
    v_mfma_f32_32x32x16_bf16 v[208:223], v[88:91], a[248:251], v[208:223]
    v_rcp_f32 v148, v148
    v_rcp_f32 v149, v149
    v_rcp_f32 v150, v150
    v_rcp_f32 v151, v151
    s_waitcnt lgkmcnt(0)
    v_mfma_f32_32x32x16_bf16 v[208:223], v[92:95], a[252:255], v[208:223]
    v_mul_f32 v204, v204, v148
    v_mul_f32 v205, v205, v149
    v_mul_f32 v206, v206, v150
    v_mul_f32 v207, v207, v151
    v_cvt_pk_bf16_f32 v198, v204, v205
    v_cvt_pk_bf16_f32 v199, v206, v207
    s_add_u32 s57, s96, 1024
    buffer_store_dwordx4 v[196:199], v244, s[36:39], s57 offen offset:512 sc1
    ds_read_b128 v[128:131], v243 offset:256
    ds_read_b128 v[132:135], v243 offset:640
    ds_read_b128 v[136:139], v243 offset:1024
    ds_read_b128 v[140:143], v243 offset:1408
    s_waitcnt lgkmcnt(0)
    v_fma_f32 v208, v208, v152, v140
    v_fma_f32 v209, v209, v152, v141
    v_fma_f32 v210, v210, v152, v142
    v_fma_f32 v211, v211, v152, v143
    v_fmac_f32 v208, v128, v153
    v_fmac_f32 v209, v129, v153
    v_fmac_f32 v210, v130, v153
    v_fmac_f32 v211, v131, v153
    v_fmac_f32 v208, v132, v154
    v_fmac_f32 v209, v133, v154
    v_fmac_f32 v210, v134, v154
    v_fmac_f32 v211, v135, v154
    v_fmac_f32 v208, v136, v155
    v_fmac_f32 v209, v137, v155
    v_fmac_f32 v210, v138, v155
    v_fmac_f32_e64 v211, v139, v155
    ds_read_b128 v[128:131], v243 offset:288
    ds_read_b128 v[132:135], v243 offset:672
    ds_read_b128 v[136:139], v243 offset:1056
    ds_read_b128 v[140:143], v243 offset:1440
    v_pk_mul_f32 v[144:145], v[208:209], v[208:209]
    v_pk_mul_f32 v[146:147], v[210:211], v[210:211]
    v_pk_mul_f32 v[144:145], v[144:145], s[62:63]
    v_pk_mul_f32 v[146:147], v[146:147], s[62:63]
    v_pk_add_f32 v[144:145], v[144:145], s[60:61]
    v_pk_add_f32 v[146:147], v[146:147], s[60:61]
    v_pk_mul_f32 v[144:145], v[144:145], v[208:209]
    v_pk_mul_f32 v[146:147], v[146:147], v[210:211]
    v_exp_f32 v144, v144
    v_exp_f32 v145, v145
    v_exp_f32 v146, v146
    v_exp_f32 v147, v147
    v_pk_add_f32 v[144:145], v[144:145], 1.0 op_sel_hi:[1,0]
    v_pk_add_f32 v[146:147], v[146:147], 1.0 op_sel_hi:[1,0]
    v_rcp_f32 v144, v144
    v_rcp_f32 v145, v145
    v_rcp_f32 v146, v146
    v_rcp_f32 v147, v147
    v_mul_f32 v208, v208, v144
    v_mul_f32 v209, v209, v145
    v_mul_f32 v210, v210, v146
    v_mul_f32 v211, v211, v147
    v_cvt_pk_bf16_f32 v208, v208, v209
    v_cvt_pk_bf16_f32 v209, v210, v211
    s_waitcnt lgkmcnt(0)
    v_fma_f32 v212, v212, v152, v140
    v_fma_f32 v213, v213, v152, v141
    v_fma_f32 v214, v214, v152, v142
    v_fma_f32 v215, v215, v152, v143
    v_fmac_f32 v212, v128, v153
    v_fmac_f32 v213, v129, v153
    v_fmac_f32 v214, v130, v153
    v_fmac_f32 v215, v131, v153
    v_fmac_f32 v212, v132, v154
    v_fmac_f32 v213, v133, v154
    v_fmac_f32 v214, v134, v154
    v_fmac_f32 v215, v135, v154
    v_fmac_f32 v212, v136, v155
    v_fmac_f32 v213, v137, v155
    v_fmac_f32 v214, v138, v155
    v_fmac_f32_e64 v215, v139, v155
    ds_read_b128 v[128:131], v243 offset:320
    ds_read_b128 v[132:135], v243 offset:704
    ds_read_b128 v[136:139], v243 offset:1088
    ds_read_b128 v[140:143], v243 offset:1472
    v_pk_mul_f32 v[148:149], v[212:213], v[212:213]
    v_pk_mul_f32 v[150:151], v[214:215], v[214:215]
    v_pk_mul_f32 v[148:149], v[148:149], s[62:63]
    v_pk_mul_f32 v[150:151], v[150:151], s[62:63]
    v_pk_add_f32 v[148:149], v[148:149], s[60:61]
    v_pk_add_f32 v[150:151], v[150:151], s[60:61]
    v_pk_mul_f32 v[148:149], v[148:149], v[212:213]
    v_pk_mul_f32 v[150:151], v[150:151], v[214:215]
    v_exp_f32 v148, v148
    v_exp_f32 v149, v149
    v_exp_f32 v150, v150
    v_exp_f32 v151, v151
    v_pk_add_f32 v[148:149], v[148:149], 1.0 op_sel_hi:[1,0]
    v_pk_add_f32 v[150:151], v[150:151], 1.0 op_sel_hi:[1,0]
    v_rcp_f32 v148, v148
    v_rcp_f32 v149, v149
    v_rcp_f32 v150, v150
    v_rcp_f32 v151, v151
    v_mul_f32 v212, v212, v148
    v_mul_f32 v213, v213, v149
    v_mul_f32 v214, v214, v150
    v_mul_f32 v215, v215, v151
    v_cvt_pk_bf16_f32 v210, v212, v213
    v_cvt_pk_bf16_f32 v211, v214, v215
    s_add_u32 s57, s96, 2048
    buffer_store_dwordx4 v[208:211], v244, s[36:39], s57 offen sc1
    s_waitcnt lgkmcnt(0)
    v_fma_f32 v216, v216, v152, v140
    v_fma_f32 v217, v217, v152, v141
    v_fma_f32 v218, v218, v152, v142
    v_fma_f32 v219, v219, v152, v143
    v_fmac_f32 v216, v128, v153
    v_fmac_f32 v217, v129, v153
    v_fmac_f32 v218, v130, v153
    v_fmac_f32 v219, v131, v153
    v_fmac_f32 v216, v132, v154
    v_fmac_f32 v217, v133, v154
    v_fmac_f32 v218, v134, v154
    v_fmac_f32 v219, v135, v154
    v_fmac_f32 v216, v136, v155
    v_fmac_f32 v217, v137, v155
    v_fmac_f32 v218, v138, v155
    v_fmac_f32_e64 v219, v139, v155
    ds_read_b128 v[128:131], v243 offset:352
    ds_read_b128 v[132:135], v243 offset:736
    ds_read_b128 v[136:139], v243 offset:1120
    ds_read_b128 v[140:143], v243 offset:1504
    v_pk_mul_f32 v[144:145], v[216:217], v[216:217]
    v_pk_mul_f32 v[146:147], v[218:219], v[218:219]
    v_pk_mul_f32 v[144:145], v[144:145], s[62:63]
    v_pk_mul_f32 v[146:147], v[146:147], s[62:63]
    v_pk_add_f32 v[144:145], v[144:145], s[60:61]
    v_pk_add_f32 v[146:147], v[146:147], s[60:61]
    v_pk_mul_f32 v[144:145], v[144:145], v[216:217]
    v_pk_mul_f32 v[146:147], v[146:147], v[218:219]
    v_exp_f32 v144, v144
    v_exp_f32 v145, v145
    v_exp_f32 v146, v146
    v_exp_f32 v147, v147
    v_pk_add_f32 v[144:145], v[144:145], 1.0 op_sel_hi:[1,0]
    v_pk_add_f32 v[146:147], v[146:147], 1.0 op_sel_hi:[1,0]
    v_rcp_f32 v144, v144
    v_rcp_f32 v145, v145
    v_rcp_f32 v146, v146
    v_rcp_f32 v147, v147
    v_mul_f32 v216, v216, v144
    v_mul_f32 v217, v217, v145
    v_mul_f32 v218, v218, v146
    v_mul_f32 v219, v219, v147
    v_cvt_pk_bf16_f32 v212, v216, v217
    v_cvt_pk_bf16_f32 v213, v218, v219
    s_waitcnt lgkmcnt(0)
    v_fma_f32 v220, v220, v152, v140
    v_fma_f32 v221, v221, v152, v141
    v_fma_f32 v222, v222, v152, v142
    v_fma_f32 v223, v223, v152, v143
    v_fmac_f32 v220, v128, v153
    v_fmac_f32 v221, v129, v153
    v_fmac_f32 v222, v130, v153
    v_fmac_f32 v223, v131, v153
    v_fmac_f32 v220, v132, v154
    v_fmac_f32 v221, v133, v154
    v_fmac_f32 v222, v134, v154
    v_fmac_f32 v223, v135, v154
    v_fmac_f32 v220, v136, v155
    v_fmac_f32 v221, v137, v155
    v_fmac_f32 v222, v138, v155
    v_fmac_f32_e64 v223, v139, v155
    v_pk_mul_f32 v[148:149], v[220:221], v[220:221]
    v_pk_mul_f32 v[150:151], v[222:223], v[222:223]
    v_pk_mul_f32 v[148:149], v[148:149], s[62:63]
    v_pk_mul_f32 v[150:151], v[150:151], s[62:63]
    v_pk_add_f32 v[148:149], v[148:149], s[60:61]
    v_pk_add_f32 v[150:151], v[150:151], s[60:61]
    v_pk_mul_f32 v[148:149], v[148:149], v[220:221]
    v_pk_mul_f32 v[150:151], v[150:151], v[222:223]
    v_exp_f32 v148, v148
    v_exp_f32 v149, v149
    v_exp_f32 v150, v150
    v_exp_f32 v151, v151
    v_pk_add_f32 v[148:149], v[148:149], 1.0 op_sel_hi:[1,0]
    v_pk_add_f32 v[150:151], v[150:151], 1.0 op_sel_hi:[1,0]
    v_rcp_f32 v148, v148
    v_rcp_f32 v149, v149
    v_rcp_f32 v150, v150
    v_rcp_f32 v151, v151
    v_mul_f32 v220, v220, v148
    v_mul_f32 v221, v221, v149
    v_mul_f32 v222, v222, v150
    v_mul_f32 v223, v223, v151
    v_cvt_pk_bf16_f32 v214, v220, v221
    v_cvt_pk_bf16_f32 v215, v222, v223
    s_add_u32 s57, s96, 2048
    buffer_store_dwordx4 v[212:215], v244, s[36:39], s57 offen offset:512 sc1
    s_waitcnt vmcnt(0)
    s_barrier
    s_lshl_b32 s62, s53, 4
    s_add_u32 s62, s62, s54
    s_cmp_lg_u32 s55, 0
    s_cbranch_scc1 PF_97
    s_lshl_b32 s57, s62, 7
    s_add_u32 s57, s57, 184320
    v_mov_b32 v3, s52
    v_mov_b32 v4, 0
    s_mov_b64 exec, 1
    buffer_store_dword v3, v4, s[36:39], s57 offen sc1
    s_nop 1
    s_mov_b64 exec, -1
PF_97:
    s_add_u32 s95, s95, 4096
    buffer_load_dwordx4 a[160:163], v2, s[36:39], s95 offen offset:0 sc1
    buffer_load_dwordx4 a[164:167], v2, s[36:39], s95 offen offset:1024 sc1
    buffer_load_dwordx4 a[168:171], v2, s[36:39], s95 offen offset:2048 sc1
    buffer_load_dwordx4 a[172:175], v2, s[36:39], s95 offen offset:3072 sc1
    s_add_u32 s95, s95, 4096
    buffer_load_dwordx4 a[176:179], v2, s[36:39], s95 offen offset:0 sc1
    buffer_load_dwordx4 a[180:183], v2, s[36:39], s95 offen offset:1024 sc1
    buffer_load_dwordx4 a[184:187], v2, s[36:39], s95 offen offset:2048 sc1
    buffer_load_dwordx4 a[188:191], v2, s[36:39], s95 offen offset:3072 sc1
    s_add_u32 s95, s95, 4096
    buffer_load_dwordx4 a[192:195], v2, s[36:39], s95 offen offset:0 sc1
    buffer_load_dwordx4 a[196:199], v2, s[36:39], s95 offen offset:1024 sc1
    buffer_load_dwordx4 a[200:203], v2, s[36:39], s95 offen offset:2048 sc1
    buffer_load_dwordx4 a[204:207], v2, s[36:39], s95 offen offset:3072 sc1
    s_add_u32 s95, s95, 4096
    buffer_load_dwordx4 a[208:211], v2, s[36:39], s95 offen offset:0 sc1
    buffer_load_dwordx4 a[212:215], v2, s[36:39], s95 offen offset:1024 sc1
    buffer_load_dwordx4 a[216:219], v2, s[36:39], s95 offen offset:2048 sc1
    buffer_load_dwordx4 a[220:223], v2, s[36:39], s95 offen offset:3072 sc1
    s_add_u32 s95, s95, 4096
    buffer_load_dwordx4 a[224:227], v2, s[36:39], s95 offen offset:0 sc1
    buffer_load_dwordx4 a[228:231], v2, s[36:39], s95 offen offset:1024 sc1
    buffer_load_dwordx4 a[232:235], v2, s[36:39], s95 offen offset:2048 sc1
    buffer_load_dwordx4 a[236:239], v2, s[36:39], s95 offen offset:3072 sc1
    s_and_b32 s60, s54, 1
    s_lshr_b32 s61, s54, 1
    s_lshl_b32 s62, s53, 3
    s_lshl_b32 s63, s60, 2
    s_add_u32 s62, s62, s63
    v_lshrrev_b32 v4, 4, v1
    s_mul_i32 s63, s61, 160
    v_lshlrev_b32_e64 v7, 3, v4
    buffer_load_dwordx2 v[200:201], v7, s[48:51], s63 offen offset:0
    buffer_load_dwordx2 v[202:203], v7, s[48:51], s63 offen offset:32
    buffer_load_dwordx2 v[204:205], v7, s[48:51], s63 offen offset:64
    buffer_load_dwordx2 v[206:207], v7, s[48:51], s63 offen offset:96
    buffer_load_dwordx2 v[208:209], v7, s[48:51], s63 offen offset:128
    s_add_u32 s57, s55, 0
    s_and_b32 s57, s57, 3
    s_add_u32 s57, s57, s62
    s_mul_i32 s57, s57, 48
    s_mul_i32 s58, s55, 12
    s_add_u32 s57, s57, s58
    s_lshl_b32 s57, s57, 10
    s_add_u32 s96, s57, 18874368
    s_add_u32 s57, s55, 1
    s_and_b32 s57, s57, 3
    s_add_u32 s57, s57, s62
    s_mul_i32 s57, s57, 48
    s_mul_i32 s58, s55, 12
    s_add_u32 s57, s57, s58
    s_lshl_b32 s57, s57, 10
    s_add_u32 s97, s57, 18874368
    s_add_u32 s57, s55, 2
    s_and_b32 s57, s57, 3
    s_add_u32 s57, s57, s62
    s_mul_i32 s57, s57, 48
    s_mul_i32 s58, s55, 12
    s_add_u32 s57, s57, s58
    s_lshl_b32 s57, s57, 10
    s_add_u32 s98, s57, 18874368
    s_add_u32 s57, s55, 3
    s_and_b32 s57, s57, 3
    s_add_u32 s57, s57, s62
    s_mul_i32 s57, s57, 48
    s_mul_i32 s58, s55, 12
    s_add_u32 s57, s57, s58
    s_lshl_b32 s57, s57, 10
    s_add_u32 s99, s57, 18874368
    s_add_u32 s57, s55, 1
    s_and_b32 s57, s57, 3
    s_mul_i32 s57, s57, 15360
    s_add_u32 s57, s57, 0
    v_add_u32 v211, s57, v2
    s_add_u32 s57, s55, 2
    s_and_b32 s57, s57, 3
    s_mul_i32 s57, s57, 15360
    s_add_u32 s57, s57, 5120
    v_add_u32 v212, s57, v2
    s_add_u32 s57, s55, 3
    s_and_b32 s57, s57, 3
    s_mul_i32 s57, s57, 15360
    s_add_u32 s57, s57, 10240
    v_add_u32 v213, s57, v2
    s_mul_i32 s57, s55, 15360
    s_add_u32 s57, s57, 0
    v_add_u32 v210, s57, v2
    v_lshlrev_b32_e64 v6, 4, v4
    v_add_u32 v6, 147456, v6
    s_add_u32 s57, s62, s55
    s_lshl_b32 s57, s57, 4
    s_mul_i32 s63, s57, 1280
    s_mul_i32 s58, s61, 160
    s_add_u32 s63, s63, s58
    v_and_b32 v3, 15, v1
    v_mul_u32_u24 v7, 1280, v3
    v_lshl_add_u32 v7, v4, 3, v7
    v_and_b32 v8, 15, v1
    s_lshl_b32 s57, s53, 4
    v_add_u32 v8, s57, v8
    v_lshlrev_b32 v8, 7, v8
    v_add_u32 v8, 184320, v8
    s_cmp_lg_u32 s55, 0
    s_cbranch_scc1 POLLS_98
    s_mov_b32 s57, 0
POLL_99:
    buffer_load_dword v9, v8, s[36:39], 0 offen sc1
    s_waitcnt vmcnt(0)
    v_cmp_ne_u32 vcc, s52, v9
    s_add_u32 s57, s57, 1
    s_cmp_gt_u32 s57, 400000
    s_cbranch_scc1 POLLD_100
    s_cbranch_vccnz POLL_99
POLLD_100:
POLLS_98:
    s_barrier
    s_nop 0
    buffer_load_dwordx4 v[16:19], v2, s[36:39], s97 offen offset:0 sc1
    buffer_load_dwordx4 v[20:23], v2, s[36:39], s97 offen offset:1024 sc1
    buffer_load_dwordx4 v[24:27], v2, s[36:39], s97 offen offset:2048 sc1
    buffer_load_dwordx4 v[28:31], v2, s[36:39], s97 offen offset:3072 sc1
    s_add_u32 s97, s97, 4096
    buffer_load_dwordx4 v[32:35], v2, s[36:39], s97 offen offset:0 sc1
    buffer_load_dwordx4 v[36:39], v2, s[36:39], s97 offen offset:1024 sc1
    buffer_load_dwordx4 v[40:43], v2, s[36:39], s97 offen offset:2048 sc1
    buffer_load_dwordx4 v[44:47], v2, s[36:39], s97 offen offset:3072 sc1
    s_add_u32 s97, s97, 4096
    buffer_load_dwordx4 v[48:51], v2, s[36:39], s97 offen offset:0 sc1
    buffer_load_dwordx4 v[52:55], v2, s[36:39], s97 offen offset:1024 sc1
    buffer_load_dwordx4 v[56:59], v2, s[36:39], s97 offen offset:2048 sc1
    buffer_load_dwordx4 v[60:63], v2, s[36:39], s97 offen offset:3072 sc1
    s_waitcnt vmcnt(11)
    s_nop 0
    v_mfma_f32_16x16x32_bf16 v[132:135], a[0:3], v[16:19], 0
    v_mfma_f32_16x16x32_bf16 v[136:139], a[4:7], v[16:19], 0
    v_mfma_f32_16x16x32_bf16 v[140:143], a[8:11], v[16:19], 0
    v_mfma_f32_16x16x32_bf16 v[144:147], a[12:15], v[16:19], 0
    v_mfma_f32_16x16x32_bf16 v[148:151], a[16:19], v[16:19], 0
    buffer_load_dwordx4 v[64:67], v2, s[36:39], s98 offen offset:0 sc1
    s_waitcnt vmcnt(11)
    s_nop 0
    v_mfma_f32_16x16x32_bf16 v[132:135], a[20:23], v[20:23], v[132:135]
    v_mfma_f32_16x16x32_bf16 v[136:139], a[24:27], v[20:23], v[136:139]
    v_mfma_f32_16x16x32_bf16 v[140:143], a[28:31], v[20:23], v[140:143]
    v_mfma_f32_16x16x32_bf16 v[144:147], a[32:35], v[20:23], v[144:147]
    v_mfma_f32_16x16x32_bf16 v[148:151], a[36:39], v[20:23], v[148:151]
    buffer_load_dwordx4 v[68:71], v2, s[36:39], s98 offen offset:1024 sc1
    s_waitcnt vmcnt(11)
    s_nop 0
    v_mfma_f32_16x16x32_bf16 v[132:135], a[40:43], v[24:27], v[132:135]
    v_mfma_f32_16x16x32_bf16 v[136:139], a[44:47], v[24:27], v[136:139]
    v_mfma_f32_16x16x32_bf16 v[140:143], a[48:51], v[24:27], v[140:143]
    v_mfma_f32_16x16x32_bf16 v[144:147], a[52:55], v[24:27], v[144:147]
    v_mfma_f32_16x16x32_bf16 v[148:151], a[56:59], v[24:27], v[148:151]
    buffer_load_dwordx4 v[72:75], v2, s[36:39], s98 offen offset:2048 sc1
    s_waitcnt vmcnt(11)
    s_nop 0
    v_mfma_f32_16x16x32_bf16 v[132:135], a[60:63], v[28:31], v[132:135]
    v_mfma_f32_16x16x32_bf16 v[136:139], a[64:67], v[28:31], v[136:139]
    v_mfma_f32_16x16x32_bf16 v[140:143], a[68:71], v[28:31], v[140:143]
    v_mfma_f32_16x16x32_bf16 v[144:147], a[72:75], v[28:31], v[144:147]
    v_mfma_f32_16x16x32_bf16 v[148:151], a[76:79], v[28:31], v[148:151]
    buffer_load_dwordx4 v[76:79], v2, s[36:39], s98 offen offset:3072 sc1
    s_waitcnt vmcnt(11)
    s_nop 0
    v_mfma_f32_16x16x32_bf16 v[132:135], a[80:83], v[32:35], v[132:135]
    v_mfma_f32_16x16x32_bf16 v[136:139], a[84:87], v[32:35], v[136:139]
    v_mfma_f32_16x16x32_bf16 v[140:143], a[88:91], v[32:35], v[140:143]
    v_mfma_f32_16x16x32_bf16 v[144:147], a[92:95], v[32:35], v[144:147]
    v_mfma_f32_16x16x32_bf16 v[148:151], a[96:99], v[32:35], v[148:151]
    s_add_u32 s98, s98, 4096
    buffer_load_dwordx4 v[80:83], v2, s[36:39], s98 offen offset:0 sc1
    s_waitcnt vmcnt(11)
    s_nop 0
    v_mfma_f32_16x16x32_bf16 v[132:135], a[100:103], v[36:39], v[132:135]
    v_mfma_f32_16x16x32_bf16 v[136:139], a[104:107], v[36:39], v[136:139]
    v_mfma_f32_16x16x32_bf16 v[140:143], a[108:111], v[36:39], v[140:143]
    v_mfma_f32_16x16x32_bf16 v[144:147], a[112:115], v[36:39], v[144:147]
    v_mfma_f32_16x16x32_bf16 v[148:151], a[116:119], v[36:39], v[148:151]
    buffer_load_dwordx4 v[84:87], v2, s[36:39], s98 offen offset:1024 sc1
    s_waitcnt vmcnt(11)
    s_nop 0
    v_mfma_f32_16x16x32_bf16 v[132:135], a[120:123], v[40:43], v[132:135]
    v_mfma_f32_16x16x32_bf16 v[136:139], a[124:127], v[40:43], v[136:139]
    v_mfma_f32_16x16x32_bf16 v[140:143], a[128:131], v[40:43], v[140:143]
    v_mfma_f32_16x16x32_bf16 v[144:147], a[132:135], v[40:43], v[144:147]
    v_mfma_f32_16x16x32_bf16 v[148:151], a[136:139], v[40:43], v[148:151]
    buffer_load_dwordx4 v[88:91], v2, s[36:39], s98 offen offset:2048 sc1
    s_waitcnt vmcnt(11)
    s_nop 0
    v_mfma_f32_16x16x32_bf16 v[132:135], a[140:143], v[44:47], v[132:135]
    v_mfma_f32_16x16x32_bf16 v[136:139], a[144:147], v[44:47], v[136:139]
    v_mfma_f32_16x16x32_bf16 v[140:143], a[148:151], v[44:47], v[140:143]
    v_mfma_f32_16x16x32_bf16 v[144:147], a[152:155], v[44:47], v[144:147]
    v_mfma_f32_16x16x32_bf16 v[148:151], a[156:159], v[44:47], v[148:151]
    buffer_load_dwordx4 v[92:95], v2, s[36:39], s98 offen offset:3072 sc1
    s_waitcnt vmcnt(11)
    s_nop 0
    v_mfma_f32_16x16x32_bf16 v[132:135], a[160:163], v[48:51], v[132:135]
    v_mfma_f32_16x16x32_bf16 v[136:139], a[164:167], v[48:51], v[136:139]
    v_mfma_f32_16x16x32_bf16 v[140:143], a[168:171], v[48:51], v[140:143]
    v_mfma_f32_16x16x32_bf16 v[144:147], a[172:175], v[48:51], v[144:147]
    v_mfma_f32_16x16x32_bf16 v[148:151], a[176:179], v[48:51], v[148:151]
    s_add_u32 s98, s98, 4096
    buffer_load_dwordx4 v[96:99], v2, s[36:39], s98 offen offset:0 sc1
    s_waitcnt vmcnt(11)
    s_nop 0
    v_mfma_f32_16x16x32_bf16 v[132:135], a[180:183], v[52:55], v[132:135]
    v_mfma_f32_16x16x32_bf16 v[136:139], a[184:187], v[52:55], v[136:139]
    v_mfma_f32_16x16x32_bf16 v[140:143], a[188:191], v[52:55], v[140:143]
    v_mfma_f32_16x16x32_bf16 v[144:147], a[192:195], v[52:55], v[144:147]
    v_mfma_f32_16x16x32_bf16 v[148:151], a[196:199], v[52:55], v[148:151]
    buffer_load_dwordx4 v[100:103], v2, s[36:39], s98 offen offset:1024 sc1
    s_waitcnt vmcnt(11)
    s_nop 0
    v_mfma_f32_16x16x32_bf16 v[132:135], a[200:203], v[56:59], v[132:135]
    v_mfma_f32_16x16x32_bf16 v[136:139], a[204:207], v[56:59], v[136:139]
    v_mfma_f32_16x16x32_bf16 v[140:143], a[208:211], v[56:59], v[140:143]
    v_mfma_f32_16x16x32_bf16 v[144:147], a[212:215], v[56:59], v[144:147]
    v_mfma_f32_16x16x32_bf16 v[148:151], a[216:219], v[56:59], v[148:151]
    buffer_load_dwordx4 v[104:107], v2, s[36:39], s98 offen offset:2048 sc1
    s_waitcnt vmcnt(11)
    s_nop 0
    v_mfma_f32_16x16x32_bf16 v[132:135], a[220:223], v[60:63], v[132:135]
    v_mfma_f32_16x16x32_bf16 v[136:139], a[224:227], v[60:63], v[136:139]
    v_mfma_f32_16x16x32_bf16 v[140:143], a[228:231], v[60:63], v[140:143]
    v_mfma_f32_16x16x32_bf16 v[144:147], a[232:235], v[60:63], v[144:147]
    v_mfma_f32_16x16x32_bf16 v[148:151], a[236:239], v[60:63], v[148:151]
    buffer_load_dwordx4 v[108:111], v2, s[36:39], s98 offen offset:3072 sc1
    s_waitcnt vmcnt(11)
    s_nop 0
    v_mfma_f32_16x16x32_bf16 v[152:155], a[0:3], v[64:67], 0
    v_mfma_f32_16x16x32_bf16 v[156:159], a[4:7], v[64:67], 0
    v_mfma_f32_16x16x32_bf16 v[160:163], a[8:11], v[64:67], 0
    v_mfma_f32_16x16x32_bf16 v[164:167], a[12:15], v[64:67], 0
    v_mfma_f32_16x16x32_bf16 v[168:171], a[16:19], v[64:67], 0
    buffer_load_dwordx4 v[16:19], v2, s[36:39], s99 offen offset:0 sc1
    s_waitcnt vmcnt(11)
    s_nop 0
    v_mfma_f32_16x16x32_bf16 v[152:155], a[20:23], v[68:71], v[152:155]
    ds_write_b128 v211, v[132:135] offset:0
    v_mfma_f32_16x16x32_bf16 v[156:159], a[24:27], v[68:71], v[156:159]
    ds_write_b128 v211, v[136:139] offset:1024
    v_mfma_f32_16x16x32_bf16 v[160:163], a[28:31], v[68:71], v[160:163]
    ds_write_b128 v211, v[140:143] offset:2048
    v_mfma_f32_16x16x32_bf16 v[164:167], a[32:35], v[68:71], v[164:167]
    v_mfma_f32_16x16x32_bf16 v[168:171], a[36:39], v[68:71], v[168:171]
    buffer_load_dwordx4 v[20:23], v2, s[36:39], s99 offen offset:1024 sc1
    s_waitcnt vmcnt(11)
    s_nop 0
    v_mfma_f32_16x16x32_bf16 v[152:155], a[40:43], v[72:75], v[152:155]
    ds_write_b128 v211, v[144:147] offset:3072
    v_mfma_f32_16x16x32_bf16 v[156:159], a[44:47], v[72:75], v[156:159]
    ds_write_b128 v211, v[148:151] offset:4096
    v_mfma_f32_16x16x32_bf16 v[160:163], a[48:51], v[72:75], v[160:163]
    v_mfma_f32_16x16x32_bf16 v[164:167], a[52:55], v[72:75], v[164:167]
    v_mfma_f32_16x16x32_bf16 v[168:171], a[56:59], v[72:75], v[168:171]
    buffer_load_dwordx4 v[24:27], v2, s[36:39], s99 offen offset:2048 sc1
    s_waitcnt vmcnt(11)
    s_nop 0
    v_mfma_f32_16x16x32_bf16 v[152:155], a[60:63], v[76:79], v[152:155]
    v_mfma_f32_16x16x32_bf16 v[156:159], a[64:67], v[76:79], v[156:159]
    v_mfma_f32_16x16x32_bf16 v[160:163], a[68:71], v[76:79], v[160:163]
    v_mfma_f32_16x16x32_bf16 v[164:167], a[72:75], v[76:79], v[164:167]
    v_mfma_f32_16x16x32_bf16 v[168:171], a[76:79], v[76:79], v[168:171]
    buffer_load_dwordx4 v[28:31], v2, s[36:39], s99 offen offset:3072 sc1
    s_waitcnt vmcnt(11)
    s_nop 0
    v_mfma_f32_16x16x32_bf16 v[152:155], a[80:83], v[80:83], v[152:155]
    v_mfma_f32_16x16x32_bf16 v[156:159], a[84:87], v[80:83], v[156:159]
    v_mfma_f32_16x16x32_bf16 v[160:163], a[88:91], v[80:83], v[160:163]
    v_mfma_f32_16x16x32_bf16 v[164:167], a[92:95], v[80:83], v[164:167]
    v_mfma_f32_16x16x32_bf16 v[168:171], a[96:99], v[80:83], v[168:171]
    s_add_u32 s99, s99, 4096
    buffer_load_dwordx4 v[32:35], v2, s[36:39], s99 offen offset:0 sc1
    s_waitcnt vmcnt(11)
    s_nop 0
    v_mfma_f32_16x16x32_bf16 v[152:155], a[100:103], v[84:87], v[152:155]
    v_mfma_f32_16x16x32_bf16 v[156:159], a[104:107], v[84:87], v[156:159]
    v_mfma_f32_16x16x32_bf16 v[160:163], a[108:111], v[84:87], v[160:163]
    v_mfma_f32_16x16x32_bf16 v[164:167], a[112:115], v[84:87], v[164:167]
    v_mfma_f32_16x16x32_bf16 v[168:171], a[116:119], v[84:87], v[168:171]
    buffer_load_dwordx4 v[36:39], v2, s[36:39], s99 offen offset:1024 sc1
    s_waitcnt vmcnt(11)
    s_nop 0
    v_mfma_f32_16x16x32_bf16 v[152:155], a[120:123], v[88:91], v[152:155]
    v_mfma_f32_16x16x32_bf16 v[156:159], a[124:127], v[88:91], v[156:159]
    v_mfma_f32_16x16x32_bf16 v[160:163], a[128:131], v[88:91], v[160:163]
    v_mfma_f32_16x16x32_bf16 v[164:167], a[132:135], v[88:91], v[164:167]
    v_mfma_f32_16x16x32_bf16 v[168:171], a[136:139], v[88:91], v[168:171]
    buffer_load_dwordx4 v[40:43], v2, s[36:39], s99 offen offset:2048 sc1
    s_waitcnt vmcnt(11)
    s_nop 0
    v_mfma_f32_16x16x32_bf16 v[152:155], a[140:143], v[92:95], v[152:155]
    v_mfma_f32_16x16x32_bf16 v[156:159], a[144:147], v[92:95], v[156:159]
    v_mfma_f32_16x16x32_bf16 v[160:163], a[148:151], v[92:95], v[160:163]
    v_mfma_f32_16x16x32_bf16 v[164:167], a[152:155], v[92:95], v[164:167]
    v_mfma_f32_16x16x32_bf16 v[168:171], a[156:159], v[92:95], v[168:171]
    buffer_load_dwordx4 v[44:47], v2, s[36:39], s99 offen offset:3072 sc1
    s_waitcnt vmcnt(11)
    s_nop 0
    v_mfma_f32_16x16x32_bf16 v[152:155], a[160:163], v[96:99], v[152:155]
    v_mfma_f32_16x16x32_bf16 v[156:159], a[164:167], v[96:99], v[156:159]
    v_mfma_f32_16x16x32_bf16 v[160:163], a[168:171], v[96:99], v[160:163]
    v_mfma_f32_16x16x32_bf16 v[164:167], a[172:175], v[96:99], v[164:167]
    v_mfma_f32_16x16x32_bf16 v[168:171], a[176:179], v[96:99], v[168:171]
    s_add_u32 s99, s99, 4096
    buffer_load_dwordx4 v[48:51], v2, s[36:39], s99 offen offset:0 sc1
    s_waitcnt vmcnt(11)
    s_nop 0
    v_mfma_f32_16x16x32_bf16 v[152:155], a[180:183], v[100:103], v[152:155]
    v_mfma_f32_16x16x32_bf16 v[156:159], a[184:187], v[100:103], v[156:159]
    v_mfma_f32_16x16x32_bf16 v[160:163], a[188:191], v[100:103], v[160:163]
    v_mfma_f32_16x16x32_bf16 v[164:167], a[192:195], v[100:103], v[164:167]
    v_mfma_f32_16x16x32_bf16 v[168:171], a[196:199], v[100:103], v[168:171]
    buffer_load_dwordx4 v[52:55], v2, s[36:39], s99 offen offset:1024 sc1
    s_waitcnt vmcnt(11)
    s_nop 0
    v_mfma_f32_16x16x32_bf16 v[152:155], a[200:203], v[104:107], v[152:155]
    v_mfma_f32_16x16x32_bf16 v[156:159], a[204:207], v[104:107], v[156:159]
    v_mfma_f32_16x16x32_bf16 v[160:163], a[208:211], v[104:107], v[160:163]
    v_mfma_f32_16x16x32_bf16 v[164:167], a[212:215], v[104:107], v[164:167]
    v_mfma_f32_16x16x32_bf16 v[168:171], a[216:219], v[104:107], v[168:171]
    buffer_load_dwordx4 v[56:59], v2, s[36:39], s99 offen offset:2048 sc1
    s_waitcnt vmcnt(11)
    s_nop 0
    v_mfma_f32_16x16x32_bf16 v[152:155], a[220:223], v[108:111], v[152:155]
    v_mfma_f32_16x16x32_bf16 v[156:159], a[224:227], v[108:111], v[156:159]
    v_mfma_f32_16x16x32_bf16 v[160:163], a[228:231], v[108:111], v[160:163]
    v_mfma_f32_16x16x32_bf16 v[164:167], a[232:235], v[108:111], v[164:167]
    v_mfma_f32_16x16x32_bf16 v[168:171], a[236:239], v[108:111], v[168:171]
    buffer_load_dwordx4 v[60:63], v2, s[36:39], s99 offen offset:3072 sc1
    s_waitcnt vmcnt(11)
    s_nop 0
    v_mfma_f32_16x16x32_bf16 v[172:175], a[0:3], v[16:19], 0
    v_mfma_f32_16x16x32_bf16 v[176:179], a[4:7], v[16:19], 0
    v_mfma_f32_16x16x32_bf16 v[180:183], a[8:11], v[16:19], 0
    v_mfma_f32_16x16x32_bf16 v[184:187], a[12:15], v[16:19], 0
    v_mfma_f32_16x16x32_bf16 v[188:191], a[16:19], v[16:19], 0
    buffer_load_dwordx4 v[64:67], v2, s[36:39], s96 offen offset:0 sc1
    s_waitcnt vmcnt(11)
    s_nop 0
    v_mfma_f32_16x16x32_bf16 v[172:175], a[20:23], v[20:23], v[172:175]
    ds_write_b128 v212, v[152:155] offset:0
    v_mfma_f32_16x16x32_bf16 v[176:179], a[24:27], v[20:23], v[176:179]
    ds_write_b128 v212, v[156:159] offset:1024
    v_mfma_f32_16x16x32_bf16 v[180:183], a[28:31], v[20:23], v[180:183]
    ds_write_b128 v212, v[160:163] offset:2048
    v_mfma_f32_16x16x32_bf16 v[184:187], a[32:35], v[20:23], v[184:187]
    v_mfma_f32_16x16x32_bf16 v[188:191], a[36:39], v[20:23], v[188:191]
    buffer_load_dwordx4 v[68:71], v2, s[36:39], s96 offen offset:1024 sc1
    s_waitcnt vmcnt(11)
    s_nop 0
    v_mfma_f32_16x16x32_bf16 v[172:175], a[40:43], v[24:27], v[172:175]
    ds_write_b128 v212, v[164:167] offset:3072
    v_mfma_f32_16x16x32_bf16 v[176:179], a[44:47], v[24:27], v[176:179]
    ds_write_b128 v212, v[168:171] offset:4096
    v_mfma_f32_16x16x32_bf16 v[180:183], a[48:51], v[24:27], v[180:183]
    v_mfma_f32_16x16x32_bf16 v[184:187], a[52:55], v[24:27], v[184:187]
    v_mfma_f32_16x16x32_bf16 v[188:191], a[56:59], v[24:27], v[188:191]
    buffer_load_dwordx4 v[72:75], v2, s[36:39], s96 offen offset:2048 sc1
    s_waitcnt vmcnt(11)
    s_nop 0
    v_mfma_f32_16x16x32_bf16 v[172:175], a[60:63], v[28:31], v[172:175]
    v_mfma_f32_16x16x32_bf16 v[176:179], a[64:67], v[28:31], v[176:179]
    v_mfma_f32_16x16x32_bf16 v[180:183], a[68:71], v[28:31], v[180:183]
    v_mfma_f32_16x16x32_bf16 v[184:187], a[72:75], v[28:31], v[184:187]
    v_mfma_f32_16x16x32_bf16 v[188:191], a[76:79], v[28:31], v[188:191]
    buffer_load_dwordx4 v[76:79], v2, s[36:39], s96 offen offset:3072 sc1
    s_waitcnt vmcnt(11)
    s_nop 0
    v_mfma_f32_16x16x32_bf16 v[172:175], a[80:83], v[32:35], v[172:175]
    v_mfma_f32_16x16x32_bf16 v[176:179], a[84:87], v[32:35], v[176:179]
    v_mfma_f32_16x16x32_bf16 v[180:183], a[88:91], v[32:35], v[180:183]
    v_mfma_f32_16x16x32_bf16 v[184:187], a[92:95], v[32:35], v[184:187]
    v_mfma_f32_16x16x32_bf16 v[188:191], a[96:99], v[32:35], v[188:191]
    s_add_u32 s96, s96, 4096
    buffer_load_dwordx4 v[80:83], v2, s[36:39], s96 offen offset:0 sc1
    s_waitcnt vmcnt(11)
    s_nop 0
    v_mfma_f32_16x16x32_bf16 v[172:175], a[100:103], v[36:39], v[172:175]
    v_mfma_f32_16x16x32_bf16 v[176:179], a[104:107], v[36:39], v[176:179]
    v_mfma_f32_16x16x32_bf16 v[180:183], a[108:111], v[36:39], v[180:183]
    v_mfma_f32_16x16x32_bf16 v[184:187], a[112:115], v[36:39], v[184:187]
    v_mfma_f32_16x16x32_bf16 v[188:191], a[116:119], v[36:39], v[188:191]
    buffer_load_dwordx4 v[84:87], v2, s[36:39], s96 offen offset:1024 sc1
    s_waitcnt vmcnt(11)
    s_nop 0
    v_mfma_f32_16x16x32_bf16 v[172:175], a[120:123], v[40:43], v[172:175]
    v_mfma_f32_16x16x32_bf16 v[176:179], a[124:127], v[40:43], v[176:179]
    v_mfma_f32_16x16x32_bf16 v[180:183], a[128:131], v[40:43], v[180:183]
    v_mfma_f32_16x16x32_bf16 v[184:187], a[132:135], v[40:43], v[184:187]
    v_mfma_f32_16x16x32_bf16 v[188:191], a[136:139], v[40:43], v[188:191]
    buffer_load_dwordx4 v[88:91], v2, s[36:39], s96 offen offset:2048 sc1
    s_waitcnt vmcnt(11)
    s_nop 0
    v_mfma_f32_16x16x32_bf16 v[172:175], a[140:143], v[44:47], v[172:175]
    v_mfma_f32_16x16x32_bf16 v[176:179], a[144:147], v[44:47], v[176:179]
    v_mfma_f32_16x16x32_bf16 v[180:183], a[148:151], v[44:47], v[180:183]
    v_mfma_f32_16x16x32_bf16 v[184:187], a[152:155], v[44:47], v[184:187]
    v_mfma_f32_16x16x32_bf16 v[188:191], a[156:159], v[44:47], v[188:191]
    buffer_load_dwordx4 v[92:95], v2, s[36:39], s96 offen offset:3072 sc1
    s_waitcnt vmcnt(11)
    s_nop 0
    v_mfma_f32_16x16x32_bf16 v[172:175], a[160:163], v[48:51], v[172:175]
    v_mfma_f32_16x16x32_bf16 v[176:179], a[164:167], v[48:51], v[176:179]
    v_mfma_f32_16x16x32_bf16 v[180:183], a[168:171], v[48:51], v[180:183]
    v_mfma_f32_16x16x32_bf16 v[184:187], a[172:175], v[48:51], v[184:187]
    v_mfma_f32_16x16x32_bf16 v[188:191], a[176:179], v[48:51], v[188:191]
    s_add_u32 s96, s96, 4096
    buffer_load_dwordx4 v[96:99], v2, s[36:39], s96 offen offset:0 sc1
    s_waitcnt vmcnt(11)
    s_nop 0
    v_mfma_f32_16x16x32_bf16 v[172:175], a[180:183], v[52:55], v[172:175]
    v_mfma_f32_16x16x32_bf16 v[176:179], a[184:187], v[52:55], v[176:179]
    v_mfma_f32_16x16x32_bf16 v[180:183], a[188:191], v[52:55], v[180:183]
    v_mfma_f32_16x16x32_bf16 v[184:187], a[192:195], v[52:55], v[184:187]
    v_mfma_f32_16x16x32_bf16 v[188:191], a[196:199], v[52:55], v[188:191]
    buffer_load_dwordx4 v[100:103], v2, s[36:39], s96 offen offset:1024 sc1
    s_waitcnt vmcnt(11)
    s_nop 0
    v_mfma_f32_16x16x32_bf16 v[172:175], a[200:203], v[56:59], v[172:175]
    v_mfma_f32_16x16x32_bf16 v[176:179], a[204:207], v[56:59], v[176:179]
    v_mfma_f32_16x16x32_bf16 v[180:183], a[208:211], v[56:59], v[180:183]
    v_mfma_f32_16x16x32_bf16 v[184:187], a[212:215], v[56:59], v[184:187]
    v_mfma_f32_16x16x32_bf16 v[188:191], a[216:219], v[56:59], v[188:191]
    buffer_load_dwordx4 v[104:107], v2, s[36:39], s96 offen offset:2048 sc1
    s_waitcnt vmcnt(11)
    s_nop 0
    v_mfma_f32_16x16x32_bf16 v[172:175], a[220:223], v[60:63], v[172:175]
    v_mfma_f32_16x16x32_bf16 v[176:179], a[224:227], v[60:63], v[176:179]
    v_mfma_f32_16x16x32_bf16 v[180:183], a[228:231], v[60:63], v[180:183]
    v_mfma_f32_16x16x32_bf16 v[184:187], a[232:235], v[60:63], v[184:187]
    v_mfma_f32_16x16x32_bf16 v[188:191], a[236:239], v[60:63], v[188:191]
    buffer_load_dwordx4 v[108:111], v2, s[36:39], s96 offen offset:3072 sc1
    s_waitcnt vmcnt(11)
    s_nop 0
    v_mfma_f32_16x16x32_bf16 v[112:115], a[0:3], v[64:67], 0
    v_mfma_f32_16x16x32_bf16 v[116:119], a[4:7], v[64:67], 0
    v_mfma_f32_16x16x32_bf16 v[120:123], a[8:11], v[64:67], 0
    v_mfma_f32_16x16x32_bf16 v[124:127], a[12:15], v[64:67], 0
    v_mfma_f32_16x16x32_bf16 v[128:131], a[16:19], v[64:67], 0
    s_waitcnt vmcnt(10)
    s_nop 0
    v_mfma_f32_16x16x32_bf16 v[112:115], a[20:23], v[68:71], v[112:115]
    ds_write_b128 v213, v[172:175] offset:0
    v_mfma_f32_16x16x32_bf16 v[116:119], a[24:27], v[68:71], v[116:119]
    ds_write_b128 v213, v[176:179] offset:1024
    v_mfma_f32_16x16x32_bf16 v[120:123], a[28:31], v[68:71], v[120:123]
    ds_write_b128 v213, v[180:183] offset:2048
    v_mfma_f32_16x16x32_bf16 v[124:127], a[32:35], v[68:71], v[124:127]
    v_mfma_f32_16x16x32_bf16 v[128:131], a[36:39], v[68:71], v[128:131]
    s_waitcnt vmcnt(9)
    s_nop 0
    v_mfma_f32_16x16x32_bf16 v[112:115], a[40:43], v[72:75], v[112:115]
    ds_write_b128 v213, v[184:187] offset:3072
    v_mfma_f32_16x16x32_bf16 v[116:119], a[44:47], v[72:75], v[116:119]
    ds_write_b128 v213, v[188:191] offset:4096
    v_mfma_f32_16x16x32_bf16 v[120:123], a[48:51], v[72:75], v[120:123]
    v_mfma_f32_16x16x32_bf16 v[124:127], a[52:55], v[72:75], v[124:127]
    v_mfma_f32_16x16x32_bf16 v[128:131], a[56:59], v[72:75], v[128:131]
    s_waitcnt vmcnt(8)
    s_nop 0
    v_mfma_f32_16x16x32_bf16 v[112:115], a[60:63], v[76:79], v[112:115]
    v_mfma_f32_16x16x32_bf16 v[116:119], a[64:67], v[76:79], v[116:119]
    v_mfma_f32_16x16x32_bf16 v[120:123], a[68:71], v[76:79], v[120:123]
    v_mfma_f32_16x16x32_bf16 v[124:127], a[72:75], v[76:79], v[124:127]
    v_mfma_f32_16x16x32_bf16 v[128:131], a[76:79], v[76:79], v[128:131]
    s_waitcnt lgkmcnt(0)
    s_barrier
    s_waitcnt vmcnt(7)
    s_nop 0
    v_mfma_f32_16x16x32_bf16 v[112:115], a[80:83], v[80:83], v[112:115]
    ds_read_b128 v[16:19], v6 offset:5440
    ds_read_b128 v[20:23], v6 offset:5504
    v_mfma_f32_16x16x32_bf16 v[116:119], a[84:87], v[80:83], v[116:119]
    ds_read_b128 v[24:27], v6 offset:5568
    ds_read_b128 v[28:31], v6 offset:5632
    v_mfma_f32_16x16x32_bf16 v[120:123], a[88:91], v[80:83], v[120:123]
    ds_read_b128 v[32:35], v6 offset:5696
    ds_read_b128 v[132:135], v210 offset:0
    v_mfma_f32_16x16x32_bf16 v[124:127], a[92:95], v[80:83], v[124:127]
    ds_read_b128 v[136:139], v210 offset:1024
    ds_read_b128 v[140:143], v210 offset:2048
    v_mfma_f32_16x16x32_bf16 v[128:131], a[96:99], v[80:83], v[128:131]
    ds_read_b128 v[144:147], v210 offset:3072
    ds_read_b128 v[148:151], v210 offset:4096
    s_waitcnt vmcnt(6)
    s_nop 0
    v_mfma_f32_16x16x32_bf16 v[112:115], a[100:103], v[84:87], v[112:115]
    ds_read_b128 v[152:155], v210 offset:5120
    ds_read_b128 v[156:159], v210 offset:6144
    v_mfma_f32_16x16x32_bf16 v[116:119], a[104:107], v[84:87], v[116:119]
    ds_read_b128 v[160:163], v210 offset:7168
    ds_read_b128 v[164:167], v210 offset:8192
    v_mfma_f32_16x16x32_bf16 v[120:123], a[108:111], v[84:87], v[120:123]
    ds_read_b128 v[168:171], v210 offset:9216
    s_waitcnt lgkmcnt(14)
    ds_read_b128 v[172:175], v210 offset:10240
    v_mfma_f32_16x16x32_bf16 v[124:127], a[112:115], v[84:87], v[124:127]
    s_waitcnt lgkmcnt(14)
    ds_read_b128 v[176:179], v210 offset:11264
    s_waitcnt lgkmcnt(14)
    ds_read_b128 v[180:183], v210 offset:12288
    v_mfma_f32_16x16x32_bf16 v[128:131], a[116:119], v[84:87], v[128:131]
    s_waitcnt lgkmcnt(14)
    ds_read_b128 v[184:187], v210 offset:13312
    s_waitcnt lgkmcnt(14)
    ds_read_b128 v[188:191], v210 offset:14336
    s_waitcnt vmcnt(5)
    v_mfma_f32_16x16x32_bf16 v[112:115], a[120:123], v[88:91], v[112:115]
    v_lshlrev_b32_e64 v36, 16, v230
    v_and_b32 v37, 0xffff0000, v230
    v_mfma_f32_16x16x32_bf16 v[116:119], a[124:127], v[88:91], v[116:119]
    v_lshlrev_b32_e64 v38, 16, v231
    v_and_b32 v39, 0xffff0000, v231
    v_mfma_f32_16x16x32_bf16 v[120:123], a[128:131], v[88:91], v[120:123]
    v_lshlrev_b32_e64 v40, 16, v232
    v_and_b32 v41, 0xffff0000, v232
    v_mfma_f32_16x16x32_bf16 v[124:127], a[132:135], v[88:91], v[124:127]
    v_lshlrev_b32_e64 v42, 16, v233
    v_and_b32 v43, 0xffff0000, v233
    v_mfma_f32_16x16x32_bf16 v[128:131], a[136:139], v[88:91], v[128:131]
    v_lshlrev_b32_e64 v44, 16, v234
    v_and_b32 v45, 0xffff0000, v234
    s_waitcnt vmcnt(4)
    v_mfma_f32_16x16x32_bf16 v[112:115], a[140:143], v[92:95], v[112:115]
    v_lshlrev_b32 v46, 16, v235
    v_and_b32 v47, 0xffff0000, v235
    v_mfma_f32_16x16x32_bf16 v[116:119], a[144:147], v[92:95], v[116:119]
    v_lshlrev_b32_e64 v48, 16, v236
    v_and_b32 v49, 0xffff0000, v236
    v_mfma_f32_16x16x32_bf16 v[120:123], a[148:151], v[92:95], v[120:123]
    v_lshlrev_b32_e64 v50, 16, v237
    v_and_b32 v51, 0xffff0000, v237
    v_mfma_f32_16x16x32_bf16 v[124:127], a[152:155], v[92:95], v[124:127]
    v_lshlrev_b32_e64 v52, 16, v238
    v_and_b32 v53, 0xffff0000, v238
    v_mfma_f32_16x16x32_bf16 v[128:131], a[156:159], v[92:95], v[128:131]
    v_lshlrev_b32_e64 v54, 16, v239
    v_and_b32 v55, 0xffff0000, v239
    s_waitcnt vmcnt(3)
    v_mfma_f32_16x16x32_bf16 v[112:115], a[160:163], v[96:99], v[112:115]
    v_lshlrev_b32 v192, 16, v200
    v_and_b32 v193, 0xffff0000, v200
    v_mfma_f32_16x16x32_bf16 v[116:119], a[164:167], v[96:99], v[116:119]
    v_pk_fma_f32 v[36:37], v[16:17], v[192:193], v[36:37]
    v_lshlrev_b32_e64 v194, 16, v201
    v_mfma_f32_16x16x32_bf16 v[120:123], a[168:171], v[96:99], v[120:123]
    v_and_b32 v195, 0xffff0000, v201
    v_pk_fma_f32 v[38:39], v[18:19], v[194:195], v[38:39]
    v_mfma_f32_16x16x32_bf16 v[124:127], a[172:175], v[96:99], v[124:127]
    v_lshlrev_b32_e64 v196, 16, v202
    v_and_b32 v197, 0xffff0000, v202
    v_mfma_f32_16x16x32_bf16 v[128:131], a[176:179], v[96:99], v[128:131]
    v_pk_fma_f32 v[40:41], v[20:21], v[196:197], v[40:41]
    v_lshlrev_b32 v198, 16, v203
    s_waitcnt vmcnt(2)
    v_mfma_f32_16x16x32_bf16 v[112:115], a[180:183], v[100:103], v[112:115]
    v_and_b32 v199, 0xffff0000, v203
    v_pk_fma_f32 v[42:43], v[22:23], v[198:199], v[42:43]
    v_mfma_f32_16x16x32_bf16 v[116:119], a[184:187], v[100:103], v[116:119]
    v_lshlrev_b32_e64 v192, 16, v204
    v_and_b32 v193, 0xffff0000, v204
    v_mfma_f32_16x16x32_bf16 v[120:123], a[188:191], v[100:103], v[120:123]
    v_pk_fma_f32 v[44:45], v[24:25], v[192:193], v[44:45]
    v_lshlrev_b32_e64 v194, 16, v205
    v_mfma_f32_16x16x32_bf16 v[124:127], a[192:195], v[100:103], v[124:127]
    v_and_b32 v195, 0xffff0000, v205
    v_pk_fma_f32 v[46:47], v[26:27], v[194:195], v[46:47]
    v_mfma_f32_16x16x32_bf16 v[128:131], a[196:199], v[100:103], v[128:131]
    v_lshlrev_b32_e64 v196, 16, v206
    v_and_b32 v197, 0xffff0000, v206
    s_waitcnt vmcnt(1)
    v_mfma_f32_16x16x32_bf16 v[112:115], a[200:203], v[104:107], v[112:115]
    v_pk_fma_f32 v[48:49], v[28:29], v[196:197], v[48:49]
    v_lshlrev_b32 v198, 16, v207
    v_mfma_f32_16x16x32_bf16 v[116:119], a[204:207], v[104:107], v[116:119]
    v_and_b32 v199, 0xffff0000, v207
    v_pk_fma_f32 v[50:51], v[30:31], v[198:199], v[50:51]
    v_mfma_f32_16x16x32_bf16 v[120:123], a[208:211], v[104:107], v[120:123]
    v_lshlrev_b32_e64 v192, 16, v208
    v_and_b32 v193, 0xffff0000, v208
    v_mfma_f32_16x16x32_bf16 v[124:127], a[212:215], v[104:107], v[124:127]
    v_pk_fma_f32 v[52:53], v[32:33], v[192:193], v[52:53]
    v_lshlrev_b32_e64 v194, 16, v209
    v_mfma_f32_16x16x32_bf16 v[128:131], a[216:219], v[104:107], v[128:131]
    v_and_b32 v195, 0xffff0000, v209
    v_pk_fma_f32 v[54:55], v[34:35], v[194:195], v[54:55]
    s_waitcnt vmcnt(0)
    s_nop 0
    v_mfma_f32_16x16x32_bf16 v[112:115], a[220:223], v[108:111], v[112:115]
    v_mfma_f32_16x16x32_bf16 v[116:119], a[224:227], v[108:111], v[116:119]
    v_mfma_f32_16x16x32_bf16 v[120:123], a[228:231], v[108:111], v[120:123]
    v_mfma_f32_16x16x32_bf16 v[124:127], a[232:235], v[108:111], v[124:127]
    v_mfma_f32_16x16x32_bf16 v[128:131], a[236:239], v[108:111], v[128:131]
    s_waitcnt lgkmcnt(9)
    v_pk_add_f32 v[132:133], v[132:133], v[152:153]
    s_waitcnt lgkmcnt(4)
    s_nop 0
    v_pk_add_f32 v[112:113], v[112:113], v[172:173]
    v_pk_add_f32 v[134:135], v[134:135], v[154:155]
    v_pk_add_f32 v[114:115], v[114:115], v[174:175]
    v_pk_add_f32 v[136:137], v[136:137], v[156:157]
    s_waitcnt lgkmcnt(3)
    v_pk_add_f32 v[116:117], v[116:117], v[176:177]
    v_pk_add_f32 v[138:139], v[138:139], v[158:159]
    v_pk_add_f32 v[118:119], v[118:119], v[178:179]
    v_pk_add_f32 v[140:141], v[140:141], v[160:161]
    s_waitcnt lgkmcnt(2)
    v_pk_add_f32 v[120:121], v[120:121], v[180:181]
    v_pk_add_f32 v[142:143], v[142:143], v[162:163]
    v_pk_add_f32 v[122:123], v[122:123], v[182:183]
    v_pk_add_f32 v[144:145], v[144:145], v[164:165]
    s_waitcnt lgkmcnt(1)
    v_pk_add_f32 v[124:125], v[124:125], v[184:185]
    v_pk_add_f32 v[146:147], v[146:147], v[166:167]
    v_pk_add_f32 v[126:127], v[126:127], v[186:187]
    v_pk_add_f32 v[148:149], v[148:149], v[168:169]
    s_waitcnt lgkmcnt(0)
    s_nop 0
    v_pk_add_f32 v[128:129], v[128:129], v[188:189]
    v_pk_add_f32 v[150:151], v[150:151], v[170:171]
    v_pk_add_f32 v[130:131], v[130:131], v[190:191]
    v_pk_add_f32 v[112:113], v[112:113], v[132:133]
    v_pk_add_f32 v[114:115], v[114:115], v[134:135]
    v_pk_add_f32 v[116:117], v[116:117], v[136:137]
    v_pk_add_f32 v[118:119], v[118:119], v[138:139]
    v_pk_add_f32 v[120:121], v[120:121], v[140:141]
    v_pk_add_f32 v[122:123], v[122:123], v[142:143]
    v_pk_add_f32 v[124:125], v[124:125], v[144:145]
    v_pk_add_f32 v[126:127], v[126:127], v[146:147]
    v_pk_add_f32 v[128:129], v[128:129], v[148:149]
    v_pk_add_f32 v[130:131], v[130:131], v[150:151]
    v_pk_fma_f32 v[36:37], v[16:17], v[112:113], v[36:37]
    v_pk_fma_f32 v[38:39], v[18:19], v[114:115], v[38:39]
    v_pk_fma_f32 v[40:41], v[20:21], v[116:117], v[40:41]
    v_pk_fma_f32 v[42:43], v[22:23], v[118:119], v[42:43]
    v_pk_fma_f32 v[44:45], v[24:25], v[120:121], v[44:45]
    v_pk_fma_f32 v[46:47], v[26:27], v[122:123], v[46:47]
    v_pk_fma_f32 v[48:49], v[28:29], v[124:125], v[48:49]
    v_pk_fma_f32 v[50:51], v[30:31], v[126:127], v[50:51]
    v_pk_fma_f32 v[52:53], v[32:33], v[128:129], v[52:53]
    v_pk_fma_f32 v[54:55], v[34:35], v[130:131], v[54:55]
    v_cvt_pk_bf16_f32 v64, v36, v37
    v_cvt_pk_bf16_f32 v65, v38, v39
    v_cvt_pk_bf16_f32 v66, v40, v41
    v_cvt_pk_bf16_f32 v67, v42, v43
    v_cvt_pk_bf16_f32 v68, v44, v45
    v_cvt_pk_bf16_f32 v69, v46, v47
    v_cvt_pk_bf16_f32 v70, v48, v49
    v_cvt_pk_bf16_f32 v71, v50, v51
    v_cvt_pk_bf16_f32 v72, v52, v53
    v_cvt_pk_bf16_f32 v73, v54, v55
    buffer_store_dwordx2 v[64:65], v7, s[32:35], s63 offen offset:0
    buffer_store_dwordx2 v[66:67], v7, s[32:35], s63 offen offset:32
    buffer_store_dwordx2 v[68:69], v7, s[32:35], s63 offen offset:64
    buffer_store_dwordx2 v[70:71], v7, s[32:35], s63 offen offset:96
    buffer_store_dwordx2 v[72:73], v7, s[32:35], s63 offen offset:128
    s_waitcnt vmcnt(0)
    s_or_b32 s57, s56, s55
    s_cmp_lg_u32 s57, 0
    s_cbranch_scc1 EP_101
    v_mov_b32 v3, s52
    v_mov_b32 v4, 0
    s_mov_b64 exec, 1
    buffer_store_dword v3, v4, s[36:39], 0 offen
EP_101:
L_END:
    s_endpgm
RSC_36:
    v_max3_f32 v3, |v128|, |v129|, |v130|
    v_max_f32 v3, v3, |v131|
    s_cmp_lg_u32 s55, 0
    s_cbranch_scc1 RSC_36_a
    v_max3_f32 v4, |v144|, |v145|, |v146|
    v_max3_f32 v3, v3, v4, |v147|
RSC_36_a:
    s_nop 1
    v_max_f32_dpp v3, v3, v3 row_ror:8 row_mask:0xf bank_mask:0xf
    s_nop 1
    v_max_f32_dpp v3, v3, v3 row_ror:4 row_mask:0xf bank_mask:0xf
    s_nop 1
    v_max_f32_dpp v3, v3, v3 row_ror:2 row_mask:0xf bank_mask:0xf
    s_nop 1
    v_max_f32_dpp v3, v3, v3 row_ror:1 row_mask:0xf bank_mask:0xf
    s_nop 1
    v_mov_b32 v4, v3
    s_nop 1
    v_permlane16_swap_b32 v3, v4
    s_nop 1
    v_max_f32 v3, v3, v4
    s_nop 1
    v_mov_b32 v4, v3
    s_nop 1
    v_permlane32_swap_b32 v3, v4
    s_nop 1
    v_max_f32 v3, v3, v4
    s_lshl_b32 s57, s55, 2
    s_add_u32 s57, s57, 161808
    v_mov_b32 v4, s57
    ds_write_b32 v4, v3
    s_waitcnt lgkmcnt(0)
    s_barrier
    v_mov_b32 v4, 161808
    ds_read_b128 v[8:11], v4
    s_waitcnt lgkmcnt(0)
    v_max3_f32 v3, v8, v9, v10
    v_max_f32 v3, v3, v11
    s_nop 1
    v_readfirstlane_b32 s57, v3
    s_nop 3
    s_lshr_b32 s57, s57, 23
    s_and_b32 s57, s57, 0xff
    s_sub_i32 s57, 267, s57
    s_max_i32 s57, s57, 27
    s_min_i32 s57, s57, 227
    s_sub_i32 s58, 254, s57
    s_lshl_b32 s57, s57, 23
    s_lshl_b32 s6, s58, 23
    v_mul_f32 v128, s57, v128
    v_mul_f32 v129, s57, v129
    v_mul_f32 v130, s57, v130
    v_mul_f32 v131, s57, v131
    v_cvt_pk_f16_f32 v132, v128, v129
    v_cvt_pk_f16_f32 v133, v130, v131
    ds_write_b64 v12, v[132:133]
    s_cmp_lg_u32 s55, 0
    s_cbranch_scc1 RSC_36_b
    v_mul_f32 v144, s57, v144
    v_mul_f32 v145, s57, v145
    v_mul_f32 v146, s57, v146
    v_mul_f32 v147, s57, v147
    v_cvt_pk_f16_f32 v148, v144, v145
    v_cvt_pk_f16_f32 v149, v146, v147
    ds_write_b64 v13, v[148:149]
RSC_36_b:
    s_waitcnt lgkmcnt(0)
    s_barrier
    s_branch RSB_35
US_39:
    v_mul_f32 v64, s6, v64
    v_mul_f32 v65, s6, v65
    v_mul_f32 v66, s6, v66
    v_mul_f32 v67, s6, v67
    v_mul_f32 v68, s6, v68
    v_mul_f32 v69, s6, v69
    v_mul_f32 v70, s6, v70
    v_mul_f32 v71, s6, v71
    v_mul_f32 v72, s6, v72
    v_mul_f32 v73, s6, v73
    v_mul_f32 v74, s6, v74
    v_mul_f32 v75, s6, v75
    v_mul_f32 v76, s6, v76
    v_mul_f32 v77, s6, v77
    v_mul_f32 v78, s6, v78
    v_mul_f32 v79, s6, v79
    v_mul_f32 v80, s6, v80
    v_mul_f32 v81, s6, v81
    v_mul_f32 v82, s6, v82
    v_mul_f32 v83, s6, v83
    v_mul_f32 v84, s6, v84
    v_mul_f32 v85, s6, v85
    v_mul_f32 v86, s6, v86
    v_mul_f32 v87, s6, v87
    v_mul_f32 v88, s6, v88
    v_mul_f32 v89, s6, v89
    v_mul_f32 v90, s6, v90
    v_mul_f32 v91, s6, v91
    v_mul_f32 v92, s6, v92
    v_mul_f32 v93, s6, v93
    v_mul_f32 v94, s6, v94
    v_mul_f32 v95, s6, v95
    v_mul_f32 v96, s6, v96
    v_mul_f32 v97, s6, v97
    v_mul_f32 v98, s6, v98
    v_mul_f32 v99, s6, v99
    v_mul_f32 v100, s6, v100
    v_mul_f32 v101, s6, v101
    v_mul_f32 v102, s6, v102
    v_mul_f32 v103, s6, v103
    v_mul_f32 v104, s6, v104
    v_mul_f32 v105, s6, v105
    v_mul_f32 v106, s6, v106
    v_mul_f32 v107, s6, v107
    v_mul_f32 v108, s6, v108
    v_mul_f32 v109, s6, v109
    v_mul_f32 v110, s6, v110
    v_mul_f32 v111, s6, v111
    v_mul_f32 v112, s6, v112
    v_mul_f32 v113, s6, v113
    v_mul_f32 v114, s6, v114
    v_mul_f32 v115, s6, v115
    v_mul_f32 v116, s6, v116
    v_mul_f32 v117, s6, v117
    v_mul_f32 v118, s6, v118
    v_mul_f32 v119, s6, v119
    v_mul_f32 v120, s6, v120
    v_mul_f32 v121, s6, v121
    v_mul_f32 v122, s6, v122
    v_mul_f32 v123, s6, v123
    v_mul_f32 v124, s6, v124
    v_mul_f32 v125, s6, v125
    v_mul_f32 v126, s6, v126
    v_mul_f32 v127, s6, v127
    s_branch USB_40
FX_52:
    v_mov_b32 v16, 0xf149f2ca
    v_mov_b32 v17, 0xf149f2ca
    v_mov_b32 v18, 0xf149f2ca
    v_mov_b32 v19, 0xf149f2ca
    v_mov_b32 v20, 0xf149f2ca
    v_mov_b32 v21, 0xf149f2ca
    v_mov_b32 v22, 0xf149f2ca
    v_mov_b32 v23, 0xf149f2ca
    v_mov_b32 v24, 0xf149f2ca
    v_mov_b32 v25, 0xf149f2ca
    v_mov_b32 v26, 0xf149f2ca
    v_mov_b32 v27, 0xf149f2ca
    v_mov_b32 v28, 0xf149f2ca
    v_mov_b32 v29, 0xf149f2ca
    v_mov_b32 v30, 0xf149f2ca
    v_mov_b32 v31, 0xf149f2ca
    s_branch FXB_53
FX_54:
    v_mov_b32 v32, 0xf149f2ca
    v_mov_b32 v33, 0xf149f2ca
    v_mov_b32 v34, 0xf149f2ca
    v_mov_b32 v35, 0xf149f2ca
    v_mov_b32 v36, 0xf149f2ca
    v_mov_b32 v37, 0xf149f2ca
    v_mov_b32 v38, 0xf149f2ca
    v_mov_b32 v39, 0xf149f2ca
    v_mov_b32 v40, 0xf149f2ca
    v_mov_b32 v41, 0xf149f2ca
    v_mov_b32 v42, 0xf149f2ca
    v_mov_b32 v43, 0xf149f2ca
    v_mov_b32 v44, 0xf149f2ca
    v_mov_b32 v45, 0xf149f2ca
    v_mov_b32 v46, 0xf149f2ca
    v_mov_b32 v47, 0xf149f2ca
    s_branch FXB_55
FX_56:
    v_mov_b32 v48, 0xf149f2ca
    v_mov_b32 v49, 0xf149f2ca
    v_mov_b32 v50, 0xf149f2ca
    v_mov_b32 v51, 0xf149f2ca
    v_mov_b32 v52, 0xf149f2ca
    v_mov_b32 v53, 0xf149f2ca
    v_mov_b32 v54, 0xf149f2ca
    v_mov_b32 v55, 0xf149f2ca
    v_mov_b32 v56, 0xf149f2ca
    v_mov_b32 v57, 0xf149f2ca
    v_mov_b32 v58, 0xf149f2ca
    v_mov_b32 v59, 0xf149f2ca
    v_mov_b32 v60, 0xf149f2ca
    v_mov_b32 v61, 0xf149f2ca
    v_mov_b32 v62, 0xf149f2ca
    v_mov_b32 v63, 0xf149f2ca
    s_branch FXB_57
FX_58:
    v_mov_b32 v64, 0xf149f2ca
    v_mov_b32 v65, 0xf149f2ca
    v_mov_b32 v66, 0xf149f2ca
    v_mov_b32 v67, 0xf149f2ca
    v_mov_b32 v68, 0xf149f2ca
    v_mov_b32 v69, 0xf149f2ca
    v_mov_b32 v70, 0xf149f2ca
    v_mov_b32 v71, 0xf149f2ca
    v_mov_b32 v72, 0xf149f2ca
    v_mov_b32 v73, 0xf149f2ca
    v_mov_b32 v74, 0xf149f2ca
    v_mov_b32 v75, 0xf149f2ca
    v_mov_b32 v76, 0xf149f2ca
    v_mov_b32 v77, 0xf149f2ca
    v_mov_b32 v78, 0xf149f2ca
    v_mov_b32 v79, 0xf149f2ca
    s_branch FXB_59
FX_60:
    v_mov_b32 v80, 0xf149f2ca
    v_mov_b32 v81, 0xf149f2ca
    v_mov_b32 v82, 0xf149f2ca
    v_mov_b32 v83, 0xf149f2ca
    v_mov_b32 v84, 0xf149f2ca
    v_mov_b32 v85, 0xf149f2ca
    v_mov_b32 v86, 0xf149f2ca
    v_mov_b32 v87, 0xf149f2ca
    v_mov_b32 v88, 0xf149f2ca
    v_mov_b32 v89, 0xf149f2ca
    v_mov_b32 v90, 0xf149f2ca
    v_mov_b32 v91, 0xf149f2ca
    v_mov_b32 v92, 0xf149f2ca
    v_mov_b32 v93, 0xf149f2ca
    v_mov_b32 v94, 0xf149f2ca
    v_mov_b32 v95, 0xf149f2ca
    s_branch FXB_61
FX_62:
    v_mov_b32 v96, 0xf149f2ca
    v_mov_b32 v97, 0xf149f2ca
    v_mov_b32 v98, 0xf149f2ca
    v_mov_b32 v99, 0xf149f2ca
    v_mov_b32 v100, 0xf149f2ca
    v_mov_b32 v101, 0xf149f2ca
    v_mov_b32 v102, 0xf149f2ca
    v_mov_b32 v103, 0xf149f2ca
    v_mov_b32 v104, 0xf149f2ca
    v_mov_b32 v105, 0xf149f2ca
    v_mov_b32 v106, 0xf149f2ca
    v_mov_b32 v107, 0xf149f2ca
    v_mov_b32 v108, 0xf149f2ca
    v_mov_b32 v109, 0xf149f2ca
    v_mov_b32 v110, 0xf149f2ca
    v_mov_b32 v111, 0xf149f2ca
    s_branch FXB_63
FX_64:
    v_mov_b32 v112, 0xf149f2ca
    v_mov_b32 v113, 0xf149f2ca
    v_mov_b32 v114, 0xf149f2ca
    v_mov_b32 v115, 0xf149f2ca
    v_mov_b32 v116, 0xf149f2ca
    v_mov_b32 v117, 0xf149f2ca
    v_mov_b32 v118, 0xf149f2ca
    v_mov_b32 v119, 0xf149f2ca
    v_mov_b32 v120, 0xf149f2ca
    v_mov_b32 v121, 0xf149f2ca
    v_mov_b32 v122, 0xf149f2ca
    v_mov_b32 v123, 0xf149f2ca
    v_mov_b32 v124, 0xf149f2ca
    v_mov_b32 v125, 0xf149f2ca
    v_mov_b32 v126, 0xf149f2ca
    v_mov_b32 v127, 0xf149f2ca
    s_branch FXB_65
FX_66:
    v_mov_b32 v128, 0xf149f2ca
    v_mov_b32 v129, 0xf149f2ca
    v_mov_b32 v130, 0xf149f2ca
    v_mov_b32 v131, 0xf149f2ca
    v_mov_b32 v132, 0xf149f2ca
    v_mov_b32 v133, 0xf149f2ca
    v_mov_b32 v134, 0xf149f2ca
    v_mov_b32 v135, 0xf149f2ca
    v_mov_b32 v136, 0xf149f2ca
    v_mov_b32 v137, 0xf149f2ca
    v_mov_b32 v138, 0xf149f2ca
    v_mov_b32 v139, 0xf149f2ca
    v_mov_b32 v140, 0xf149f2ca
    v_mov_b32 v141, 0xf149f2ca
    v_mov_b32 v142, 0xf149f2ca
    v_mov_b32 v143, 0xf149f2ca
    s_branch FXB_67
FX_68:
    v_mov_b32 v16, 0xf149f2ca
    v_mov_b32 v17, 0xf149f2ca
    v_mov_b32 v18, 0xf149f2ca
    v_mov_b32 v19, 0xf149f2ca
    v_mov_b32 v20, 0xf149f2ca
    v_mov_b32 v21, 0xf149f2ca
    v_mov_b32 v22, 0xf149f2ca
    v_mov_b32 v23, 0xf149f2ca
    v_mov_b32 v24, 0xf149f2ca
    v_mov_b32 v25, 0xf149f2ca
    v_mov_b32 v26, 0xf149f2ca
    v_mov_b32 v27, 0xf149f2ca
    v_mov_b32 v28, 0xf149f2ca
    v_mov_b32 v29, 0xf149f2ca
    v_mov_b32 v30, 0xf149f2ca
    v_mov_b32 v31, 0xf149f2ca
    s_branch FXB_69
FX_70:
    v_mov_b32 v32, 0xf149f2ca
    v_mov_b32 v33, 0xf149f2ca
    v_mov_b32 v34, 0xf149f2ca
    v_mov_b32 v35, 0xf149f2ca
    v_mov_b32 v36, 0xf149f2ca
    v_mov_b32 v37, 0xf149f2ca
    v_mov_b32 v38, 0xf149f2ca
    v_mov_b32 v39, 0xf149f2ca
    v_mov_b32 v40, 0xf149f2ca
    v_mov_b32 v41, 0xf149f2ca
    v_mov_b32 v42, 0xf149f2ca
    v_mov_b32 v43, 0xf149f2ca
    v_mov_b32 v44, 0xf149f2ca
    v_mov_b32 v45, 0xf149f2ca
    v_mov_b32 v46, 0xf149f2ca
    v_mov_b32 v47, 0xf149f2ca
    s_branch FXB_71
FX_72:
    v_mov_b32 v48, 0xf149f2ca
    v_mov_b32 v49, 0xf149f2ca
    v_mov_b32 v50, 0xf149f2ca
    v_mov_b32 v51, 0xf149f2ca
    v_mov_b32 v52, 0xf149f2ca
    v_mov_b32 v53, 0xf149f2ca
    v_mov_b32 v54, 0xf149f2ca
    v_mov_b32 v55, 0xf149f2ca
    v_mov_b32 v56, 0xf149f2ca
    v_mov_b32 v57, 0xf149f2ca
    v_mov_b32 v58, 0xf149f2ca
    v_mov_b32 v59, 0xf149f2ca
    v_mov_b32 v60, 0xf149f2ca
    v_mov_b32 v61, 0xf149f2ca
    v_mov_b32 v62, 0xf149f2ca
    v_mov_b32 v63, 0xf149f2ca
    s_branch FXB_73
FX_74:
    v_mov_b32 v64, 0xf149f2ca
    v_mov_b32 v65, 0xf149f2ca
    v_mov_b32 v66, 0xf149f2ca
    v_mov_b32 v67, 0xf149f2ca
    v_mov_b32 v68, 0xf149f2ca
    v_mov_b32 v69, 0xf149f2ca
    v_mov_b32 v70, 0xf149f2ca
    v_mov_b32 v71, 0xf149f2ca
    v_mov_b32 v72, 0xf149f2ca
    v_mov_b32 v73, 0xf149f2ca
    v_mov_b32 v74, 0xf149f2ca
    v_mov_b32 v75, 0xf149f2ca
    v_mov_b32 v76, 0xf149f2ca
    v_mov_b32 v77, 0xf149f2ca
    v_mov_b32 v78, 0xf149f2ca
    v_mov_b32 v79, 0xf149f2ca
    s_branch FXB_75
FX_76:
    v_mov_b32 v80, 0xf149f2ca
    v_mov_b32 v81, 0xf149f2ca
    v_mov_b32 v82, 0xf149f2ca
    v_mov_b32 v83, 0xf149f2ca
    v_mov_b32 v84, 0xf149f2ca
    v_mov_b32 v85, 0xf149f2ca
    v_mov_b32 v86, 0xf149f2ca
    v_mov_b32 v87, 0xf149f2ca
    v_mov_b32 v88, 0xf149f2ca
    v_mov_b32 v89, 0xf149f2ca
    v_mov_b32 v90, 0xf149f2ca
    v_mov_b32 v91, 0xf149f2ca
    v_mov_b32 v92, 0xf149f2ca
    v_mov_b32 v93, 0xf149f2ca
    v_mov_b32 v94, 0xf149f2ca
    v_mov_b32 v95, 0xf149f2ca
    s_branch FXB_77
FX_78:
    v_mov_b32 v96, 0xf149f2ca
    v_mov_b32 v97, 0xf149f2ca
    v_mov_b32 v98, 0xf149f2ca
    v_mov_b32 v99, 0xf149f2ca
    v_mov_b32 v100, 0xf149f2ca
    v_mov_b32 v101, 0xf149f2ca
    v_mov_b32 v102, 0xf149f2ca
    v_mov_b32 v103, 0xf149f2ca
    v_mov_b32 v104, 0xf149f2ca
    v_mov_b32 v105, 0xf149f2ca
    v_mov_b32 v106, 0xf149f2ca
    v_mov_b32 v107, 0xf149f2ca
    v_mov_b32 v108, 0xf149f2ca
    v_mov_b32 v109, 0xf149f2ca
    v_mov_b32 v110, 0xf149f2ca
    v_mov_b32 v111, 0xf149f2ca
    s_branch FXB_79
FX_80:
    v_mov_b32 v112, 0xf149f2ca
    v_mov_b32 v113, 0xf149f2ca
    v_mov_b32 v114, 0xf149f2ca
    v_mov_b32 v115, 0xf149f2ca
    v_mov_b32 v116, 0xf149f2ca
    v_mov_b32 v117, 0xf149f2ca
    v_mov_b32 v118, 0xf149f2ca
    v_mov_b32 v119, 0xf149f2ca
    v_mov_b32 v120, 0xf149f2ca
    v_mov_b32 v121, 0xf149f2ca
    v_mov_b32 v122, 0xf149f2ca
    v_mov_b32 v123, 0xf149f2ca
    v_mov_b32 v124, 0xf149f2ca
    v_mov_b32 v125, 0xf149f2ca
    v_mov_b32 v126, 0xf149f2ca
    v_mov_b32 v127, 0xf149f2ca
    s_branch FXB_81
FX_82:
    v_mov_b32 v128, 0xf149f2ca
    v_mov_b32 v129, 0xf149f2ca
    v_mov_b32 v130, 0xf149f2ca
    v_mov_b32 v131, 0xf149f2ca
    v_mov_b32 v132, 0xf149f2ca
    v_mov_b32 v133, 0xf149f2ca
    v_mov_b32 v134, 0xf149f2ca
    v_mov_b32 v135, 0xf149f2ca
    v_mov_b32 v136, 0xf149f2ca
    v_mov_b32 v137, 0xf149f2ca
    v_mov_b32 v138, 0xf149f2ca
    v_mov_b32 v139, 0xf149f2ca
    v_mov_b32 v140, 0xf149f2ca
    v_mov_b32 v141, 0xf149f2ca
    v_mov_b32 v142, 0xf149f2ca
    v_mov_b32 v143, 0xf149f2ca
    s_branch FXB_83
L_CODE_END:

.section .rodata,"a"
.p2align 6
.amdhsa_kernel adaLN_cond__sliding_block__mixer_channel_mlp__prompt_kernel
  .amdhsa_next_free_vgpr 512
  .amdhsa_next_free_sgpr 102
  .amdhsa_accum_offset 256
  .amdhsa_group_segment_fixed_size 0
  .amdhsa_kernarg_size 104
  .amdhsa_user_sgpr_count 2
  .amdhsa_user_sgpr_kernarg_segment_ptr 1
  .amdhsa_system_sgpr_workgroup_id_x 1
  .amdhsa_float_denorm_mode_32 3
  .amdhsa_float_denorm_mode_16_64 3
.end_amdhsa_kernel
```
